```python
import torch

def _softmax(x, axis=-1):
    return torch.softmax(x, dim=axis)

def _gelu(x):
    return torch.nn.functional.gelu(x, approximate='tanh')

def _silu(x):
    return torch.nn.functional.silu(x)

def _sigmoid(x):
    return torch.sigmoid(x)

def _layernorm(x, axis=-1, eps=1e-05):
    m = x.mean(dim=axis, keepdim=True)
    v = x.var(dim=axis, keepdim=True, unbiased=False)
    return (x - m) / torch.sqrt(v + eps)

def _scatter_add(tgt, idx, src, axis=0):
    return tgt.clone().index_add_(axis, idx, src)

def _segment_sum(src, seg, n):
    out = torch.zeros((n,) + src.shape[1:], dtype=src.dtype)
    return out.index_add_(0, seg, src)

def _pad(x, pw):
    flat = tuple((v for pair in reversed(pw) for v in pair))
    return torch.nn.functional.pad(x, flat)
kernel_name = 'parallel_sum__grouped_kv_mqa__mixer_gmlp__prompt'

def setup_inputs():

    _w = lambda a: (lambda t: t.to(torch.bfloat16) if t.is_floating_point() else t)(torch.as_tensor(a))

    def _A_setup():
        B, S, D, H = (1, 2048, 640, 32)
        Dh = D // H
        return {'x': _w((lambda *s: torch.randn(*s, dtype=torch.bfloat16) * 0.05)(B, S, D)), 'wq': _w((lambda *s: torch.randn(*s, dtype=torch.bfloat16) * 0.2)(D, H * Dh)), 'wk': _w((lambda *s: torch.randn(*s, dtype=torch.bfloat16) * 0.2)(D, Dh)), 'wv': _w((lambda *s: torch.randn(*s, dtype=torch.bfloat16) * 0.1)(D, Dh)), 'wo': _w((lambda *s: torch.randn(*s, dtype=torch.bfloat16) * 0.1)(H * Dh, D))}
    _A_in = _A_setup()

    def _B_setup():
        B, S, D, F = (1, 2048, 640, 1728)
        Fh = F // 2
        return {'x': _w((lambda *s: torch.randn(*s, dtype=torch.bfloat16) * 0.05)(B, S, D)), 'w_in': _w((lambda *s: torch.randn(*s, dtype=torch.bfloat16) * 0.8)(D, 2 * Fh)), 'w_sp': _w(0.01 * (lambda *s: torch.randn(*s, dtype=torch.bfloat16) * 0.8)(S, S)), 'b_sp': _w(1.0 + 0.01 * (lambda *s: torch.randn(*s, dtype=torch.bfloat16) * 0.1)(S)), 'w_out': _w((lambda *s: torch.randn(*s, dtype=torch.bfloat16) * 0.1)(Fh, D))}
    _B_in = _B_setup()
    return {'A_x': _A_in['x'], 'A_wq': _A_in['wq'], 'A_wk': _A_in['wk'], 'A_wv': _A_in['wv'], 'A_wo': _A_in['wo'], 'B_x': _B_in['x'], 'B_w_in': _B_in['w_in'], 'B_w_sp': _B_in['w_sp'], 'B_b_sp': _B_in['b_sp'], 'B_w_out': _B_in['w_out']}

def reference(A_x, A_wq, A_wk, A_wv, A_wo, B_x, B_w_in, B_w_sp, B_b_sp, B_w_out):

    def _A_ref(x, wq, wk, wv, wo):
        B, S, D = x.shape
        H = 32
        Dh = D // H
        q = (lambda x, *d: x.permute(*d))((x @ wq).reshape(B, S, H, Dh), 0, 2, 1, 3)
        k = x @ wk
        v = x @ wv
        scores = torch.einsum('bhqd,bkd->bhqk', q, k) * Dh ** (-0.5)
        p = _softmax(scores, axis=-1)
        o = torch.einsum('bhqk,bkd->bhqd', p, v)
        return (lambda x, *d: x.permute(*d))(o, 0, 2, 1, 3).reshape(B, S, H * Dh) @ wo

    def _B_ref(x, w_in, w_sp, b_sp, w_out):
        B, S, D = x.shape
        F = w_in.shape[-1]
        Fh = F // 2
        z = _gelu(torch.einsum('bsd,df->bsf', x, w_in))
        z1 = z[..., :Fh].clone()
        z2 = _layernorm(z[..., Fh:], axis=-1)
        g = torch.einsum('ts,bsf->btf', w_sp, z2) + b_sp[None, :, None]
        return torch.einsum('bsf,fd->bsd', z1 * g, w_out)
    x = A_x
    xn = _layernorm(x, axis=-1)
    return x + _A_ref(xn, A_wq, A_wk, A_wv, A_wo) + _B_ref(xn, B_w_in, B_w_sp, B_b_sp, B_w_out)
```

```asm
; @launch grid=(256,1,1) block=(768,1,1) lds=163456
.amdgcn_target "amdgcn-amd-amdhsa--gfx950"
.text
.globl parallel_sum__grouped_kv_mqa__mixer_gmlp__prompt_kernel
.p2align 8
.type parallel_sum__grouped_kv_mqa__mixer_gmlp__prompt_kernel,@function
parallel_sum__grouped_kv_mqa__mixer_gmlp__prompt_kernel:
    s_cmp_ge_u32 s2, 256
    s_cbranch_scc1 L_parallel_sum__grouped_kv_mqa__mixer_gmlp__prompt_end_1
    s_load_dwordx8 s[44:51], s[0:1], 0
    s_load_dwordx2 s[52:53], s[0:1], 32
    s_load_dwordx8 s[56:63], s[0:1], 48
    s_load_dwordx4 s[64:67], s[0:1], 80
    s_load_dwordx2 s[68:69], s[0:1], 96
    v_lshrrev_b32 v2, 6, v0
    v_and_b32 v1, 63, v0
    v_readfirstlane_b32 s3, v2
    v_and_b32 v2, 31, v0
    v_lshlrev_b32 v2, 2, v2
    v_add_u32 v2, 163328, v2
    v_mov_b32_e64 v3, 0
    ds_write_b32 v2, v3
    v_and_b32 v2, 3, v0
    v_lshlrev_b32 v2, 8, v2
    v_add_u32 v2, 161280, v2
    ds_write_b32 v2, v3
    s_and_b32 s6, s2, 7
    s_lshl_b32 s5, s6, 5
    s_lshr_b32 s4, s2, 3
    s_add_u32 s5, s5, s4
    s_lshl_b32 s4, s5, 3
    s_add_u32 s4, s4, s3
    s_lshl_b32 s6, s6, 1
    s_bfe_u32 s7, s2, 0x10003
    s_add_u32 s6, s6, s7
    s_lshr_b32 s7, s2, 4
    s_and_b32 s98, s2, 7
    s_lshl_b32 s98, s98, 2
    s_bfe_u32 s99, s2, 0x20003
    s_add_u32 s98, s98, s99
    s_lshr_b32 s99, s2, 5
    s_mov_b32 s70, 400000
    s_waitcnt lgkmcnt(0)
    s_bfe_u32 s6, s2, 0x20001
    s_lshl_b32 s6, s6, 2
    s_bfe_u32 s7, s2, 0x20003
    s_add_u32 s6, s6, s7
    s_and_b32 s7, s2, 1
    s_mul_i32 s7, s7, 7
    s_add_u32 s7, s7, s99
    s_add_u32 s72, s68, 0x00700000
    s_addc_u32 s73, s69, 0
    s_mov_b32 s74, 0x00080080
    s_mov_b32 s75, 0x00020000
    s_load_dwordx2 s[96:97], s[72:73], 0x00080000
    s_cmp_ge_u32 s3, 8
    s_cbranch_scc1 L_parallel_sum__grouped_kv_mqa__mixer_gmlp__prompt_gem_2
    s_mov_b32 s8, s44
    s_mov_b32 s9, s45
    s_mov_b32 s10, 0x00280000
    s_mov_b32 s11, 0x00020000
    s_mul_i32 s16, s4, 1280
    v_lshlrev_b32_e64 v30, 4, v1
    s_mov_b32 s24, 0xffff0000
    v_mov_b32 v8, 0
    v_mov_b32 v9, 0
    v_mov_b32 v10, 0
    v_mov_b32 v11, 0
    buffer_load_dwordx4 v[4:7], v30, s[8:11], s16 offen
    s_mov_b64 exec, 0xffff
    buffer_load_dwordx4 v[8:11], v30, s[8:11], s16 offen offset:1024
    s_mov_b64 exec, -1
    v_lshlrev_b32 v31, 7, v1
    s_and_b32 s17, s4, 255
    s_mov_b32 s28, s46
    s_mov_b32 s29, s47
    s_mov_b32 s30, 0x000c8000
    s_mov_b32 s31, 0x00020000
    s_mov_b32 s32, s48
    s_mov_b32 s33, s49
    s_mov_b32 s34, 0x00006400
    s_mov_b32 s35, 0x00020000
    s_mov_b32 s36, s50
    s_mov_b32 s37, s51
    s_mov_b32 s38, 0x00006400
    s_mov_b32 s39, 0x00020000
    s_lshl_b32 s17, s2, 3
    s_add_u32 s17, s17, s3
    s_mul_i32 s18, s17, 512
    s_lshl_b32 s19, s17, 7
    s_mov_b64 exec, 0x0000000f
    buffer_load_dword v32, v31, s[28:31], s18 offen
    s_mov_b64 exec, 1
    buffer_load_dword v32, v31, s[32:35], s19 offen
    buffer_load_dword v32, v31, s[36:39], s19 offen
    s_mov_b64 exec, -1
    s_add_u32 s12, s68, 0x00280000
    s_addc_u32 s13, s69, 0
    s_mov_b32 s14, 0x00280000
    s_mov_b32 s15, 0x00020000
    s_waitcnt lgkmcnt(0)
    s_add_u32 s96, s96, 1
    v_and_b32 v129, 31, v1
    v_lshrrev_b32_e64 v130, 5, v1
    v_mov_b32 v132, 0x3f803f80
    v_mov_b32 v133, 0x3f803f80
    s_mov_b32 s27, 0
    s_lshl_b32 s16, s3, 7
    v_lshl_add_u32 v150, v1, 10, s16
    s_cmp_lg_u32 s99, 7
    s_cbranch_scc1 L_parallel_sum__grouped_kv_mqa__mixer_gmlp__prompt_q1_11
    s_lshr_b32 s17, s3, 1
    s_lshl_b32 s17, s17, 12
    s_and_b32 s19, s3, 1
    s_mul_i32 s18, s19, 1280
    s_cmp_ge_u32 s3, 6
    s_cselect_b32 s17, s18, s17
    s_mul_i32 s19, s19, 2688
    s_add_u32 s19, s19, 54784
    v_bfe_u32 v136, v129, 1, 3
    v_xor_b32 v136, v136, v130
    s_and_b32 s16, s3, 1
    s_lshl_b32 s16, s16, 12
    s_add_u32 s16, s16, 20992
    v_lshl_add_u32 v137, v129, 7, s16
    v_xor_b32_e64 v138, 0, v136
    v_lshl_add_u32 v124, v138, 4, v137
    v_xor_b32_e64 v138, 2, v136
    v_lshl_add_u32 v125, v138, 4, v137
    v_xor_b32_e64 v138, 4, v136
    v_lshl_add_u32 v126, v138, 4, v137
    v_xor_b32_e64 v138, 6, v136
    v_lshl_add_u32 v127, v138, 4, v137
    v_bfe_u32 v136, v1, 2, 2
    v_lshl_add_u32 v136, v130, 3, v136
    v_mul_u32_u24_e64 v136, 40, v136
    v_bfe_u32 v137, v1, 4, 1
    v_lshl_add_u32 v136, v137, 5, v136
    v_and_b32_e64 v137, 3, v1
    v_lshl_add_u32 v136, v137, 3, v136
    s_add_u32 s16, s17, 29184
    v_add_u32 v128, s16, v136
    v_mov_b32 v36, 0
    v_mov_b32 v37, 0
    v_mov_b32 v38, 0
    v_mov_b32 v39, 0
    v_mov_b32 v40, 0
    v_mov_b32 v41, 0
    v_mov_b32 v42, 0
    v_mov_b32 v43, 0
    v_mov_b32 v44, 0
    v_mov_b32 v45, 0
    v_mov_b32 v46, 0
    v_mov_b32 v47, 0
    v_mov_b32 v48, 0
    v_mov_b32 v49, 0
    v_mov_b32 v50, 0
    v_mov_b32 v51, 0
    v_mov_b32 v52, 0
    v_mov_b32 v53, 0
    v_mov_b32 v54, 0
    v_mov_b32 v55, 0
    v_mov_b32 v56, 0
    v_mov_b32 v57, 0
    v_mov_b32 v58, 0
    v_mov_b32 v59, 0
    s_waitcnt vmcnt(3)
    v_lshlrev_b32 v12, 16, v4
    v_and_b32 v13, s24, v4
    v_lshlrev_b32 v14, 16, v5
    v_and_b32 v15, s24, v5
    v_lshlrev_b32 v16, 16, v6
    v_and_b32 v17, s24, v6
    v_lshlrev_b32 v18, 16, v7
    v_and_b32 v19, s24, v7
    v_lshlrev_b32 v20, 16, v8
    v_and_b32 v21, s24, v8
    v_lshlrev_b32 v22, 16, v9
    v_and_b32 v23, s24, v9
    v_lshlrev_b32 v24, 16, v10
    v_and_b32 v25, s24, v10
    v_lshlrev_b32 v26, 16, v11
    v_and_b32 v27, s24, v11
    v_add_f32 v28, v12, v13
    v_mul_f32 v29, v12, v12
    v_fmac_f32 v29, v13, v13
    v_add_f32 v28, v28, v14
    v_fmac_f32 v29, v14, v14
    v_add_f32 v28, v28, v15
    v_fmac_f32 v29, v15, v15
    v_add_f32 v28, v28, v16
    v_fmac_f32 v29, v16, v16
    v_add_f32 v28, v28, v17
    v_fmac_f32 v29, v17, v17
    v_add_f32 v28, v28, v18
    v_fmac_f32 v29, v18, v18
    v_add_f32 v28, v28, v19
    v_fmac_f32 v29, v19, v19
    v_add_f32 v28, v28, v20
    v_fmac_f32 v29, v20, v20
    v_add_f32 v28, v28, v21
    v_fmac_f32 v29, v21, v21
    v_add_f32 v28, v28, v22
    v_fmac_f32 v29, v22, v22
    v_add_f32 v28, v28, v23
    v_fmac_f32 v29, v23, v23
    v_add_f32 v28, v28, v24
    v_fmac_f32 v29, v24, v24
    v_add_f32 v28, v28, v25
    v_fmac_f32 v29, v25, v25
    v_add_f32 v28, v28, v26
    v_fmac_f32 v29, v26, v26
    v_add_f32 v28, v28, v27
    v_fmac_f32 v29, v27, v27
    s_nop 0
    v_add_f32_dpp v28, v28, v28 row_shr:1 row_mask:0xf bank_mask:0xf bound_ctrl:0
    v_add_f32_dpp v29, v29, v29 row_shr:1 row_mask:0xf bank_mask:0xf bound_ctrl:0
    s_nop 0
    v_add_f32_dpp v28, v28, v28 row_shr:2 row_mask:0xf bank_mask:0xf bound_ctrl:0
    v_add_f32_dpp v29, v29, v29 row_shr:2 row_mask:0xf bank_mask:0xf bound_ctrl:0
    s_nop 0
    v_add_f32_dpp v28, v28, v28 row_shr:4 row_mask:0xf bank_mask:0xf bound_ctrl:0
    v_add_f32_dpp v29, v29, v29 row_shr:4 row_mask:0xf bank_mask:0xf bound_ctrl:0
    s_nop 0
    v_add_f32_dpp v28, v28, v28 row_shr:8 row_mask:0xf bank_mask:0xf bound_ctrl:0
    v_add_f32_dpp v29, v29, v29 row_shr:8 row_mask:0xf bank_mask:0xf bound_ctrl:0
    s_nop 0
    v_add_f32_dpp v28, v28, v28 row_bcast:15 row_mask:0xa bank_mask:0xf
    v_add_f32_dpp v29, v29, v29 row_bcast:15 row_mask:0xa bank_mask:0xf
    s_nop 0
    v_add_f32_dpp v28, v28, v28 row_bcast:31 row_mask:0xc bank_mask:0xf
    v_add_f32_dpp v29, v29, v29 row_bcast:31 row_mask:0xc bank_mask:0xf
    v_mul_f32 v28, 0x3acccccd, v28
    v_mul_f32 v29, 0x3acccccd, v29
    v_fma_f32 v29, -v28, v28, v29
    v_max_f32 v29, 0, v29
    v_add_f32 v29, 0x3727c5ac, v29
    v_rsq_f32_e64 v29, v29
    s_mul_i32 s22, s4, 1280
    v_mul_f32 v28, v28, v29
    s_nop 0
    v_readlane_b32 s20, v29, 63
    v_readlane_b32 s21, v28, 63
    s_nop 1
    v_mov_b32 v28, s21
    v_fma_f32 v12, v12, s20, -v28
    v_fma_f32 v13, v13, s20, -v28
    v_fma_f32 v14, v14, s20, -v28
    v_fma_f32 v15, v15, s20, -v28
    v_fma_f32 v16, v16, s20, -v28
    v_fma_f32 v17, v17, s20, -v28
    v_fma_f32 v18, v18, s20, -v28
    v_fma_f32 v19, v19, s20, -v28
    v_fma_f32 v20, v20, s20, -v28
    v_fma_f32 v21, v21, s20, -v28
    v_fma_f32 v22, v22, s20, -v28
    v_fma_f32 v23, v23, s20, -v28
    v_fma_f32 v24, v24, s20, -v28
    v_fma_f32 v25, v25, s20, -v28
    v_fma_f32 v26, v26, s20, -v28
    v_fma_f32 v27, v27, s20, -v28
    v_cvt_pk_bf16_f32 v4, v12, v13
    v_cvt_pk_bf16_f32 v5, v14, v15
    v_cvt_pk_bf16_f32 v6, v16, v17
    v_cvt_pk_bf16_f32 v7, v18, v19
    v_cvt_pk_bf16_f32 v8, v20, v21
    v_cvt_pk_bf16_f32 v9, v22, v23
    v_cvt_pk_bf16_f32 v10, v24, v25
    v_cvt_pk_bf16_f32 v11, v26, v27
    buffer_store_dwordx4 v[4:7], v30, s[12:15], s22 offen sc1
    s_mov_b64 exec, 0xffff
    buffer_store_dwordx4 v[8:11], v30, s[12:15], s22 offen offset:1024 sc1
    s_mov_b64 exec, -1
    s_cmp_ge_u32 s3, 6
    s_cbranch_scc1 L_parallel_sum__grouped_kv_mqa__mixer_gmlp__prompt_kx_7
    s_cmp_ge_u32 s3, 4
    s_cbranch_scc1 L_parallel_sum__grouped_kv_mqa__mixer_gmlp__prompt_ki_8
    s_cmp_ge_u32 s3, 2
    s_cbranch_scc1 L_parallel_sum__grouped_kv_mqa__mixer_gmlp__prompt_kvv_9
    s_mov_b32 s25, 0
    s_barrier
    ds_read_b128 v[60:63], v124
    ds_read_b64_tr_b16 v[92:93], v128 offset:0
    ds_read_b64_tr_b16 v[94:95], v128 offset:160
    ds_read_b128 v[64:67], v125
    ds_read_b64_tr_b16 v[96:97], v128 offset:640
    ds_read_b64_tr_b16 v[98:99], v128 offset:800
    ds_read_b128 v[68:71], v126
    ds_read_b64_tr_b16 v[100:101], v128 offset:1280
    ds_read_b64_tr_b16 v[102:103], v128 offset:1440
    ds_read_b128 v[72:75], v127
    ds_read_b64_tr_b16 v[104:105], v128 offset:1920
    ds_read_b64_tr_b16 v[106:107], v128 offset:2080
L_parallel_sum__grouped_kv_mqa__mixer_gmlp__prompt_fl_16:
    s_mov_b32 s26, 20480
    s_cmp_eq_u32 s25, 5
    s_cmov_b32 s26, 0xfffe7000
    v_add_u32 v124, s26, v124
    v_add_u32 v125, s26, v125
    v_add_u32 v126, s26, v126
    v_add_u32 v127, s26, v127
    v_add_u32 v128, s26, v128
    s_waitcnt lgkmcnt(0)
    v_mfma_f32_32x32x16_bf16 v[36:51], v[92:95], v[60:63], v[36:51]
    ds_read_b128 v[76:79], v124
    ds_read_b64_tr_b16 v[108:109], v128 offset:0
    ds_read_b64_tr_b16 v[110:111], v128 offset:160
    ds_read_b128 v[80:83], v125
    v_mfma_f32_32x32x16_bf16 v[36:51], v[96:99], v[64:67], v[36:51]
    ds_read_b64_tr_b16 v[112:113], v128 offset:640
    ds_read_b64_tr_b16 v[114:115], v128 offset:800
    ds_read_b128 v[84:87], v126
    ds_read_b64_tr_b16 v[116:117], v128 offset:1280
    v_mfma_f32_32x32x16_bf16 v[36:51], v[100:103], v[68:71], v[36:51]
    ds_read_b64_tr_b16 v[118:119], v128 offset:1440
    ds_read_b128 v[88:91], v127
    ds_read_b64_tr_b16 v[120:121], v128 offset:1920
    ds_read_b64_tr_b16 v[122:123], v128 offset:2080
    v_mfma_f32_32x32x16_bf16 v[36:51], v[104:107], v[72:75], v[36:51]
    s_add_u32 s25, s25, 1
    s_mov_b32 s26, 20480
    s_cmp_eq_u32 s25, 5
    s_cmov_b32 s26, 0xfffe7000
    v_add_u32 v124, s26, v124
    v_add_u32 v125, s26, v125
    v_add_u32 v126, s26, v126
    v_add_u32 v127, s26, v127
    v_add_u32 v128, s26, v128
    s_cmp_lg_u32 s25, 3
    s_cbranch_scc1 L_parallel_sum__grouped_kv_mqa__mixer_gmlp__prompt_fe1_18
    s_waitcnt vmcnt(0)
L_parallel_sum__grouped_kv_mqa__mixer_gmlp__prompt_fe1_18:
    s_cmp_eq_u32 s25, 9
    s_waitcnt lgkmcnt(0)
    s_cbranch_scc1 L_parallel_sum__grouped_kv_mqa__mixer_gmlp__prompt_fnb_17
    s_barrier
L_parallel_sum__grouped_kv_mqa__mixer_gmlp__prompt_fnb_17:
    v_mfma_f32_32x32x16_bf16 v[36:51], v[108:111], v[76:79], v[36:51]
    ds_read_b128 v[60:63], v124
    ds_read_b64_tr_b16 v[92:93], v128 offset:0
    ds_read_b64_tr_b16 v[94:95], v128 offset:160
    ds_read_b128 v[64:67], v125
    v_mfma_f32_32x32x16_bf16 v[36:51], v[112:115], v[80:83], v[36:51]
    ds_read_b64_tr_b16 v[96:97], v128 offset:640
    ds_read_b64_tr_b16 v[98:99], v128 offset:800
    ds_read_b128 v[68:71], v126
    ds_read_b64_tr_b16 v[100:101], v128 offset:1280
    v_mfma_f32_32x32x16_bf16 v[36:51], v[116:119], v[84:87], v[36:51]
    ds_read_b64_tr_b16 v[102:103], v128 offset:1440
    ds_read_b128 v[72:75], v127
    ds_read_b64_tr_b16 v[104:105], v128 offset:1920
    ds_read_b64_tr_b16 v[106:107], v128 offset:2080
    v_mfma_f32_32x32x16_bf16 v[36:51], v[120:123], v[88:91], v[36:51]
    s_add_u32 s25, s25, 1
    s_cmp_lt_u32 s25, 10
    s_cbranch_scc1 L_parallel_sum__grouped_kv_mqa__mixer_gmlp__prompt_fl_16
    s_waitcnt lgkmcnt(0)
    s_barrier
    s_lshr_b32 s16, s3, 1
    s_lshl_b32 s16, s16, 9
    s_add_u32 s16, s16, 60160
    v_lshlrev_b32 v136, 4, v129
    v_lshl_add_u32 v136, v130, 3, v136
    v_add_u32_e64 v136, s16, v136
    ds_read_b64 v[52:53], v136
    s_and_b32 s16, s3, 1
    s_lshl_b32 s16, s16, 7
    s_add_u32 s16, s16, 54272
    v_lshl_add_u32 v136, v129, 2, s16
    ds_read_b32 v140, v136
    ds_read_b32 v141, v136 offset:256
    s_waitcnt lgkmcnt(2)
    v_add_f32 v54, v52, v53
    v_and_b32 v55, s24, v54
    v_sub_f32 v54, v54, v55
    v_cvt_pk_bf16_f32 v52, v55, v55
    v_cvt_pk_bf16_f32 v53, v54, 0
    s_waitcnt lgkmcnt(0)
    v_and_b32 v138, s24, v140
    v_sub_f32_e64 v139, v140, v138
    v_cvt_pk_bf16_f32 v142, -v138, -v139
    v_cvt_pk_bf16_f32 v143, -v138, 0
    s_nop 1
    v_mfma_f32_32x32x8_bf16 v[36:51], v[52:53], v[142:143], v[36:51]
    v_lshl_add_u32 v136, v1, 4, s19
    v_lshl_add_u32 v137, v129, 2, s19
    s_nop 7
    s_nop 1
    v_mul_f32 v36, v141, v36
    v_mul_f32 v37, v141, v37
    v_mul_f32 v38, v141, v38
    v_mul_f32 v39, v141, v39
    v_mul_f32 v40, v141, v40
    v_mul_f32 v41, v141, v41
    v_mul_f32 v42, v141, v42
    v_mul_f32 v43, v141, v43
    v_mul_f32 v44, v141, v44
    v_mul_f32 v45, v141, v45
    v_mul_f32 v46, v141, v46
    v_mul_f32_e64 v47, v141, v47
    v_cvt_pk_bf16_f32 v60, v36, v37
    v_cvt_pk_bf16_f32 v61, v38, v39
    v_cvt_pk_bf16_f32 v62, v40, v41
    v_cvt_pk_bf16_f32 v63, v42, v43
    v_cvt_pk_bf16_f32 v64, v44, v45
    v_cvt_pk_bf16_f32 v65, v46, v47
    v_permlane32_swap_b32 v60, v62
    v_permlane32_swap_b32 v61, v63
    ds_write_b128 v136, v[60:63] offset:0
    s_mov_b32 exec_hi, 0
    ds_write_b32 v137, v64 offset:1024
    ds_write_b32 v137, v65 offset:1152
    s_mov_b64 exec, -1
    s_branch L_parallel_sum__grouped_kv_mqa__mixer_gmlp__prompt_kj_10
L_parallel_sum__grouped_kv_mqa__mixer_gmlp__prompt_kvv_9:
    s_mov_b32 s25, 0
    s_barrier
    ds_read_b128 v[60:63], v124
    ds_read_b64_tr_b16 v[92:93], v128 offset:0
    ds_read_b64_tr_b16 v[94:95], v128 offset:160
    ds_read_b128 v[64:67], v125
    ds_read_b64_tr_b16 v[96:97], v128 offset:640
    ds_read_b64_tr_b16 v[98:99], v128 offset:800
    ds_read_b128 v[68:71], v126
    ds_read_b64_tr_b16 v[100:101], v128 offset:1280
    ds_read_b64_tr_b16 v[102:103], v128 offset:1440
    ds_read_b128 v[72:75], v127
    ds_read_b64_tr_b16 v[104:105], v128 offset:1920
    ds_read_b64_tr_b16 v[106:107], v128 offset:2080
L_parallel_sum__grouped_kv_mqa__mixer_gmlp__prompt_fl_21:
    s_mov_b32 s26, 20480
    s_cmp_eq_u32 s25, 5
    s_cmov_b32 s26, 0xfffe7000
    v_add_u32 v124, s26, v124
    v_add_u32 v125, s26, v125
    v_add_u32 v126, s26, v126
    v_add_u32 v127, s26, v127
    v_add_u32 v128, s26, v128
    s_waitcnt lgkmcnt(0)
    v_mfma_f32_32x32x16_bf16 v[36:51], v[60:63], v[92:95], v[36:51]
    ds_read_b128 v[76:79], v124
    ds_read_b64_tr_b16 v[108:109], v128 offset:0
    ds_read_b64_tr_b16 v[110:111], v128 offset:160
    ds_read_b128 v[80:83], v125
    v_mfma_f32_32x32x16_bf16 v[36:51], v[64:67], v[96:99], v[36:51]
    ds_read_b64_tr_b16 v[112:113], v128 offset:640
    ds_read_b64_tr_b16 v[114:115], v128 offset:800
    ds_read_b128 v[84:87], v126
    ds_read_b64_tr_b16 v[116:117], v128 offset:1280
    v_mfma_f32_32x32x16_bf16 v[36:51], v[68:71], v[100:103], v[36:51]
    ds_read_b64_tr_b16 v[118:119], v128 offset:1440
    ds_read_b128 v[88:91], v127
    ds_read_b64_tr_b16 v[120:121], v128 offset:1920
    ds_read_b64_tr_b16 v[122:123], v128 offset:2080
    v_mfma_f32_32x32x16_bf16 v[36:51], v[72:75], v[104:107], v[36:51]
    s_add_u32 s25, s25, 1
    s_mov_b32 s26, 20480
    s_cmp_eq_u32 s25, 5
    s_cmov_b32 s26, 0xfffe7000
    v_add_u32 v124, s26, v124
    v_add_u32 v125, s26, v125
    v_add_u32 v126, s26, v126
    v_add_u32 v127, s26, v127
    v_add_u32 v128, s26, v128
    s_cmp_lg_u32 s25, 3
    s_cbranch_scc1 L_parallel_sum__grouped_kv_mqa__mixer_gmlp__prompt_fe1_23
    s_waitcnt vmcnt(0)
L_parallel_sum__grouped_kv_mqa__mixer_gmlp__prompt_fe1_23:
    s_cmp_eq_u32 s25, 9
    s_waitcnt lgkmcnt(0)
    s_cbranch_scc1 L_parallel_sum__grouped_kv_mqa__mixer_gmlp__prompt_fnb_22
    s_barrier
L_parallel_sum__grouped_kv_mqa__mixer_gmlp__prompt_fnb_22:
    v_mfma_f32_32x32x16_bf16 v[36:51], v[76:79], v[108:111], v[36:51]
    ds_read_b128 v[60:63], v124
    ds_read_b64_tr_b16 v[92:93], v128 offset:0
    ds_read_b64_tr_b16 v[94:95], v128 offset:160
    ds_read_b128 v[64:67], v125
    v_mfma_f32_32x32x16_bf16 v[36:51], v[80:83], v[112:115], v[36:51]
    ds_read_b64_tr_b16 v[96:97], v128 offset:640
    ds_read_b64_tr_b16 v[98:99], v128 offset:800
    ds_read_b128 v[68:71], v126
    ds_read_b64_tr_b16 v[100:101], v128 offset:1280
    v_mfma_f32_32x32x16_bf16 v[36:51], v[84:87], v[116:119], v[36:51]
    ds_read_b64_tr_b16 v[102:103], v128 offset:1440
    ds_read_b128 v[72:75], v127
    ds_read_b64_tr_b16 v[104:105], v128 offset:1920
    ds_read_b64_tr_b16 v[106:107], v128 offset:2080
    v_mfma_f32_32x32x16_bf16 v[36:51], v[88:91], v[120:123], v[36:51]
    s_add_u32 s25, s25, 1
    s_cmp_lt_u32 s25, 10
    s_cbranch_scc1 L_parallel_sum__grouped_kv_mqa__mixer_gmlp__prompt_fl_21
    s_waitcnt lgkmcnt(0)
    s_barrier
    s_lshr_b32 s16, s3, 1
    s_lshl_b32 s16, s16, 9
    s_add_u32 s16, s16, 60160
    v_lshlrev_b32 v136, 4, v129
    v_lshl_add_u32 v136, v130, 3, v136
    v_add_u32_e64 v136, s16, v136
    ds_read_b64 v[52:53], v136
    s_and_b32 s16, s3, 1
    s_lshl_b32 s16, s16, 7
    s_add_u32 s16, s16, 54272
    v_lshl_add_u32 v136, v129, 2, s16
    ds_read_b32 v140, v136
    ds_read_b32 v141, v136 offset:256
    s_waitcnt lgkmcnt(2)
    v_add_f32 v54, v52, v53
    v_and_b32 v55, s24, v54
    v_sub_f32 v54, v54, v55
    v_cvt_pk_bf16_f32 v52, v55, v55
    v_cvt_pk_bf16_f32 v53, v54, 0
    s_waitcnt lgkmcnt(0)
    v_and_b32 v138, s24, v140
    v_sub_f32_e64 v139, v140, v138
    v_cvt_pk_bf16_f32 v142, -v138, -v139
    v_cvt_pk_bf16_f32 v143, -v138, 0
    s_nop 1
    v_mfma_f32_32x32x8_bf16 v[36:51], v[142:143], v[52:53], v[36:51]
    v_lshl_add_u32 v136, v130, 4, s16
    ds_read_b128 v[92:95], v136 offset:256
    ds_read_b128 v[96:99], v136 offset:288
    ds_read_b128 v[100:103], v136 offset:320
    ds_read_b128 v[104:107], v136 offset:352
    v_mul_u32_u24 v137, 336, v130
    v_lshl_add_u32 v137, v129, 4, v137
    v_add_u32 v137, s19, v137
    v_cmp_eq_u32 vcc, 20, v129
    s_nop 3
    s_waitcnt lgkmcnt(0)
    v_mul_f32 v36, v92, v36
    v_mul_f32 v37, v93, v37
    v_mul_f32 v38, v94, v38
    v_mul_f32 v39, v95, v39
    v_mul_f32 v40, v96, v40
    v_mul_f32 v41, v97, v41
    v_mul_f32 v42, v98, v42
    v_mul_f32 v43, v99, v43
    v_mul_f32 v44, v100, v44
    v_mul_f32 v45, v101, v45
    v_mul_f32 v46, v102, v46
    v_mul_f32 v47, v103, v47
    v_mul_f32 v48, v104, v48
    v_mul_f32 v49, v105, v49
    v_mul_f32 v50, v106, v50
    v_mul_f32_e64 v51, v107, v51
    v_cvt_pk_bf16_f32 v60, v36, v37
    v_cvt_pk_bf16_f32 v61, v38, v39
    v_cvt_pk_bf16_f32 v62, v40, v41
    v_cvt_pk_bf16_f32 v63, v42, v43
    v_cvt_pk_bf16_f32 v64, v44, v45
    v_cvt_pk_bf16_f32 v65, v46, v47
    v_cvt_pk_bf16_f32 v66, v48, v49
    v_cvt_pk_bf16_f32 v67, v50, v51
    v_cndmask_b32 v60, v60, v132, vcc
    v_cndmask_b32 v61, v61, v132, vcc
    v_cndmask_b32 v62, v62, v132, vcc
    v_cndmask_b32 v63, v63, v132, vcc
    v_cndmask_b32 v64, v64, v132, vcc
    v_cndmask_b32 v65, v65, v132, vcc
    v_cndmask_b32 v66, v66, v132, vcc
    v_cndmask_b32 v67, v67, v132, vcc
    s_mov_b32 exec_lo, 0x1fffff
    s_mov_b32 exec_hi, 0x1fffff
    ds_write_b128 v137, v[60:63] offset:1280
    ds_write_b128 v137, v[64:67] offset:1952
    s_mov_b64 exec, -1
    s_branch L_parallel_sum__grouped_kv_mqa__mixer_gmlp__prompt_kj_10
L_parallel_sum__grouped_kv_mqa__mixer_gmlp__prompt_ki_8:
    s_mov_b32 s25, 0
    s_barrier
L_parallel_sum__grouped_kv_mqa__mixer_gmlp__prompt_fl_26:
    s_waitcnt lgkmcnt(0)
    s_add_u32 s25, s25, 1
    s_cmp_lg_u32 s25, 3
    s_cbranch_scc1 L_parallel_sum__grouped_kv_mqa__mixer_gmlp__prompt_fe1_28
    s_waitcnt vmcnt(0)
L_parallel_sum__grouped_kv_mqa__mixer_gmlp__prompt_fe1_28:
    s_cmp_eq_u32 s25, 9
    s_waitcnt lgkmcnt(0)
    s_cbranch_scc1 L_parallel_sum__grouped_kv_mqa__mixer_gmlp__prompt_fnb_27
    s_barrier
L_parallel_sum__grouped_kv_mqa__mixer_gmlp__prompt_fnb_27:
    s_add_u32 s25, s25, 1
    s_cmp_lt_u32 s25, 10
    s_cbranch_scc1 L_parallel_sum__grouped_kv_mqa__mixer_gmlp__prompt_fl_26
    s_waitcnt lgkmcnt(0)
    s_barrier
    s_branch L_parallel_sum__grouped_kv_mqa__mixer_gmlp__prompt_kj_10
L_parallel_sum__grouped_kv_mqa__mixer_gmlp__prompt_kx_7:
    s_mov_b32 s25, 0
    s_barrier
    ds_read_b64_tr_b16 v[60:61], v128 offset:0
    ds_read_b64_tr_b16 v[62:63], v128 offset:160
    ds_read_b64_tr_b16 v[64:65], v128 offset:640
    ds_read_b64_tr_b16 v[66:67], v128 offset:800
    ds_read_b64_tr_b16 v[68:69], v128 offset:4096
    ds_read_b64_tr_b16 v[70:71], v128 offset:4256
    ds_read_b64_tr_b16 v[72:73], v128 offset:4736
    ds_read_b64_tr_b16 v[74:75], v128 offset:4896
L_parallel_sum__grouped_kv_mqa__mixer_gmlp__prompt_fl_31:
    s_mov_b32 s26, 20480
    s_cmp_eq_u32 s25, 5
    s_cmov_b32 s26, 0xfffe7000
    v_add_u32 v128, s26, v128
    s_waitcnt lgkmcnt(0)
    ds_read_b64_tr_b16 v[92:93], v128 offset:0
    ds_read_b64_tr_b16 v[94:95], v128 offset:160
    ds_read_b64_tr_b16 v[96:97], v128 offset:640
    ds_read_b64_tr_b16 v[98:99], v128 offset:800
    ds_read_b64_tr_b16 v[100:101], v128 offset:4096
    ds_read_b64_tr_b16 v[102:103], v128 offset:4256
    ds_read_b64_tr_b16 v[104:105], v128 offset:4736
    ds_read_b64_tr_b16 v[106:107], v128 offset:4896
    v_mfma_f32_4x4x4_16b_bf16 v[36:39], v[132:133], v[60:61], v[36:39]
    v_mfma_f32_4x4x4_16b_bf16 v[40:43], v[132:133], v[68:69], v[40:43]
    s_nop 0
    v_mfma_f32_4x4x4_16b_bf16 v[36:39], v[132:133], v[62:63], v[36:39]
    v_mfma_f32_4x4x4_16b_bf16 v[40:43], v[132:133], v[70:71], v[40:43]
    s_nop 0
    v_mfma_f32_4x4x4_16b_bf16 v[36:39], v[132:133], v[64:65], v[36:39]
    v_mfma_f32_4x4x4_16b_bf16 v[40:43], v[132:133], v[72:73], v[40:43]
    s_nop 0
    v_mfma_f32_4x4x4_16b_bf16 v[36:39], v[132:133], v[66:67], v[36:39]
    v_mfma_f32_4x4x4_16b_bf16 v[40:43], v[132:133], v[74:75], v[40:43]
    s_nop 0
    s_add_u32 s25, s25, 1
    s_mov_b32 s26, 20480
    s_cmp_eq_u32 s25, 5
    s_cmov_b32 s26, 0xfffe7000
    v_add_u32 v128, s26, v128
    s_cmp_lg_u32 s25, 3
    s_cbranch_scc1 L_parallel_sum__grouped_kv_mqa__mixer_gmlp__prompt_fe1_33
    s_waitcnt vmcnt(0)
L_parallel_sum__grouped_kv_mqa__mixer_gmlp__prompt_fe1_33:
    s_cmp_eq_u32 s25, 9
    s_waitcnt lgkmcnt(0)
    s_cbranch_scc1 L_parallel_sum__grouped_kv_mqa__mixer_gmlp__prompt_fnb_32
    s_barrier
L_parallel_sum__grouped_kv_mqa__mixer_gmlp__prompt_fnb_32:
    s_cmp_lg_u32 s25, 3
    s_cbranch_scc1 L_parallel_sum__grouped_kv_mqa__mixer_gmlp__prompt_fe2_34
    s_cmp_lg_u32 s3, 7
    s_cbranch_scc1 L_parallel_sum__grouped_kv_mqa__mixer_gmlp__prompt_fe2_34
    s_lshl_b32 s16, s5, 7
    v_mov_b32 v142, s96
    v_mov_b32 v143, s97
    v_lshlrev_b32 v140, 3, v1
    s_mov_b64 exec, 0xffff
    buffer_store_dwordx2 v[142:143], v140, s[72:75], s16 offen sc1
    s_mov_b64 exec, -1
L_parallel_sum__grouped_kv_mqa__mixer_gmlp__prompt_fe2_34:
    ds_read_b64_tr_b16 v[60:61], v128 offset:0
    ds_read_b64_tr_b16 v[62:63], v128 offset:160
    ds_read_b64_tr_b16 v[64:65], v128 offset:640
    ds_read_b64_tr_b16 v[66:67], v128 offset:800
    ds_read_b64_tr_b16 v[68:69], v128 offset:4096
    ds_read_b64_tr_b16 v[70:71], v128 offset:4256
    ds_read_b64_tr_b16 v[72:73], v128 offset:4736
    ds_read_b64_tr_b16 v[74:75], v128 offset:4896
    v_mfma_f32_4x4x4_16b_bf16 v[36:39], v[132:133], v[92:93], v[36:39]
    v_mfma_f32_4x4x4_16b_bf16 v[40:43], v[132:133], v[100:101], v[40:43]
    s_nop 0
    v_mfma_f32_4x4x4_16b_bf16 v[36:39], v[132:133], v[94:95], v[36:39]
    v_mfma_f32_4x4x4_16b_bf16 v[40:43], v[132:133], v[102:103], v[40:43]
    s_nop 0
    v_mfma_f32_4x4x4_16b_bf16 v[36:39], v[132:133], v[96:97], v[36:39]
    v_mfma_f32_4x4x4_16b_bf16 v[40:43], v[132:133], v[104:105], v[40:43]
    s_nop 0
    v_mfma_f32_4x4x4_16b_bf16 v[36:39], v[132:133], v[98:99], v[36:39]
    v_mfma_f32_4x4x4_16b_bf16 v[40:43], v[132:133], v[106:107], v[40:43]
    s_nop 0
    s_add_u32 s25, s25, 1
    s_cmp_lt_u32 s25, 10
    s_cbranch_scc1 L_parallel_sum__grouped_kv_mqa__mixer_gmlp__prompt_fl_31
    s_waitcnt lgkmcnt(0)
    s_and_b32 s16, s3, 1
    s_lshl_b32 s16, s16, 2
    s_add_u32 s16, s16, 60160
    v_lshlrev_b32 v136, 4, v129
    v_lshl_add_u32 v136, v130, 3, v136
    v_add_u32_e64 v136, s16, v136
    ds_write_b32 v136, v36 offset:0
    ds_write_b32 v136, v40 offset:512
    s_waitcnt lgkmcnt(0)
    s_barrier
    s_barrier
    s_add_u32 s28, s68, 0x00940000
    s_addc_u32 s29, s69, 0
    s_mov_b32 s30, 0x0002a000
    s_mov_b32 s31, 0x00020000
    v_lshlrev_b32 v137, 4, v1
    v_add_u32 v136, s19, v137
    ds_read_b128 v[60:63], v136 offset:0
    ds_read_b128 v[64:67], v136 offset:1024
    ds_read_b128 v[68:71], v136 offset:2048
    s_lshl_b32 s16, s98, 1
    s_and_b32 s17, s3, 1
    s_add_u32 s16, s16, s17
    s_mul_i32 s17, s16, 2688
    s_waitcnt lgkmcnt(0)
    buffer_store_dwordx4 v[60:63], v137, s[28:31], s17 offen sc1
    buffer_store_dwordx4 v[64:67], v137, s[28:31], s17 offen offset:1024 sc1
    s_mov_b32 exec_hi, 0xff
    buffer_store_dwordx4 v[68:71], v137, s[28:31], s17 offen offset:2048 sc1
    s_mov_b64 exec, -1
    s_lshl_b32 s16, s16, 7
    s_add_u32 s16, s16, 131072
    s_waitcnt vmcnt(0)
    v_mov_b32 v142, s96
    v_mov_b32 v143, s97
    v_lshlrev_b32 v140, 3, v1
    s_mov_b64 exec, 0xffff
    buffer_store_dwordx2 v[142:143], v140, s[72:75], s16 offen sc1
    s_mov_b64 exec, -1
    s_barrier
    s_and_b32 s17, s3, 1
    s_mul_i32 s17, s17, 6144
    v_bfe_u32 v136, v129, 1, 3
    v_xor_b32 v136, v136, v130
    s_and_b32 s16, s3, 1
    s_lshl_b32 s16, s16, 12
    s_add_u32 s16, s16, 20992
    v_lshl_add_u32 v137, v129, 7, s16
    v_xor_b32_e64 v138, 0, v136
    v_lshl_add_u32 v124, v138, 4, v137
    v_xor_b32_e64 v138, 2, v136
    v_lshl_add_u32 v125, v138, 4, v137
    v_xor_b32_e64 v138, 4, v136
    v_lshl_add_u32 v126, v138, 4, v137
    v_xor_b32_e64 v138, 6, v136
    v_lshl_add_u32 v127, v138, 4, v137
    v_bfe_u32 v136, v1, 2, 2
    v_lshl_add_u32 v136, v130, 3, v136
    v_mul_u32_u24 v136, 192, v136
    v_bfe_u32 v137, v1, 4, 1
    v_lshl_add_u32 v136, v137, 5, v136
    v_and_b32_e64 v137, 3, v1
    v_lshl_add_u32 v136, v137, 3, v136
    s_add_u32 s16, s17, 29184
    v_add_u32 v128, s16, v136
    s_and_b32 s16, s99, 1
    s_lshl_b32 s16, s16, 5
    v_add_u32 v128, s16, v128
    v_mov_b32 v36, 0
    v_mov_b32 v37, 0
    v_mov_b32 v38, 0
    v_mov_b32 v39, 0
    v_mov_b32 v40, 0
    v_mov_b32 v41, 0
    v_mov_b32 v42, 0
    v_mov_b32 v43, 0
    v_mov_b32 v44, 0
    v_mov_b32 v45, 0
    v_mov_b32 v46, 0
    v_mov_b32 v47, 0
    v_mov_b32 v48, 0
    v_mov_b32 v49, 0
    v_mov_b32 v50, 0
    v_mov_b32 v51, 0
    v_mov_b32 v52, 0
    v_mov_b32 v53, 0
    v_mov_b32 v54, 0
    v_mov_b32 v55, 0
    v_mov_b32 v56, 0
    v_mov_b32 v57, 0
    v_mov_b32 v58, 0
    v_mov_b32 v59, 0
    s_mov_b32 s25, 0
    s_barrier
    ds_read_b64_tr_b16 v[60:61], v128 offset:0
    ds_read_b64_tr_b16 v[62:63], v128 offset:768
    ds_read_b64_tr_b16 v[64:65], v128 offset:3072
    ds_read_b64_tr_b16 v[66:67], v128 offset:3840
    ds_read_b64_tr_b16 v[68:69], v128 offset:64
    ds_read_b64_tr_b16 v[70:71], v128 offset:832
    ds_read_b64_tr_b16 v[72:73], v128 offset:3136
    ds_read_b64_tr_b16 v[74:75], v128 offset:3904
    ds_read_b64_tr_b16 v[76:77], v128 offset:128
    ds_read_b64_tr_b16 v[78:79], v128 offset:896
    ds_read_b64_tr_b16 v[80:81], v128 offset:3200
    ds_read_b64_tr_b16 v[82:83], v128 offset:3968
L_parallel_sum__grouped_kv_mqa__mixer_gmlp__prompt_fl_36:
    s_mov_b32 s26, 20480
    s_cmp_eq_u32 s25, 5
    s_cmov_b32 s26, 0xfffe7000
    v_add_u32 v128, s26, v128
    s_waitcnt lgkmcnt(0)
    ds_read_b64_tr_b16 v[92:93], v128 offset:0
    ds_read_b64_tr_b16 v[94:95], v128 offset:768
    ds_read_b64_tr_b16 v[96:97], v128 offset:3072
    ds_read_b64_tr_b16 v[98:99], v128 offset:3840
    ds_read_b64_tr_b16 v[100:101], v128 offset:64
    ds_read_b64_tr_b16 v[102:103], v128 offset:832
    ds_read_b64_tr_b16 v[104:105], v128 offset:3136
    ds_read_b64_tr_b16 v[106:107], v128 offset:3904
    ds_read_b64_tr_b16 v[108:109], v128 offset:128
    ds_read_b64_tr_b16 v[110:111], v128 offset:896
    ds_read_b64_tr_b16 v[112:113], v128 offset:3200
    ds_read_b64_tr_b16 v[114:115], v128 offset:3968
    v_mfma_f32_4x4x4_16b_bf16 v[36:39], v[132:133], v[60:61], v[36:39]
    v_mfma_f32_4x4x4_16b_bf16 v[40:43], v[132:133], v[68:69], v[40:43]
    v_mfma_f32_4x4x4_16b_bf16 v[44:47], v[132:133], v[76:77], v[44:47]
    v_mfma_f32_4x4x4_16b_bf16 v[36:39], v[132:133], v[62:63], v[36:39]
    v_mfma_f32_4x4x4_16b_bf16 v[40:43], v[132:133], v[70:71], v[40:43]
    v_mfma_f32_4x4x4_16b_bf16 v[44:47], v[132:133], v[78:79], v[44:47]
    v_mfma_f32_4x4x4_16b_bf16 v[36:39], v[132:133], v[64:65], v[36:39]
    v_mfma_f32_4x4x4_16b_bf16 v[40:43], v[132:133], v[72:73], v[40:43]
    v_mfma_f32_4x4x4_16b_bf16 v[44:47], v[132:133], v[80:81], v[44:47]
    v_mfma_f32_4x4x4_16b_bf16 v[36:39], v[132:133], v[66:67], v[36:39]
    v_mfma_f32_4x4x4_16b_bf16 v[40:43], v[132:133], v[74:75], v[40:43]
    v_mfma_f32_4x4x4_16b_bf16 v[44:47], v[132:133], v[82:83], v[44:47]
    s_add_u32 s25, s25, 1
    s_mov_b32 s26, 20480
    s_cmp_eq_u32 s25, 5
    s_cmov_b32 s26, 0xfffe7000
    v_add_u32 v128, s26, v128
    s_cmp_eq_u32 s25, 9
    s_waitcnt lgkmcnt(0)
    s_cbranch_scc1 L_parallel_sum__grouped_kv_mqa__mixer_gmlp__prompt_fnb_37
    s_barrier
L_parallel_sum__grouped_kv_mqa__mixer_gmlp__prompt_fnb_37:
    ds_read_b64_tr_b16 v[60:61], v128 offset:0
    ds_read_b64_tr_b16 v[62:63], v128 offset:768
    ds_read_b64_tr_b16 v[64:65], v128 offset:3072
    ds_read_b64_tr_b16 v[66:67], v128 offset:3840
    ds_read_b64_tr_b16 v[68:69], v128 offset:64
    ds_read_b64_tr_b16 v[70:71], v128 offset:832
    ds_read_b64_tr_b16 v[72:73], v128 offset:3136
    ds_read_b64_tr_b16 v[74:75], v128 offset:3904
    ds_read_b64_tr_b16 v[76:77], v128 offset:128
    ds_read_b64_tr_b16 v[78:79], v128 offset:896
    ds_read_b64_tr_b16 v[80:81], v128 offset:3200
    ds_read_b64_tr_b16 v[82:83], v128 offset:3968
    v_mfma_f32_4x4x4_16b_bf16 v[36:39], v[132:133], v[92:93], v[36:39]
    v_mfma_f32_4x4x4_16b_bf16 v[40:43], v[132:133], v[100:101], v[40:43]
    v_mfma_f32_4x4x4_16b_bf16 v[44:47], v[132:133], v[108:109], v[44:47]
    v_mfma_f32_4x4x4_16b_bf16 v[36:39], v[132:133], v[94:95], v[36:39]
    v_mfma_f32_4x4x4_16b_bf16 v[40:43], v[132:133], v[102:103], v[40:43]
    v_mfma_f32_4x4x4_16b_bf16 v[44:47], v[132:133], v[110:111], v[44:47]
    v_mfma_f32_4x4x4_16b_bf16 v[36:39], v[132:133], v[96:97], v[36:39]
    v_mfma_f32_4x4x4_16b_bf16 v[40:43], v[132:133], v[104:105], v[40:43]
    v_mfma_f32_4x4x4_16b_bf16 v[44:47], v[132:133], v[112:113], v[44:47]
    v_mfma_f32_4x4x4_16b_bf16 v[36:39], v[132:133], v[98:99], v[36:39]
    v_mfma_f32_4x4x4_16b_bf16 v[40:43], v[132:133], v[106:107], v[40:43]
    v_mfma_f32_4x4x4_16b_bf16 v[44:47], v[132:133], v[114:115], v[44:47]
    s_cmp_lg_u32 s25, 7
    s_cbranch_scc1 L_parallel_sum__grouped_kv_mqa__mixer_gmlp__prompt_fe3_40
    s_mov_b32 s16, 131072
    s_mov_b64 exec, 0xff
    buffer_load_dwordx2 v[148:149], v150, s[72:75], s16 offen sc1
    s_mov_b64 exec, -1
L_parallel_sum__grouped_kv_mqa__mixer_gmlp__prompt_fe3_40:
    s_add_u32 s25, s25, 1
    s_cmp_lt_u32 s25, 10
    s_cbranch_scc1 L_parallel_sum__grouped_kv_mqa__mixer_gmlp__prompt_fl_36
    s_waitcnt lgkmcnt(0)
    s_branch L_parallel_sum__grouped_kv_mqa__mixer_gmlp__prompt_q2x_15
L_parallel_sum__grouped_kv_mqa__mixer_gmlp__prompt_kj_10:
    s_waitcnt lgkmcnt(0)
    s_barrier
    s_barrier
    s_lshr_b32 s17, s3, 1
    s_lshl_b32 s17, s17, 6
    v_bfe_u32 v136, v129, 1, 3
    v_xor_b32 v136, v136, v130
    s_and_b32 s16, s3, 1
    s_lshl_b32 s16, s16, 12
    s_add_u32 s16, s16, 20992
    v_lshl_add_u32 v137, v129, 7, s16
    v_xor_b32_e64 v138, 0, v136
    v_lshl_add_u32 v124, v138, 4, v137
    v_xor_b32_e64 v138, 2, v136
    v_lshl_add_u32 v125, v138, 4, v137
    v_xor_b32_e64 v138, 4, v136
    v_lshl_add_u32 v126, v138, 4, v137
    v_xor_b32_e64 v138, 6, v136
    v_lshl_add_u32 v127, v138, 4, v137
    v_bfe_u32 v136, v1, 2, 2
    v_lshl_add_u32 v136, v130, 3, v136
    v_mul_u32_u24 v136, 192, v136
    v_bfe_u32 v137, v1, 4, 1
    v_lshl_add_u32 v136, v137, 5, v136
    v_and_b32_e64 v137, 3, v1
    v_lshl_add_u32 v136, v137, 3, v136
    s_add_u32 s16, s17, 29184
    v_add_u32 v128, s16, v136
    s_and_b32 s16, s99, 1
    s_lshl_b32 s16, s16, 5
    v_add_u32 v128, s16, v128
    v_mov_b32 v36, 0
    v_mov_b32 v37, 0
    v_mov_b32 v38, 0
    v_mov_b32 v39, 0
    v_mov_b32 v40, 0
    v_mov_b32 v41, 0
    v_mov_b32 v42, 0
    v_mov_b32 v43, 0
    v_mov_b32 v44, 0
    v_mov_b32 v45, 0
    v_mov_b32 v46, 0
    v_mov_b32 v47, 0
    v_mov_b32 v48, 0
    v_mov_b32 v49, 0
    v_mov_b32 v50, 0
    v_mov_b32 v51, 0
    v_mov_b32 v52, 0
    v_mov_b32 v53, 0
    v_mov_b32 v54, 0
    v_mov_b32 v55, 0
    v_mov_b32 v56, 0
    v_mov_b32 v57, 0
    v_mov_b32 v58, 0
    v_mov_b32 v59, 0
    s_mov_b32 s25, 0
    s_barrier
    ds_read_b128 v[60:63], v124
    ds_read_b64_tr_b16 v[92:93], v128 offset:0
    ds_read_b64_tr_b16 v[94:95], v128 offset:768
    ds_read_b128 v[64:67], v125
    ds_read_b64_tr_b16 v[96:97], v128 offset:3072
    ds_read_b64_tr_b16 v[98:99], v128 offset:3840
    ds_read_b128 v[68:71], v126
    ds_read_b64_tr_b16 v[100:101], v128 offset:6144
    ds_read_b64_tr_b16 v[102:103], v128 offset:6912
    ds_read_b128 v[72:75], v127
    ds_read_b64_tr_b16 v[104:105], v128 offset:9216
    ds_read_b64_tr_b16 v[106:107], v128 offset:9984
L_parallel_sum__grouped_kv_mqa__mixer_gmlp__prompt_fl_41:
    s_mov_b32 s26, 20480
    s_cmp_eq_u32 s25, 5
    s_cmov_b32 s26, 0xfffe7000
    v_add_u32 v124, s26, v124
    v_add_u32 v125, s26, v125
    v_add_u32 v126, s26, v126
    v_add_u32_e64 v127, s26, v127
    v_add_u32 v128, s26, v128
    s_waitcnt lgkmcnt(0)
    v_mfma_f32_32x32x16_bf16 v[36:51], v[92:95], v[60:63], v[36:51]
    ds_read_b128 v[76:79], v124
    ds_read_b64_tr_b16 v[108:109], v128 offset:0
    ds_read_b64_tr_b16 v[110:111], v128 offset:768
    ds_read_b128 v[80:83], v125
    v_mfma_f32_32x32x16_bf16 v[36:51], v[96:99], v[64:67], v[36:51]
    ds_read_b64_tr_b16 v[112:113], v128 offset:3072
    ds_read_b64_tr_b16 v[114:115], v128 offset:3840
    ds_read_b128 v[84:87], v126
    ds_read_b64_tr_b16 v[116:117], v128 offset:6144
    v_mfma_f32_32x32x16_bf16 v[36:51], v[100:103], v[68:71], v[36:51]
    ds_read_b64_tr_b16 v[118:119], v128 offset:6912
    ds_read_b128 v[88:91], v127
    ds_read_b64_tr_b16 v[120:121], v128 offset:9216
    ds_read_b64_tr_b16 v[122:123], v128 offset:9984
    v_mfma_f32_32x32x16_bf16 v[36:51], v[104:107], v[72:75], v[36:51]
    s_add_u32 s25, s25, 1
    s_mov_b32 s26, 20480
    s_cmp_eq_u32 s25, 5
    s_cmov_b32 s26, 0xfffe7000
    v_add_u32 v124, s26, v124
    v_add_u32 v125, s26, v125
    v_add_u32 v126, s26, v126
    v_add_u32 v127, s26, v127
    v_add_u32_e64 v128, s26, v128
    s_cmp_eq_u32 s25, 9
    s_waitcnt lgkmcnt(0)
    s_cbranch_scc1 L_parallel_sum__grouped_kv_mqa__mixer_gmlp__prompt_fnb_42
    s_barrier
L_parallel_sum__grouped_kv_mqa__mixer_gmlp__prompt_fnb_42:
    v_mfma_f32_32x32x16_bf16 v[36:51], v[108:111], v[76:79], v[36:51]
    ds_read_b128 v[60:63], v124
    ds_read_b64_tr_b16 v[92:93], v128 offset:0
    ds_read_b64_tr_b16 v[94:95], v128 offset:768
    ds_read_b128 v[64:67], v125
    v_mfma_f32_32x32x16_bf16 v[36:51], v[112:115], v[80:83], v[36:51]
    ds_read_b64_tr_b16 v[96:97], v128 offset:3072
    ds_read_b64_tr_b16 v[98:99], v128 offset:3840
    ds_read_b128 v[68:71], v126
    ds_read_b64_tr_b16 v[100:101], v128 offset:6144
    v_mfma_f32_32x32x16_bf16 v[36:51], v[116:119], v[84:87], v[36:51]
    ds_read_b64_tr_b16 v[102:103], v128 offset:6912
    ds_read_b128 v[72:75], v127
    ds_read_b64_tr_b16 v[104:105], v128 offset:9216
    ds_read_b64_tr_b16 v[106:107], v128 offset:9984
    v_mfma_f32_32x32x16_bf16 v[36:51], v[120:123], v[88:91], v[36:51]
    s_cmp_lg_u32 s25, 7
    s_cbranch_scc1 L_parallel_sum__grouped_kv_mqa__mixer_gmlp__prompt_fe3_45
    s_mov_b32 s16, 131072
    s_mov_b64 exec, 0xff
    buffer_load_dwordx2 v[148:149], v150, s[72:75], s16 offen sc1
    s_mov_b64 exec, -1
L_parallel_sum__grouped_kv_mqa__mixer_gmlp__prompt_fe3_45:
    s_add_u32 s25, s25, 1
    s_cmp_lt_u32 s25, 10
    s_cbranch_scc1 L_parallel_sum__grouped_kv_mqa__mixer_gmlp__prompt_fl_41
    s_waitcnt lgkmcnt(0)
    s_branch L_parallel_sum__grouped_kv_mqa__mixer_gmlp__prompt_qe_13
L_parallel_sum__grouped_kv_mqa__mixer_gmlp__prompt_q1_11:
    s_lshr_b32 s17, s3, 1
    s_lshl_b32 s17, s17, 6
    s_and_b32 s18, s3, 1
    s_mul_i32 s18, s18, 6144
    s_cmp_ge_u32 s3, 6
    s_cselect_b32 s17, s18, s17
    v_bfe_u32 v136, v129, 1, 3
    v_xor_b32 v136, v136, v130
    s_and_b32 s16, s3, 1
    s_lshl_b32 s16, s16, 12
    s_add_u32 s16, s16, 20992
    v_lshl_add_u32 v137, v129, 7, s16
    v_xor_b32_e64 v138, 0, v136
    v_lshl_add_u32 v124, v138, 4, v137
    v_xor_b32_e64 v138, 2, v136
    v_lshl_add_u32 v125, v138, 4, v137
    v_xor_b32_e64 v138, 4, v136
    v_lshl_add_u32 v126, v138, 4, v137
    v_xor_b32_e64 v138, 6, v136
    v_lshl_add_u32 v127, v138, 4, v137
    v_bfe_u32 v136, v1, 2, 2
    v_lshl_add_u32 v136, v130, 3, v136
    v_mul_u32_u24 v136, 192, v136
    v_bfe_u32 v137, v1, 4, 1
    v_lshl_add_u32 v136, v137, 5, v136
    v_and_b32_e64 v137, 3, v1
    v_lshl_add_u32 v136, v137, 3, v136
    s_add_u32 s16, s17, 29184
    v_add_u32 v128, s16, v136
    s_and_b32 s16, s99, 1
    s_lshl_b32 s16, s16, 5
    v_add_u32 v128, s16, v128
    v_mov_b32 v36, 0
    v_mov_b32 v37, 0
    v_mov_b32 v38, 0
    v_mov_b32 v39, 0
    v_mov_b32 v40, 0
    v_mov_b32 v41, 0
    v_mov_b32 v42, 0
    v_mov_b32 v43, 0
    v_mov_b32 v44, 0
    v_mov_b32 v45, 0
    v_mov_b32 v46, 0
    v_mov_b32 v47, 0
    v_mov_b32 v48, 0
    v_mov_b32 v49, 0
    v_mov_b32 v50, 0
    v_mov_b32 v51, 0
    v_mov_b32 v52, 0
    v_mov_b32 v53, 0
    v_mov_b32 v54, 0
    v_mov_b32 v55, 0
    v_mov_b32 v56, 0
    v_mov_b32 v57, 0
    v_mov_b32 v58, 0
    v_mov_b32 v59, 0
    s_waitcnt vmcnt(3)
    v_lshlrev_b32 v12, 16, v4
    v_and_b32 v13, s24, v4
    v_lshlrev_b32 v14, 16, v5
    v_and_b32 v15, s24, v5
    v_lshlrev_b32 v16, 16, v6
    v_and_b32 v17, s24, v6
    v_lshlrev_b32 v18, 16, v7
    v_and_b32 v19, s24, v7
    v_lshlrev_b32 v20, 16, v8
    v_and_b32 v21, s24, v8
    v_lshlrev_b32 v22, 16, v9
    v_and_b32 v23, s24, v9
    v_lshlrev_b32 v24, 16, v10
    v_and_b32 v25, s24, v10
    v_lshlrev_b32 v26, 16, v11
    v_and_b32 v27, s24, v11
    v_add_f32 v28, v12, v13
    v_mul_f32 v29, v12, v12
    v_fmac_f32 v29, v13, v13
    v_add_f32 v28, v28, v14
    v_fmac_f32 v29, v14, v14
    v_add_f32 v28, v28, v15
    v_fmac_f32 v29, v15, v15
    v_add_f32 v28, v28, v16
    v_fmac_f32 v29, v16, v16
    v_add_f32 v28, v28, v17
    v_fmac_f32 v29, v17, v17
    v_add_f32 v28, v28, v18
    v_fmac_f32 v29, v18, v18
    v_add_f32 v28, v28, v19
    v_fmac_f32 v29, v19, v19
    v_add_f32 v28, v28, v20
    v_fmac_f32 v29, v20, v20
    v_add_f32 v28, v28, v21
    v_fmac_f32 v29, v21, v21
    v_add_f32 v28, v28, v22
    v_fmac_f32 v29, v22, v22
    v_add_f32 v28, v28, v23
    v_fmac_f32 v29, v23, v23
    v_add_f32 v28, v28, v24
    v_fmac_f32 v29, v24, v24
    v_add_f32 v28, v28, v25
    v_fmac_f32 v29, v25, v25
    v_add_f32 v28, v28, v26
    v_fmac_f32 v29, v26, v26
    v_add_f32_e64 v28, v28, v27
    v_fmac_f32 v29, v27, v27
    s_nop 0
    v_add_f32_dpp v28, v28, v28 row_shr:1 row_mask:0xf bank_mask:0xf bound_ctrl:0
    v_add_f32_dpp v29, v29, v29 row_shr:1 row_mask:0xf bank_mask:0xf bound_ctrl:0
    s_nop 0
    v_add_f32_dpp v28, v28, v28 row_shr:2 row_mask:0xf bank_mask:0xf bound_ctrl:0
    v_add_f32_dpp v29, v29, v29 row_shr:2 row_mask:0xf bank_mask:0xf bound_ctrl:0
    s_nop 0
    v_add_f32_dpp v28, v28, v28 row_shr:4 row_mask:0xf bank_mask:0xf bound_ctrl:0
    v_add_f32_dpp v29, v29, v29 row_shr:4 row_mask:0xf bank_mask:0xf bound_ctrl:0
    s_nop 0
    v_add_f32_dpp v28, v28, v28 row_shr:8 row_mask:0xf bank_mask:0xf bound_ctrl:0
    v_add_f32_dpp v29, v29, v29 row_shr:8 row_mask:0xf bank_mask:0xf bound_ctrl:0
    s_nop 0
    v_add_f32_dpp v28, v28, v28 row_bcast:15 row_mask:0xa bank_mask:0xf
    v_add_f32_dpp v29, v29, v29 row_bcast:15 row_mask:0xa bank_mask:0xf
    s_nop 0
    v_add_f32_dpp v28, v28, v28 row_bcast:31 row_mask:0xc bank_mask:0xf
    v_add_f32_dpp v29, v29, v29 row_bcast:31 row_mask:0xc bank_mask:0xf
    v_mul_f32 v28, 0x3acccccd, v28
    v_mul_f32 v29, 0x3acccccd, v29
    v_fma_f32 v29, -v28, v28, v29
    v_max_f32 v29, 0, v29
    v_add_f32 v29, 0x3727c5ac, v29
    v_rsq_f32_e64 v29, v29
    s_mul_i32 s22, s4, 1280
    v_mul_f32 v28, v28, v29
    s_nop 0
    v_readlane_b32 s20, v29, 63
    v_readlane_b32 s21, v28, 63
    s_nop 1
    v_mov_b32 v28, s21
    v_fma_f32 v12, v12, s20, -v28
    v_fma_f32 v13, v13, s20, -v28
    v_fma_f32 v14, v14, s20, -v28
    v_fma_f32 v15, v15, s20, -v28
    v_fma_f32 v16, v16, s20, -v28
    v_fma_f32 v17, v17, s20, -v28
    v_fma_f32 v18, v18, s20, -v28
    v_fma_f32 v19, v19, s20, -v28
    v_fma_f32 v20, v20, s20, -v28
    v_fma_f32 v21, v21, s20, -v28
    v_fma_f32 v22, v22, s20, -v28
    v_fma_f32 v23, v23, s20, -v28
    v_fma_f32 v24, v24, s20, -v28
    v_fma_f32 v25, v25, s20, -v28
    v_fma_f32 v26, v26, s20, -v28
    v_fma_f32 v27, v27, s20, -v28
    v_cvt_pk_bf16_f32 v4, v12, v13
    v_cvt_pk_bf16_f32 v5, v14, v15
    v_cvt_pk_bf16_f32 v6, v16, v17
    v_cvt_pk_bf16_f32 v7, v18, v19
    v_cvt_pk_bf16_f32 v8, v20, v21
    v_cvt_pk_bf16_f32 v9, v22, v23
    v_cvt_pk_bf16_f32 v10, v24, v25
    v_cvt_pk_bf16_f32 v11, v26, v27
    buffer_store_dwordx4 v[4:7], v30, s[12:15], s22 offen sc1
    s_mov_b64 exec, 0xffff
    buffer_store_dwordx4 v[8:11], v30, s[12:15], s22 offen offset:1024 sc1
    s_mov_b64 exec, -1
    s_cmp_ge_u32 s3, 6
    s_cbranch_scc1 L_parallel_sum__grouped_kv_mqa__mixer_gmlp__prompt_q1x_12
    s_mov_b32 s25, 0
    s_barrier
    ds_read_b128 v[60:63], v124
    ds_read_b64_tr_b16 v[92:93], v128 offset:0
    ds_read_b64_tr_b16 v[94:95], v128 offset:768
    ds_read_b128 v[64:67], v125
    ds_read_b64_tr_b16 v[96:97], v128 offset:3072
    ds_read_b64_tr_b16 v[98:99], v128 offset:3840
    ds_read_b128 v[68:71], v126
    ds_read_b64_tr_b16 v[100:101], v128 offset:6144
    ds_read_b64_tr_b16 v[102:103], v128 offset:6912
    ds_read_b128 v[72:75], v127
    ds_read_b64_tr_b16 v[104:105], v128 offset:9216
    ds_read_b64_tr_b16 v[106:107], v128 offset:9984
L_parallel_sum__grouped_kv_mqa__mixer_gmlp__prompt_fl_46:
    s_mov_b32 s26, 20480
    s_cmp_eq_u32 s25, 5
    s_cmov_b32 s26, 0xfffe7000
    v_add_u32 v124, s26, v124
    v_add_u32 v125, s26, v125
    v_add_u32 v126, s26, v126
    v_add_u32 v127, s26, v127
    v_add_u32 v128, s26, v128
    s_waitcnt lgkmcnt(0)
    v_mfma_f32_32x32x16_bf16 v[36:51], v[92:95], v[60:63], v[36:51]
    ds_read_b128 v[76:79], v124
    ds_read_b64_tr_b16 v[108:109], v128 offset:0
    ds_read_b64_tr_b16 v[110:111], v128 offset:768
    ds_read_b128 v[80:83], v125
    v_mfma_f32_32x32x16_bf16 v[36:51], v[96:99], v[64:67], v[36:51]
    ds_read_b64_tr_b16 v[112:113], v128 offset:3072
    ds_read_b64_tr_b16 v[114:115], v128 offset:3840
    ds_read_b128 v[84:87], v126
    ds_read_b64_tr_b16 v[116:117], v128 offset:6144
    v_mfma_f32_32x32x16_bf16 v[36:51], v[100:103], v[68:71], v[36:51]
    ds_read_b64_tr_b16 v[118:119], v128 offset:6912
    ds_read_b128 v[88:91], v127
    ds_read_b64_tr_b16 v[120:121], v128 offset:9216
    ds_read_b64_tr_b16 v[122:123], v128 offset:9984
    v_mfma_f32_32x32x16_bf16 v[36:51], v[104:107], v[72:75], v[36:51]
    s_add_u32 s25, s25, 1
    s_mov_b32 s26, 20480
    s_cmp_eq_u32 s25, 5
    s_cmov_b32 s26, 0xfffe7000
    v_add_u32 v124, s26, v124
    v_add_u32 v125, s26, v125
    v_add_u32 v126, s26, v126
    v_add_u32 v127, s26, v127
    v_add_u32 v128, s26, v128
    s_cmp_lg_u32 s25, 3
    s_cbranch_scc1 L_parallel_sum__grouped_kv_mqa__mixer_gmlp__prompt_fe1_48
    s_waitcnt vmcnt(0)
L_parallel_sum__grouped_kv_mqa__mixer_gmlp__prompt_fe1_48:
    s_cmp_eq_u32 s25, 9
    s_waitcnt lgkmcnt(0)
    s_cbranch_scc1 L_parallel_sum__grouped_kv_mqa__mixer_gmlp__prompt_fnb_47
    s_barrier
L_parallel_sum__grouped_kv_mqa__mixer_gmlp__prompt_fnb_47:
    v_mfma_f32_32x32x16_bf16 v[36:51], v[108:111], v[76:79], v[36:51]
    ds_read_b128 v[60:63], v124
    ds_read_b64_tr_b16 v[92:93], v128 offset:0
    ds_read_b64_tr_b16 v[94:95], v128 offset:768
    ds_read_b128 v[64:67], v125
    v_mfma_f32_32x32x16_bf16 v[36:51], v[112:115], v[80:83], v[36:51]
    ds_read_b64_tr_b16 v[96:97], v128 offset:3072
    ds_read_b64_tr_b16 v[98:99], v128 offset:3840
    ds_read_b128 v[68:71], v126
    ds_read_b64_tr_b16 v[100:101], v128 offset:6144
    v_mfma_f32_32x32x16_bf16 v[36:51], v[116:119], v[84:87], v[36:51]
    ds_read_b64_tr_b16 v[102:103], v128 offset:6912
    ds_read_b128 v[72:75], v127
    ds_read_b64_tr_b16 v[104:105], v128 offset:9216
    ds_read_b64_tr_b16 v[106:107], v128 offset:9984
    v_mfma_f32_32x32x16_bf16 v[36:51], v[120:123], v[88:91], v[36:51]
    s_cmp_lg_u32 s25, 5
    s_cbranch_scc1 L_parallel_sum__grouped_kv_mqa__mixer_gmlp__prompt_fe5_51
    s_mov_b32 s12, s56
    s_mov_b32 s13, s57
    s_mov_b32 s14, 0x0021c000
    s_mov_b32 s15, 0x00020000
    s_lshl_b32 s20, s2, 3
    s_add_u32 s20, s20, s3
    s_mul_i32 s20, s20, 1280
    s_mov_b64 exec, 0x3ff
    buffer_load_dword v32, v31, s[12:15], s20 offen
    s_mov_b64 exec, -1
L_parallel_sum__grouped_kv_mqa__mixer_gmlp__prompt_fe5_51:
    s_cmp_lg_u32 s25, 7
    s_cbranch_scc1 L_parallel_sum__grouped_kv_mqa__mixer_gmlp__prompt_fe3_50
    s_mov_b32 s16, 131072
    s_mov_b64 exec, 0xff
    buffer_load_dwordx2 v[148:149], v150, s[72:75], s16 offen sc1
    s_mov_b64 exec, -1
L_parallel_sum__grouped_kv_mqa__mixer_gmlp__prompt_fe3_50:
    s_add_u32 s25, s25, 1
    s_cmp_lt_u32 s25, 10
    s_cbranch_scc1 L_parallel_sum__grouped_kv_mqa__mixer_gmlp__prompt_fl_46
    s_waitcnt lgkmcnt(0)
L_parallel_sum__grouped_kv_mqa__mixer_gmlp__prompt_qe_13:
    s_barrier
    s_lshr_b32 s16, s3, 1
    s_lshl_b32 s16, s16, 9
    s_add_u32 s16, s16, 60160
    v_lshlrev_b32 v136, 4, v129
    v_lshl_add_u32 v136, v130, 3, v136
    v_add_u32_e64 v136, s16, v136
    ds_read_b64 v[52:53], v136
    s_and_b32 s16, s3, 1
    s_lshl_b32 s16, s16, 7
    s_add_u32 s16, s16, 54272
    v_lshl_add_u32 v136, v129, 2, s16
    ds_read_b32 v140, v136
    ds_read_b32 v141, v136 offset:256
    s_waitcnt lgkmcnt(2)
    v_add_f32 v54, v52, v53
    v_and_b32 v55, s24, v54
    v_sub_f32 v54, v54, v55
    v_cvt_pk_bf16_f32 v52, v55, v55
    v_cvt_pk_bf16_f32 v53, v54, 0
    s_waitcnt lgkmcnt(0)
    v_and_b32 v138, s24, v140
    v_sub_f32_e64 v139, v140, v138
    v_cvt_pk_bf16_f32 v142, -v138, -v139
    v_cvt_pk_bf16_f32 v143, -v138, 0
    s_nop 1
    v_mfma_f32_32x32x8_bf16 v[36:51], v[52:53], v[142:143], v[36:51]
    s_waitcnt vmcnt(0)
    s_mov_b64 exec, 0xff
    v_cmp_ne_u64 vcc, s[96:97], v[148:149]
    s_mov_b64 exec, -1
    s_cbranch_vccnz L_parallel_sum__grouped_kv_mqa__mixer_gmlp__prompt_kt_52
    s_mov_b32 s27, 1
    s_add_u32 s28, s68, 0x00940000
    s_addc_u32 s29, s69, 0
    s_mov_b32 s30, 0x0002a000
    s_mov_b32 s31, 0x00020000
    s_mul_i32 s16, s3, 2688
    s_mul_i32 m0, s3, 2624
    v_lshlrev_b32 v144, 4, v1
    buffer_load_dwordx4 v144, s[28:31], s16 offen sc1 lds
    buffer_load_dwordx4 v144, s[28:31], s16 offen offset:1024 sc1 lds
    buffer_load_dwordx4 v144, s[28:31], s16 offen offset:1600 sc1 lds
L_parallel_sum__grouped_kv_mqa__mixer_gmlp__prompt_kt_52:
    v_mul_f32 v141, 0x3ea52b5c, v141
    s_and_b32 s16, s3, 1
    s_mul_i32 s16, s16, 6144
    s_lshr_b32 s17, s3, 1
    s_lshl_b32 s17, s17, 6
    s_add_u32 s16, s16, s17
    s_add_u32 s16, s16, 41984
    v_mul_u32_u24 v136, 192, v129
    v_lshl_add_u32 v136, v130, 3, v136
    v_add_u32 v136, s16, v136
    s_nop 1
    v_mul_f32 v36, v141, v36
    v_mul_f32 v37, v141, v37
    v_mul_f32 v38, v141, v38
    v_mul_f32 v39, v141, v39
    v_mul_f32 v40, v141, v40
    v_mul_f32 v41, v141, v41
    v_mul_f32 v42, v141, v42
    v_mul_f32 v43, v141, v43
    v_mul_f32 v44, v141, v44
    v_mul_f32 v45, v141, v45
    v_mul_f32 v46, v141, v46
    v_mul_f32 v47, v141, v47
    v_mul_f32 v48, v141, v48
    v_mul_f32 v49, v141, v49
    v_mul_f32 v50, v141, v50
    v_mul_f32 v51, v141, v51
    v_cvt_pk_bf16_f32 v60, v36, v37
    v_cvt_pk_bf16_f32 v61, v38, v39
    v_cvt_pk_bf16_f32 v62, v40, v41
    v_cvt_pk_bf16_f32 v63, v42, v43
    v_cvt_pk_bf16_f32 v64, v44, v45
    v_cvt_pk_bf16_f32 v65, v46, v47
    v_cvt_pk_bf16_f32 v66, v48, v49
    v_cvt_pk_bf16_f32 v67, v50, v51
    ds_write_b64 v136, v[60:61] offset:0
    ds_write_b64 v136, v[62:63] offset:16
    ds_write_b64 v136, v[64:65] offset:32
    ds_write_b64 v136, v[66:67] offset:48
    s_waitcnt lgkmcnt(0)
    s_branch L_parallel_sum__grouped_kv_mqa__mixer_gmlp__prompt_qj_14
L_parallel_sum__grouped_kv_mqa__mixer_gmlp__prompt_q1x_12:
    s_mov_b32 s25, 0
    s_barrier
    ds_read_b64_tr_b16 v[60:61], v128 offset:0
    ds_read_b64_tr_b16 v[62:63], v128 offset:768
    ds_read_b64_tr_b16 v[64:65], v128 offset:3072
    ds_read_b64_tr_b16 v[66:67], v128 offset:3840
    ds_read_b64_tr_b16 v[68:69], v128 offset:64
    ds_read_b64_tr_b16 v[70:71], v128 offset:832
    ds_read_b64_tr_b16 v[72:73], v128 offset:3136
    ds_read_b64_tr_b16 v[74:75], v128 offset:3904
    ds_read_b64_tr_b16 v[76:77], v128 offset:128
    ds_read_b64_tr_b16 v[78:79], v128 offset:896
    ds_read_b64_tr_b16 v[80:81], v128 offset:3200
    ds_read_b64_tr_b16 v[82:83], v128 offset:3968
L_parallel_sum__grouped_kv_mqa__mixer_gmlp__prompt_fl_53:
    s_mov_b32 s26, 20480
    s_cmp_eq_u32 s25, 5
    s_cmov_b32 s26, 0xfffe7000
    v_add_u32 v128, s26, v128
    s_waitcnt lgkmcnt(0)
    ds_read_b64_tr_b16 v[92:93], v128 offset:0
    ds_read_b64_tr_b16 v[94:95], v128 offset:768
    ds_read_b64_tr_b16 v[96:97], v128 offset:3072
    ds_read_b64_tr_b16 v[98:99], v128 offset:3840
    ds_read_b64_tr_b16 v[100:101], v128 offset:64
    ds_read_b64_tr_b16 v[102:103], v128 offset:832
    ds_read_b64_tr_b16 v[104:105], v128 offset:3136
    ds_read_b64_tr_b16 v[106:107], v128 offset:3904
    ds_read_b64_tr_b16 v[108:109], v128 offset:128
    ds_read_b64_tr_b16 v[110:111], v128 offset:896
    ds_read_b64_tr_b16 v[112:113], v128 offset:3200
    ds_read_b64_tr_b16 v[114:115], v128 offset:3968
    v_mfma_f32_4x4x4_16b_bf16 v[36:39], v[132:133], v[60:61], v[36:39]
    v_mfma_f32_4x4x4_16b_bf16 v[40:43], v[132:133], v[68:69], v[40:43]
    v_mfma_f32_4x4x4_16b_bf16 v[44:47], v[132:133], v[76:77], v[44:47]
    v_mfma_f32_4x4x4_16b_bf16 v[36:39], v[132:133], v[62:63], v[36:39]
    v_mfma_f32_4x4x4_16b_bf16 v[40:43], v[132:133], v[70:71], v[40:43]
    v_mfma_f32_4x4x4_16b_bf16 v[44:47], v[132:133], v[78:79], v[44:47]
    v_mfma_f32_4x4x4_16b_bf16 v[36:39], v[132:133], v[64:65], v[36:39]
    v_mfma_f32_4x4x4_16b_bf16 v[40:43], v[132:133], v[72:73], v[40:43]
    v_mfma_f32_4x4x4_16b_bf16 v[44:47], v[132:133], v[80:81], v[44:47]
    v_mfma_f32_4x4x4_16b_bf16 v[36:39], v[132:133], v[66:67], v[36:39]
    v_mfma_f32_4x4x4_16b_bf16 v[40:43], v[132:133], v[74:75], v[40:43]
    v_mfma_f32_4x4x4_16b_bf16 v[44:47], v[132:133], v[82:83], v[44:47]
    s_add_u32 s25, s25, 1
    s_mov_b32 s26, 20480
    s_cmp_eq_u32 s25, 5
    s_cmov_b32 s26, 0xfffe7000
    v_add_u32 v128, s26, v128
    s_cmp_lg_u32 s25, 3
    s_cbranch_scc1 L_parallel_sum__grouped_kv_mqa__mixer_gmlp__prompt_fe1_55
    s_waitcnt vmcnt(0)
L_parallel_sum__grouped_kv_mqa__mixer_gmlp__prompt_fe1_55:
    s_cmp_eq_u32 s25, 9
    s_waitcnt lgkmcnt(0)
    s_cbranch_scc1 L_parallel_sum__grouped_kv_mqa__mixer_gmlp__prompt_fnb_54
    s_barrier
L_parallel_sum__grouped_kv_mqa__mixer_gmlp__prompt_fnb_54:
    s_cmp_lg_u32 s25, 3
    s_cbranch_scc1 L_parallel_sum__grouped_kv_mqa__mixer_gmlp__prompt_fe2_56
    s_cmp_lg_u32 s3, 7
    s_cbranch_scc1 L_parallel_sum__grouped_kv_mqa__mixer_gmlp__prompt_fe2_56
    s_lshl_b32 s16, s5, 7
    v_mov_b32 v142, s96
    v_mov_b32 v143, s97
    v_lshlrev_b32_e64 v140, 3, v1
    s_mov_b64 exec, 0xffff
    buffer_store_dwordx2 v[142:143], v140, s[72:75], s16 offen sc1
    s_mov_b64 exec, -1
L_parallel_sum__grouped_kv_mqa__mixer_gmlp__prompt_fe2_56:
    ds_read_b64_tr_b16 v[60:61], v128 offset:0
    ds_read_b64_tr_b16 v[62:63], v128 offset:768
    ds_read_b64_tr_b16 v[64:65], v128 offset:3072
    ds_read_b64_tr_b16 v[66:67], v128 offset:3840
    ds_read_b64_tr_b16 v[68:69], v128 offset:64
    ds_read_b64_tr_b16 v[70:71], v128 offset:832
    ds_read_b64_tr_b16 v[72:73], v128 offset:3136
    ds_read_b64_tr_b16 v[74:75], v128 offset:3904
    ds_read_b64_tr_b16 v[76:77], v128 offset:128
    ds_read_b64_tr_b16 v[78:79], v128 offset:896
    ds_read_b64_tr_b16 v[80:81], v128 offset:3200
    ds_read_b64_tr_b16 v[82:83], v128 offset:3968
    v_mfma_f32_4x4x4_16b_bf16 v[36:39], v[132:133], v[92:93], v[36:39]
    v_mfma_f32_4x4x4_16b_bf16 v[40:43], v[132:133], v[100:101], v[40:43]
    v_mfma_f32_4x4x4_16b_bf16 v[44:47], v[132:133], v[108:109], v[44:47]
    v_mfma_f32_4x4x4_16b_bf16 v[36:39], v[132:133], v[94:95], v[36:39]
    v_mfma_f32_4x4x4_16b_bf16 v[40:43], v[132:133], v[102:103], v[40:43]
    v_mfma_f32_4x4x4_16b_bf16 v[44:47], v[132:133], v[110:111], v[44:47]
    v_mfma_f32_4x4x4_16b_bf16 v[36:39], v[132:133], v[96:97], v[36:39]
    v_mfma_f32_4x4x4_16b_bf16 v[40:43], v[132:133], v[104:105], v[40:43]
    v_mfma_f32_4x4x4_16b_bf16 v[44:47], v[132:133], v[112:113], v[44:47]
    v_mfma_f32_4x4x4_16b_bf16 v[36:39], v[132:133], v[98:99], v[36:39]
    v_mfma_f32_4x4x4_16b_bf16 v[40:43], v[132:133], v[106:107], v[40:43]
    v_mfma_f32_4x4x4_16b_bf16 v[44:47], v[132:133], v[114:115], v[44:47]
    s_cmp_lg_u32 s25, 5
    s_cbranch_scc1 L_parallel_sum__grouped_kv_mqa__mixer_gmlp__prompt_fe5_58
    s_mov_b32 s12, s56
    s_mov_b32 s13, s57
    s_mov_b32 s14, 0x0021c000
    s_mov_b32 s15, 0x00020000
    s_lshl_b32 s20, s2, 3
    s_add_u32 s20, s20, s3
    s_mul_i32 s20, s20, 1280
    s_mov_b64 exec, 0x3ff
    buffer_load_dword v32, v31, s[12:15], s20 offen
    s_mov_b64 exec, -1
L_parallel_sum__grouped_kv_mqa__mixer_gmlp__prompt_fe5_58:
    s_cmp_lg_u32 s25, 7
    s_cbranch_scc1 L_parallel_sum__grouped_kv_mqa__mixer_gmlp__prompt_fe3_57
    s_mov_b32 s16, 131072
    s_mov_b64 exec, 0xff
    buffer_load_dwordx2 v[148:149], v150, s[72:75], s16 offen sc1
    s_mov_b64 exec, -1
L_parallel_sum__grouped_kv_mqa__mixer_gmlp__prompt_fe3_57:
    s_add_u32 s25, s25, 1
    s_cmp_lt_u32 s25, 10
    s_cbranch_scc1 L_parallel_sum__grouped_kv_mqa__mixer_gmlp__prompt_fl_53
    s_waitcnt lgkmcnt(0)
L_parallel_sum__grouped_kv_mqa__mixer_gmlp__prompt_q2x_15:
    s_and_b32 s16, s3, 1
    s_lshl_b32 s16, s16, 2
    s_add_u32 s16, s16, 60160
    v_lshlrev_b32 v136, 4, v129
    v_lshl_add_u32 v136, v130, 3, v136
    v_add_u32_e64 v136, s16, v136
    ds_write_b32 v136, v36 offset:0
    ds_write_b32 v136, v40 offset:512
    ds_write_b32 v136, v44 offset:1024
    s_waitcnt lgkmcnt(0)
    s_barrier
    s_waitcnt vmcnt(0)
    s_mov_b64 exec, 0xff
    v_cmp_ne_u64 vcc, s[96:97], v[148:149]
    s_mov_b64 exec, -1
    s_cbranch_vccnz L_parallel_sum__grouped_kv_mqa__mixer_gmlp__prompt_kt_59
    s_mov_b32 s27, 1
    s_add_u32 s28, s68, 0x00940000
    s_addc_u32 s29, s69, 0
    s_mov_b32 s30, 0x0002a000
    s_mov_b32 s31, 0x00020000
    s_mul_i32 s16, s3, 2688
    s_mul_i32 m0, s3, 2624
    v_lshlrev_b32_e64 v144, 4, v1
    buffer_load_dwordx4 v144, s[28:31], s16 offen sc1 lds
    buffer_load_dwordx4 v144, s[28:31], s16 offen offset:1024 sc1 lds
    buffer_load_dwordx4 v144, s[28:31], s16 offen offset:1600 sc1 lds
L_parallel_sum__grouped_kv_mqa__mixer_gmlp__prompt_kt_59:
L_parallel_sum__grouped_kv_mqa__mixer_gmlp__prompt_qj_14:
L_parallel_sum__grouped_kv_mqa__mixer_gmlp__prompt_skipA_4:
    s_mov_b32 s40, s27
    v_mov_b32 v104, v150
    s_add_u32 s8, s68, 0x00940000
    s_addc_u32 s9, s69, 0
    s_mov_b32 s10, 0x0002a000
    s_mov_b32 s11, 0x00020000
    v_and_b32 v102, 31, v1
    v_lshrrev_b32 v103, 5, v1
    v_lshlrev_b32 v101, 4, v1
    s_mul_i32 s21, s3, 2624
    s_add_u32 s21, s21, 0
    s_mul_i32 s20, s3, 2688
    s_mov_b32 s24, 0xffff0000
    s_cmp_lg_u32 s40, 0
    s_cbranch_scc1 L_parallel_sum__grouped_kv_mqa__mixer_gmlp__prompt_kvd_60
    s_mov_b32 s41, 131072
    s_mov_b64 exec, 0x000000ff
L_parallel_sum__grouped_kv_mqa__mixer_gmlp__prompt_pl_61:
    buffer_load_dwordx2 v[106:107], v104, s[72:75], s41 offen sc1
    s_waitcnt vmcnt(0)
    v_cmp_ne_u64 vcc, s[96:97], v[106:107]
    s_cbranch_vccz L_parallel_sum__grouped_kv_mqa__mixer_gmlp__prompt_pd_62
    s_sleep 1
    s_sub_u32 s70, s70, 1
    s_cbranch_scc0 L_parallel_sum__grouped_kv_mqa__mixer_gmlp__prompt_pl_61
L_parallel_sum__grouped_kv_mqa__mixer_gmlp__prompt_pd_62:
    s_mov_b64 exec, -1
    s_add_u32 m0, s21, 0
    s_nop 0
    buffer_load_dwordx4 v101, s[8:11], s20 offen offset:0 sc1 lds
    buffer_load_dwordx4 v101, s[8:11], s20 offen offset:1024 sc1 lds
    buffer_load_dwordx4 v101, s[8:11], s20 offen offset:1600 sc1 lds
    s_add_u32 s20, s20, 21504
    s_sub_u32 s20, s20, 21504
L_parallel_sum__grouped_kv_mqa__mixer_gmlp__prompt_kvd_60:
    s_add_u32 s20, s20, 21504
    s_add_u32 m0, s21, 20992
    s_nop 0
    buffer_load_dwordx4 v101, s[8:11], s20 offen offset:0 sc1 lds
    buffer_load_dwordx4 v101, s[8:11], s20 offen offset:1024 sc1 lds
    buffer_load_dwordx4 v101, s[8:11], s20 offen offset:1600 sc1 lds
    s_add_u32 s20, s20, 21504
    s_lshr_b32 s18, s3, 2
    s_mul_i32 s16, s18, 2624
    s_add_u32 s16, s16, 0
    v_add_u32 v98, s16, v101
    v_lshlrev_b32 v99, 2, v1
    v_add_u32 v99, s16, v99
    v_min_u32 v100, 20, v102
    v_lshlrev_b32 v100, 4, v100
    v_mul_u32_u24 v130, 336, v103
    v_add_u32 v100, v100, v130
    v_add_u32 v100, s16, v100
    v_mov_b32 v97, 0x3f803f80
    v_mov_b32 v121, 0
    v_mov_b32 v123, 0
    v_and_b32 v126, 7, v1
    v_lshlrev_b32 v126, 2, v126
    v_add_u32 v126, 163328, v126
    s_lshl_b32 s16, s3, 2
    s_add_u32 s16, s16, 163328
    v_mov_b32 v127, s16
    v_mov_b32 v76, 0
    v_mov_b32 v77, 0
    v_mov_b32 v78, 0
    v_mov_b32 v79, 0
    v_mov_b32 v80, 0
    v_mov_b32 v81, 0
    v_mov_b32 v82, 0
    v_mov_b32 v83, 0
    v_mov_b32 v93, 0x3f803f80
    s_and_b32 s16, s3, 1
    s_mul_i32 s16, s16, 6144
    s_and_b32 s17, s3, 2
    s_add_u32 s23, s17, s18
    s_mul_i32 s17, s23, 40
    s_add_u32 s16, s16, 41984
    v_mul_u32_u24 v130, 192, v102
    v_add_u32_e64 v130, s16, v130
    v_lshl_add_u32 v131, v103, 4, v130
    v_lshl_add_u32 v132, v103, 2, v130
    s_xor_b32 s16, s23, 1
    s_mul_i32 s16, s16, 40
    v_add_u32 v133, s16, v131
    v_add_u32 v134, s16, v132
    v_add_u32 v131, s17, v131
    v_add_u32 v132, s17, v132
    s_waitcnt vmcnt(3)
    v_mov_b32 v128, 1
    ds_write_b32 v127, v128
L_parallel_sum__grouped_kv_mqa__mixer_gmlp__prompt_spin_63:
    ds_read_b32 v128, v126
    s_waitcnt lgkmcnt(0)
    v_cmp_gt_u32 vcc, 1, v128
    s_cbranch_vccz L_parallel_sum__grouped_kv_mqa__mixer_gmlp__prompt_spun_64
    s_sleep 1
    s_sub_u32 s70, s70, 1
    s_cbranch_scc0 L_parallel_sum__grouped_kv_mqa__mixer_gmlp__prompt_spin_63
L_parallel_sum__grouped_kv_mqa__mixer_gmlp__prompt_spun_64:
    ds_read_b64 v[112:113], v131
    ds_read_b64 v[114:115], v131 offset:8
    ds_read_b32 v120, v132 offset:32
    ds_read_b64 v[116:117], v133
    ds_read_b64 v[118:119], v133 offset:8
    ds_read_b32 v122, v134 offset:32
    ds_read_b128 v[88:91], v98 offset:15744
    ds_read_b32 v92, v99 offset:16768
    ds_read_b128 v[84:87], v98 offset:10496
    ds_read_b32 v96, v99 offset:11520
    s_waitcnt lgkmcnt(2)
    v_mfma_f32_32x32x16_bf16 v[36:51], v[88:91], v[112:115], 0
    v_mfma_f32_32x32x8_bf16 v[36:51], v[92:93], v[120:121], v[36:51]
    v_mfma_f32_32x32x16_bf16 v[52:67], v[88:91], v[116:119], 0
    v_mfma_f32_32x32x8_bf16 v[52:67], v[92:93], v[122:123], v[52:67]
    ds_read_b128 v[88:91], v98 offset:5248
    ds_read_b32 v92, v99 offset:6272
    s_waitcnt lgkmcnt(2)
    v_mfma_f32_32x32x16_bf16 v[4:19], v[84:87], v[112:115], 0
    v_mfma_f32_32x32x8_bf16 v[4:19], v[96:97], v[120:121], v[4:19]
    v_mfma_f32_32x32x16_bf16 v[20:35], v[84:87], v[116:119], 0
    v_mfma_f32_32x32x8_bf16 v[20:35], v[96:97], v[122:123], v[20:35]
    ds_read_b128 v[84:87], v98 offset:0
    ds_read_b32 v96, v99 offset:1024
    s_nop 5
    v_max3_f32 v124, v36, v37, v38
    v_max_f32 v124, v124, v39
    v_max3_f32 v124, v124, v40, v41
    v_max3_f32 v124, v124, v42, v43
    v_max3_f32 v124, v124, v44, v45
    v_max3_f32 v124, v124, v46, v47
    v_max3_f32 v124, v124, v48, v49
    v_max3_f32 v124, v124, v50, v51
    v_max3_f32 v125, v52, v53, v54
    v_max_f32_e64 v125, v125, v55
    v_max3_f32 v125, v125, v56, v57
    v_max3_f32 v125, v125, v58, v59
    v_max3_f32 v125, v125, v60, v61
    v_max3_f32 v125, v125, v62, v63
    v_max3_f32 v125, v125, v64, v65
    v_max3_f32 v125, v125, v66, v67
    s_waitcnt lgkmcnt(2)
    v_mfma_f32_32x32x16_bf16 v[36:51], v[88:91], v[112:115], 0
    v_mfma_f32_32x32x8_bf16 v[36:51], v[92:93], v[120:121], v[36:51]
    v_mfma_f32_32x32x16_bf16 v[52:67], v[88:91], v[116:119], 0
    v_mfma_f32_32x32x8_bf16 v[52:67], v[92:93], v[122:123], v[52:67]
    s_nop 5
    v_max3_f32 v124, v124, v4, v5
    v_max3_f32 v124, v124, v6, v7
    v_max3_f32 v124, v124, v8, v9
    v_max3_f32 v124, v124, v10, v11
    v_max3_f32 v124, v124, v12, v13
    v_max3_f32 v124, v124, v14, v15
    v_max3_f32 v124, v124, v16, v17
    v_max3_f32 v124, v124, v18, v19
    v_max3_f32 v125, v125, v20, v21
    v_max3_f32 v125, v125, v22, v23
    v_max3_f32 v125, v125, v24, v25
    v_max3_f32 v125, v125, v26, v27
    v_max3_f32 v125, v125, v28, v29
    v_max3_f32 v125, v125, v30, v31
    v_max3_f32 v125, v125, v32, v33
    v_max3_f32 v125, v125, v34, v35
    s_waitcnt lgkmcnt(0)
    v_mfma_f32_32x32x16_bf16 v[4:19], v[84:87], v[112:115], 0
    v_mfma_f32_32x32x8_bf16 v[4:19], v[96:97], v[120:121], v[4:19]
    v_mfma_f32_32x32x16_bf16 v[20:35], v[84:87], v[116:119], 0
    v_mfma_f32_32x32x8_bf16 v[20:35], v[96:97], v[122:123], v[20:35]
    s_nop 5
    v_max3_f32 v124, v124, v36, v37
    v_max3_f32 v124, v124, v38, v39
    v_max3_f32 v124, v124, v40, v41
    v_max3_f32 v124, v124, v42, v43
    v_max3_f32 v124, v124, v44, v45
    v_max3_f32 v124, v124, v46, v47
    v_max3_f32 v124, v124, v48, v49
    v_max3_f32 v124, v124, v50, v51
    v_max3_f32 v125, v125, v52, v53
    v_max3_f32 v125, v125, v54, v55
    v_max3_f32 v125, v125, v56, v57
    v_max3_f32 v125, v125, v58, v59
    v_max3_f32 v125, v125, v60, v61
    v_max3_f32 v125, v125, v62, v63
    v_max3_f32 v125, v125, v64, v65
    v_max3_f32 v125, v125, v66, v67
    v_mov_b32 v36, 0
    v_mov_b32 v37, 0
    v_mov_b32 v38, 0
    v_mov_b32 v39, 0
    v_mov_b32 v40, 0
    v_mov_b32 v41, 0
    v_mov_b32 v42, 0
    v_mov_b32 v43, 0
    v_mov_b32 v44, 0
    v_mov_b32 v45, 0
    v_mov_b32 v46, 0
    v_mov_b32 v47, 0
    v_mov_b32 v48, 0
    v_mov_b32 v49, 0
    v_mov_b32 v50, 0
    v_mov_b32 v51, 0
    v_mov_b32 v52, 0
    v_mov_b32 v53, 0
    v_mov_b32 v54, 0
    v_mov_b32 v55, 0
    v_mov_b32 v56, 0
    v_mov_b32 v57, 0
    v_mov_b32 v58, 0
    v_mov_b32 v59, 0
    v_mov_b32 v60, 0
    v_mov_b32 v61, 0
    v_mov_b32 v62, 0
    v_mov_b32 v63, 0
    v_mov_b32 v64, 0
    v_mov_b32 v65, 0
    v_mov_b32 v66, 0
    v_mov_b32 v67, 0
    v_mov_b32 v88, 0
    v_mov_b32 v89, 0
    v_mov_b32 v90, 0
    v_mov_b32 v91, 0
    v_mov_b32 v92, 0
    v_mov_b32 v93, 0
    v_mov_b32 v94, 0
    v_mov_b32 v95, 0
    v_max3_f32 v124, v124, v4, v5
    v_max3_f32 v124, v124, v6, v7
    v_max3_f32 v124, v124, v8, v9
    v_max3_f32 v124, v124, v10, v11
    v_max3_f32 v124, v124, v12, v13
    v_max3_f32 v124, v124, v14, v15
    v_max3_f32 v124, v124, v16, v17
    v_max3_f32 v124, v124, v18, v19
    v_max3_f32 v125, v125, v20, v21
    v_max3_f32 v125, v125, v22, v23
    v_max3_f32 v125, v125, v24, v25
    v_max3_f32 v125, v125, v26, v27
    v_max3_f32 v125, v125, v28, v29
    v_max3_f32 v125, v125, v30, v31
    v_max3_f32 v125, v125, v32, v33
    v_max3_f32 v125, v125, v34, v35
    v_mov_b32 v130, v124
    v_mov_b32 v131, v125
    s_nop 0
    v_permlane32_swap_b32 v124, v130
    v_permlane32_swap_b32 v125, v131
    v_max_f32 v124, v124, v130
    v_ceil_f32_e64 v124, v124
    v_add_f32 v124, 0x42c80000, v124
    v_max_f32 v125, v125, v131
    v_ceil_f32 v125, v125
    v_add_f32 v125, 0x42c80000, v125
    v_sub_f32 v130, 0, v124
    v_and_b32 v131, s24, v130
    v_sub_f32 v130, v130, v131
    v_and_b32 v132, s24, v130
    v_sub_f32 v130, v130, v132
    v_lshrrev_b32 v131, 16, v131
    v_or_b32 v131, v131, v132
    v_cmp_eq_u32 vcc, 0, v103
    v_lshrrev_b32 v130, 16, v130
    s_nop 0
    v_cndmask_b32 v121, v130, v131, vcc
    s_nop 1
    v_sub_f32 v130, 0, v125
    v_and_b32 v131, s24, v130
    v_sub_f32 v130, v130, v131
    v_and_b32 v132, s24, v130
    v_sub_f32 v130, v130, v132
    v_lshrrev_b32 v131, 16, v131
    v_or_b32 v131, v131, v132
    v_cmp_eq_u32 vcc, 0, v103
    v_lshrrev_b32 v130, 16, v130
    s_nop 0
    v_cndmask_b32 v123, v130, v131, vcc
    s_nop 1
    v_mfma_f32_32x32x16_bf16 v[4:19], v[84:87], v[112:115], 0
    v_mfma_f32_32x32x8_bf16 v[4:19], v[96:97], v[120:121], v[4:19]
    s_mov_b32 s19, 0
    s_mov_b32 s25, 0
    s_nop 7
    s_nop 1
    .p2align 6
L_parallel_sum__grouped_kv_mqa__mixer_gmlp__prompt_aloop_65:
    v_exp_f32_e64 v4, v4
    v_mfma_f32_32x32x16_bf16 v[20:35], v[84:87], v[116:119], 0
    ds_read_b128 v[84:87], v98 offset:5248
    v_exp_f32 v5, v5
    v_exp_f32 v6, v6
    v_exp_f32 v7, v7
    v_exp_f32 v8, v8
    v_cvt_pk_bf16_f32 v68, v4, v5
    v_mfma_f32_32x32x8_bf16 v[20:35], v[96:97], v[122:123], v[20:35]
    ds_read_b32 v96, v99 offset:6272
    v_exp_f32 v9, v9
    v_exp_f32 v10, v10
    v_cvt_pk_bf16_f32 v69, v6, v7
    v_cvt_pk_bf16_f32 v70, v8, v9
    v_exp_f32 v11, v11
    v_exp_f32 v12, v12
    v_mfma_f32_32x32x16_bf16 v[52:67], v[88:91], v[76:79], v[52:67]
    ds_read_b128 v[88:91], v100 offset:1280
    v_exp_f32 v13, v13
    v_exp_f32 v14, v14
    v_cvt_pk_bf16_f32 v71, v10, v11
    v_exp_f32 v15, v15
    v_exp_f32 v16, v16
    v_cvt_pk_bf16_f32 v72, v12, v13
    v_mfma_f32_32x32x16_bf16 v[52:67], v[92:95], v[80:83], v[52:67]
    ds_read_b128 v[92:95], v100 offset:1952
    v_exp_f32_e64 v17, v17
    v_cvt_pk_bf16_f32 v73, v14, v15
    v_exp_f32 v18, v18
    v_exp_f32 v19, v19
    v_cvt_pk_bf16_f32 v74, v16, v17
    v_cvt_pk_bf16_f32 v75, v18, v19
    s_waitcnt lgkmcnt(2)
    v_exp_f32 v20, v20
    v_mfma_f32_32x32x16_bf16 v[4:19], v[84:87], v[112:115], 0
    v_exp_f32 v21, v21
    v_exp_f32 v22, v22
    v_exp_f32 v23, v23
    v_exp_f32 v24, v24
    v_cvt_pk_bf16_f32 v76, v20, v21
    v_mfma_f32_32x32x8_bf16 v[4:19], v[96:97], v[120:121], v[4:19]
    v_exp_f32 v25, v25
    v_exp_f32 v26, v26
    v_cvt_pk_bf16_f32 v77, v22, v23
    v_cvt_pk_bf16_f32 v78, v24, v25
    v_cmp_lt_f32 vcc, 0x45800000, v48
    v_exp_f32_e64 v27, v27
    v_exp_f32 v28, v28
    s_waitcnt lgkmcnt(0)
    v_mfma_f32_32x32x16_bf16 v[36:51], v[88:91], v[68:71], v[36:51]
    v_exp_f32 v29, v29
    v_exp_f32 v30, v30
    v_cvt_pk_bf16_f32 v79, v26, v27
    v_exp_f32 v31, v31
    v_exp_f32 v32, v32
    v_cvt_pk_bf16_f32 v80, v28, v29
    v_mfma_f32_32x32x16_bf16 v[36:51], v[92:95], v[72:75], v[36:51]
    v_exp_f32_e64 v33, v33
    v_cvt_pk_bf16_f32 v81, v30, v31
    v_exp_f32 v34, v34
    v_exp_f32 v35, v35
    v_cvt_pk_bf16_f32 v82, v32, v33
    v_cvt_pk_bf16_f32 v83, v34, v35
    s_cbranch_vccnz L_parallel_sum__grouped_kv_mqa__mixer_gmlp__prompt_rin2_66
L_parallel_sum__grouped_kv_mqa__mixer_gmlp__prompt_rback2_70:
    v_exp_f32 v4, v4
    v_mfma_f32_32x32x16_bf16 v[20:35], v[84:87], v[116:119], 0
    ds_read_b128 v[84:87], v98 offset:10496
    v_exp_f32 v5, v5
    v_exp_f32 v6, v6
    v_exp_f32 v7, v7
    v_exp_f32 v8, v8
    v_cvt_pk_bf16_f32 v68, v4, v5
    v_mfma_f32_32x32x8_bf16 v[20:35], v[96:97], v[122:123], v[20:35]
    ds_read_b32 v96, v99 offset:11520
    v_exp_f32 v9, v9
    v_exp_f32 v10, v10
    v_cvt_pk_bf16_f32 v69, v6, v7
    v_cvt_pk_bf16_f32 v70, v8, v9
    v_cmp_lt_f32 vcc, 0x45800000, v64
    v_exp_f32 v11, v11
    v_exp_f32 v12, v12
    v_mfma_f32_32x32x16_bf16 v[52:67], v[88:91], v[76:79], v[52:67]
    ds_read_b128 v[88:91], v100 offset:6528
    v_exp_f32 v13, v13
    v_exp_f32 v14, v14
    v_cvt_pk_bf16_f32 v71, v10, v11
    v_exp_f32 v15, v15
    v_exp_f32 v16, v16
    v_cvt_pk_bf16_f32 v72, v12, v13
    v_mfma_f32_32x32x16_bf16 v[52:67], v[92:95], v[80:83], v[52:67]
    ds_read_b128 v[92:95], v100 offset:7200
    v_exp_f32_e64 v17, v17
    v_cvt_pk_bf16_f32 v73, v14, v15
    v_exp_f32 v18, v18
    v_exp_f32 v19, v19
    v_cvt_pk_bf16_f32 v74, v16, v17
    v_cvt_pk_bf16_f32 v75, v18, v19
    s_cbranch_vccnz L_parallel_sum__grouped_kv_mqa__mixer_gmlp__prompt_rin3_68
L_parallel_sum__grouped_kv_mqa__mixer_gmlp__prompt_rback3_72:
    s_waitcnt lgkmcnt(2)
    v_exp_f32_e64 v20, v20
    v_mfma_f32_32x32x16_bf16 v[4:19], v[84:87], v[112:115], 0
    v_exp_f32 v21, v21
    v_exp_f32 v22, v22
    v_exp_f32 v23, v23
    v_exp_f32 v24, v24
    v_cvt_pk_bf16_f32 v76, v20, v21
    v_mfma_f32_32x32x8_bf16 v[4:19], v[96:97], v[120:121], v[4:19]
    v_exp_f32 v25, v25
    v_exp_f32 v26, v26
    v_cvt_pk_bf16_f32 v77, v22, v23
    v_cvt_pk_bf16_f32 v78, v24, v25
    v_exp_f32_e64 v27, v27
    v_exp_f32 v28, v28
    s_waitcnt lgkmcnt(0)
    v_mfma_f32_32x32x16_bf16 v[36:51], v[88:91], v[68:71], v[36:51]
    v_exp_f32 v29, v29
    v_exp_f32 v30, v30
    v_cvt_pk_bf16_f32 v79, v26, v27
    v_exp_f32 v31, v31
    v_exp_f32 v32, v32
    v_cvt_pk_bf16_f32 v80, v28, v29
    v_mfma_f32_32x32x16_bf16 v[36:51], v[92:95], v[72:75], v[36:51]
    v_exp_f32_e64 v33, v33
    v_cvt_pk_bf16_f32 v81, v30, v31
    v_exp_f32 v34, v34
    v_exp_f32 v35, v35
    v_cvt_pk_bf16_f32 v82, v32, v33
    v_cvt_pk_bf16_f32 v83, v34, v35
    s_add_u32 s16, s19, 2
    s_waitcnt vmcnt(0)
    v_mov_b32_e64 v128, s16
    ds_write_b32 v127, v128
    s_mov_b32 s22, 20992
    s_cmp_eq_u32 s25, 41984
    s_cmov_b32 s22, 0xffff5c00
    s_sub_u32 s17, s25, 20992
    s_cmp_eq_u32 s25, 0
    s_cmov_b32 s17, 41984
    v_exp_f32 v4, v4
    v_mfma_f32_32x32x16_bf16 v[20:35], v[84:87], v[116:119], 0
    ds_read_b128 v[84:87], v98 offset:15744
    v_exp_f32 v5, v5
    v_exp_f32 v6, v6
    v_exp_f32 v7, v7
    v_exp_f32 v8, v8
    v_cvt_pk_bf16_f32 v68, v4, v5
    v_mfma_f32_32x32x8_bf16 v[20:35], v[96:97], v[122:123], v[20:35]
    ds_read_b32 v96, v99 offset:16768
    v_exp_f32 v9, v9
    v_exp_f32 v10, v10
    v_cvt_pk_bf16_f32 v69, v6, v7
    v_cvt_pk_bf16_f32 v70, v8, v9
    v_exp_f32 v11, v11
    v_exp_f32 v12, v12
    v_mfma_f32_32x32x16_bf16 v[52:67], v[88:91], v[76:79], v[52:67]
    ds_read_b128 v[88:91], v100 offset:11776
    v_exp_f32 v13, v13
    v_exp_f32 v14, v14
    v_cvt_pk_bf16_f32 v71, v10, v11
    v_exp_f32 v15, v15
    v_exp_f32 v16, v16
    v_cvt_pk_bf16_f32 v72, v12, v13
    v_mfma_f32_32x32x16_bf16 v[52:67], v[92:95], v[80:83], v[52:67]
    ds_read_b128 v[92:95], v100 offset:12448
    v_exp_f32_e64 v17, v17
    v_cvt_pk_bf16_f32 v73, v14, v15
    v_exp_f32 v18, v18
    v_exp_f32 v19, v19
    v_cvt_pk_bf16_f32 v74, v16, v17
    v_cvt_pk_bf16_f32 v75, v18, v19
    s_waitcnt lgkmcnt(2)
    v_exp_f32 v20, v20
    v_mfma_f32_32x32x16_bf16 v[4:19], v[84:87], v[112:115], 0
    ds_read_b32 v128, v126
    v_exp_f32 v21, v21
    v_exp_f32 v22, v22
    v_exp_f32 v23, v23
    v_exp_f32 v24, v24
    v_cvt_pk_bf16_f32 v76, v20, v21
    v_mfma_f32_32x32x8_bf16 v[4:19], v[96:97], v[120:121], v[4:19]
    v_exp_f32 v25, v25
    v_exp_f32 v26, v26
    v_cvt_pk_bf16_f32 v77, v22, v23
    v_cvt_pk_bf16_f32 v78, v24, v25
    v_cmp_lt_f32 vcc, 0x45800000, v48
    v_exp_f32_e64 v27, v27
    v_exp_f32 v28, v28
    s_waitcnt lgkmcnt(0)
    v_mfma_f32_32x32x16_bf16 v[36:51], v[88:91], v[68:71], v[36:51]
    v_exp_f32 v29, v29
    v_exp_f32 v30, v30
    v_cvt_pk_bf16_f32 v79, v26, v27
    v_exp_f32 v31, v31
    v_exp_f32 v32, v32
    v_cvt_pk_bf16_f32 v80, v28, v29
    v_mfma_f32_32x32x16_bf16 v[36:51], v[92:95], v[72:75], v[36:51]
    v_exp_f32_e64 v33, v33
    v_cvt_pk_bf16_f32 v81, v30, v31
    v_exp_f32 v34, v34
    v_exp_f32 v35, v35
    v_cvt_pk_bf16_f32 v82, v32, v33
    v_cvt_pk_bf16_f32 v83, v34, v35
    s_cbranch_vccnz L_parallel_sum__grouped_kv_mqa__mixer_gmlp__prompt_rin6_67
L_parallel_sum__grouped_kv_mqa__mixer_gmlp__prompt_rback6_71:
    v_cmp_gt_u32 vcc, s16, v128
    s_cbranch_vccnz L_parallel_sum__grouped_kv_mqa__mixer_gmlp__prompt_xs_74
L_parallel_sum__grouped_kv_mqa__mixer_gmlp__prompt_xd_75:
    s_cmp_ge_u32 s19, 6
    s_cbranch_scc1 L_parallel_sum__grouped_kv_mqa__mixer_gmlp__prompt_nod_76
    s_add_u32 m0, s21, s17
    s_nop 0
    buffer_load_dwordx4 v101, s[8:11], s20 offen offset:0 sc1 lds
    buffer_load_dwordx4 v101, s[8:11], s20 offen offset:1024 sc1 lds
    buffer_load_dwordx4 v101, s[8:11], s20 offen offset:1600 sc1 lds
    s_add_u32 s20, s20, 21504
L_parallel_sum__grouped_kv_mqa__mixer_gmlp__prompt_nod_76:
    v_add_u32 v98, s22, v98
    v_add_u32 v99, s22, v99
    v_exp_f32 v4, v4
    v_mfma_f32_32x32x16_bf16 v[20:35], v[84:87], v[116:119], 0
    ds_read_b128 v[84:87], v98 offset:0
    v_exp_f32 v5, v5
    v_exp_f32 v6, v6
    v_exp_f32 v7, v7
    v_exp_f32 v8, v8
    v_cvt_pk_bf16_f32 v68, v4, v5
    v_mfma_f32_32x32x8_bf16 v[20:35], v[96:97], v[122:123], v[20:35]
    ds_read_b32 v96, v99 offset:1024
    v_exp_f32 v9, v9
    v_exp_f32 v10, v10
    v_cvt_pk_bf16_f32 v69, v6, v7
    v_cvt_pk_bf16_f32 v70, v8, v9
    v_cmp_lt_f32 vcc, 0x45800000, v64
    v_exp_f32 v11, v11
    v_exp_f32 v12, v12
    v_mfma_f32_32x32x16_bf16 v[52:67], v[88:91], v[76:79], v[52:67]
    ds_read_b128 v[88:91], v100 offset:17024
    v_exp_f32 v13, v13
    v_exp_f32 v14, v14
    v_cvt_pk_bf16_f32 v71, v10, v11
    v_exp_f32 v15, v15
    v_exp_f32 v16, v16
    v_cvt_pk_bf16_f32 v72, v12, v13
    v_mfma_f32_32x32x16_bf16 v[52:67], v[92:95], v[80:83], v[52:67]
    ds_read_b128 v[92:95], v100 offset:17696
    v_exp_f32_e64 v17, v17
    v_cvt_pk_bf16_f32 v73, v14, v15
    v_exp_f32 v18, v18
    v_exp_f32 v19, v19
    v_cvt_pk_bf16_f32 v74, v16, v17
    v_cvt_pk_bf16_f32 v75, v18, v19
    s_cbranch_vccnz L_parallel_sum__grouped_kv_mqa__mixer_gmlp__prompt_rin7_69
L_parallel_sum__grouped_kv_mqa__mixer_gmlp__prompt_rback7_73:
    s_waitcnt lgkmcnt(2)
    v_exp_f32_e64 v20, v20
    v_mfma_f32_32x32x16_bf16 v[4:19], v[84:87], v[112:115], 0
    v_exp_f32 v21, v21
    v_exp_f32 v22, v22
    v_exp_f32 v23, v23
    v_exp_f32 v24, v24
    v_cvt_pk_bf16_f32 v76, v20, v21
    v_mfma_f32_32x32x8_bf16 v[4:19], v[96:97], v[120:121], v[4:19]
    v_exp_f32 v25, v25
    v_exp_f32 v26, v26
    v_cvt_pk_bf16_f32 v77, v22, v23
    v_cvt_pk_bf16_f32 v78, v24, v25
    v_exp_f32_e64 v27, v27
    v_exp_f32 v28, v28
    s_waitcnt lgkmcnt(0)
    v_mfma_f32_32x32x16_bf16 v[36:51], v[88:91], v[68:71], v[36:51]
    v_exp_f32 v29, v29
    v_exp_f32 v30, v30
    v_cvt_pk_bf16_f32 v79, v26, v27
    v_exp_f32 v31, v31
    v_exp_f32 v32, v32
    v_cvt_pk_bf16_f32 v80, v28, v29
    v_mfma_f32_32x32x16_bf16 v[36:51], v[92:95], v[72:75], v[36:51]
    v_exp_f32_e64 v33, v33
    v_cvt_pk_bf16_f32 v81, v30, v31
    v_exp_f32 v34, v34
    v_exp_f32 v35, v35
    v_cvt_pk_bf16_f32 v82, v32, v33
    v_cvt_pk_bf16_f32 v83, v34, v35
    v_add_u32 v100, s22, v100
    s_add_u32 s25, s25, s22
    s_add_u32 s19, s19, 1
    s_cmp_lt_u32 s19, 8
    s_cbranch_scc1 L_parallel_sum__grouped_kv_mqa__mixer_gmlp__prompt_aloop_65
    s_setprio 3
    v_mfma_f32_32x32x16_bf16 v[52:67], v[88:91], v[76:79], v[52:67]
    v_mfma_f32_32x32x16_bf16 v[52:67], v[92:95], v[80:83], v[52:67]
    s_mul_i32 s16, s3, 3584
    s_add_u32 s22, s16, 34304
    s_add_u32 s16, s16, 0
    s_cmp_ge_u32 s3, 5
    s_cselect_b32 s16, s22, s16
    s_xor_b32 s18, s3, 4
    s_mul_i32 s17, s18, 3584
    s_add_u32 s22, s17, 34304
    s_add_u32 s17, s17, 0
    s_cmp_ge_u32 s18, 5
    s_cselect_b32 s17, s22, s17
    v_maximum3_f32 v130, |v36|, |v37|, |v38|
    v_maximum3_f32 v130, |v39|, v130, v130
    v_maximum3_f32 v130, |v40|, |v41|, v130
    v_maximum3_f32 v130, |v42|, |v43|, v130
    v_maximum3_f32 v130, |v44|, |v45|, v130
    v_maximum3_f32 v130, |v46|, |v47|, v130
    v_maximum3_f32 v131, |v52|, |v53|, |v54|
    v_maximum3_f32 v131, |v55|, v131, v131
    v_maximum3_f32 v131, |v56|, |v57|, v131
    v_maximum3_f32 v131, |v58|, |v59|, v131
    v_maximum3_f32 v131, |v60|, |v61|, v131
    v_maximum3_f32 v131, |v62|, |v63|, v131
    v_min_f32 v132, v130, v131
    v_maximum3_f32 v130, v130, v131, v48
    v_cmp_gt_f32 vcc, 0x08800000, v132
    v_maximum3_f32 v130, v130, v130, v64
    s_cbranch_vccnz L_parallel_sum__grouped_kv_mqa__mixer_gmlp__prompt_slow_78
    v_cmp_ngt_f32 vcc, 0x7b800000, v130
    s_cbranch_vccnz L_parallel_sum__grouped_kv_mqa__mixer_gmlp__prompt_slow_78
L_parallel_sum__grouped_kv_mqa__mixer_gmlp__prompt_afin_77:
    v_add_u32 v130, s16, v101
    v_mov_b32 v65, v125
    v_lshlrev_b32 v132, 3, v1
    v_add_u32 v131, s16, v132
    ds_write_b128 v130, v[52:55]
    ds_write_b128 v130, v[56:59] offset:1024
    ds_write_b128 v130, v[60:63] offset:2048
    ds_write_b64 v131, v[64:65] offset:3072
    v_xor_b32 v133, 16, v127
    v_add_u32 v130, s17, v101
    v_add_u32 v131, s17, v132
    s_waitcnt lgkmcnt(0)
    v_mov_b32_e64 v128, 10
    ds_write_b32 v127, v128
    s_add_u32 s12, s68, 0x00cf0000
    s_addc_u32 s13, s69, 0
    s_mov_b32 s14, 0x005e0000
    s_mov_b32 s15, 0x00020000
L_parallel_sum__grouped_kv_mqa__mixer_gmlp__prompt_spin_79:
    ds_read_b32 v128, v133
    s_waitcnt lgkmcnt(0)
    v_cmp_gt_u32_e64 vcc, 10, v128
    s_cbranch_vccz L_parallel_sum__grouped_kv_mqa__mixer_gmlp__prompt_spun_80
    s_sleep 1
    s_sub_u32 s70, s70, 1
    s_cbranch_scc0 L_parallel_sum__grouped_kv_mqa__mixer_gmlp__prompt_spin_79
L_parallel_sum__grouped_kv_mqa__mixer_gmlp__prompt_spun_80:
    ds_read_b64 v[16:17], v131 offset:3072
    ds_read_b128 v[4:7], v130
    ds_read_b128 v[8:11], v130 offset:1024
    ds_read_b128 v[12:15], v130 offset:2048
    s_lshr_b32 s16, s3, 2
    s_and_b32 s17, s3, 2
    s_add_u32 s16, s16, s17
    s_mul_i32 s16, s16, 5
    v_add_u32 v130, s16, v103
    v_lshrrev_b32 v131, 1, v130
    v_and_b32 v130, 1, v130
    v_lshlrev_b32 v130, 3, v130
    v_lshl_add_u32 v130, v131, 8, v130
    v_and_b32_e64 v131, 15, v102
    v_lshl_add_u32 v130, v131, 4, v130
    v_lshrrev_b32_e64 v131, 4, v102
    v_mul_u32_u24 v131, 2560, v131
    s_and_b32 s16, s3, 1
    s_mul_i32 s16, s16, 5120
    s_add_u32 s16, s16, 41984
    v_add3_u32 v130, v130, v131, s16
    s_waitcnt lgkmcnt(3)
    v_max_f32 v131, v124, v17
    v_sub_f32 v132, v124, v131
    v_sub_f32 v133, v17, v131
    v_cvt_i32_f32 v132, v132
    v_cvt_i32_f32_e64 v133, v133
    v_ldexp_f32 v48, v48, v132
    v_ldexp_f32 v16, v16, v133
    v_add_f32 v134, v48, v16
    v_rcp_f32 v134, v134
    v_ldexp_f32 v36, v36, v132
    v_ldexp_f32 v37, v37, v132
    v_ldexp_f32 v38, v38, v132
    v_ldexp_f32 v39, v39, v132
    v_ldexp_f32 v40, v40, v132
    v_ldexp_f32 v41, v41, v132
    v_ldexp_f32 v42, v42, v132
    v_ldexp_f32 v43, v43, v132
    v_ldexp_f32 v44, v44, v132
    v_ldexp_f32 v45, v45, v132
    v_ldexp_f32 v46, v46, v132
    v_ldexp_f32 v47, v47, v132
    s_waitcnt lgkmcnt(0)
    v_ldexp_f32 v4, v4, v133
    v_ldexp_f32 v5, v5, v133
    v_ldexp_f32 v6, v6, v133
    v_ldexp_f32 v7, v7, v133
    v_ldexp_f32 v8, v8, v133
    v_ldexp_f32 v9, v9, v133
    v_ldexp_f32 v10, v10, v133
    v_ldexp_f32 v11, v11, v133
    v_ldexp_f32 v12, v12, v133
    v_ldexp_f32 v13, v13, v133
    v_ldexp_f32 v14, v14, v133
    v_ldexp_f32 v15, v15, v133
    v_add_f32 v4, v4, v36
    v_add_f32 v5, v5, v37
    v_add_f32 v6, v6, v38
    v_add_f32 v7, v7, v39
    v_add_f32 v8, v8, v40
    v_add_f32 v9, v9, v41
    v_add_f32 v10, v10, v42
    v_add_f32 v11, v11, v43
    v_add_f32 v12, v12, v44
    v_add_f32 v13, v13, v45
    v_add_f32 v14, v14, v46
    v_add_f32 v15, v15, v47
    v_mul_f32 v4, v4, v134
    v_mul_f32 v5, v5, v134
    v_mul_f32 v6, v6, v134
    v_mul_f32 v7, v7, v134
    v_mul_f32 v8, v8, v134
    v_mul_f32 v9, v9, v134
    v_mul_f32 v10, v10, v134
    v_mul_f32 v11, v11, v134
    v_mul_f32 v12, v12, v134
    v_mul_f32 v13, v13, v134
    v_mul_f32 v14, v14, v134
    v_mul_f32_e64 v15, v15, v134
    v_cvt_pk_bf16_f32 v68, v4, v5
    v_cvt_pk_bf16_f32 v69, v6, v7
    v_cvt_pk_bf16_f32 v70, v8, v9
    v_cvt_pk_bf16_f32 v71, v10, v11
    v_cvt_pk_bf16_f32 v72, v12, v13
    v_cvt_pk_bf16_f32 v73, v14, v15
    ds_write_b64 v130, v[68:69]
    ds_write_b64 v130, v[70:71] offset:256
    s_mov_b32 exec_hi, 0
    ds_write_b64 v130, v[72:73] offset:512
    s_mov_b64 exec, 1
    v_mov_b32 v132, 163376
    v_mov_b32 v133, 1
    s_waitcnt lgkmcnt(0)
    ds_add_rtn_u32 v133, v132, v133
    s_waitcnt lgkmcnt(0)
    v_readfirstlane_b32 s16, v133
    s_mov_b64 exec, -1
    s_cmp_eq_u32 s16, 7
    s_cbranch_scc1 L_parallel_sum__grouped_kv_mqa__mixer_gmlp__prompt_last_81
    s_endpgm
L_parallel_sum__grouped_kv_mqa__mixer_gmlp__prompt_last_81:
    v_and_b32 v104, 31, v1
    v_lshlrev_b32 v104, 7, v104
    s_mov_b32 s40, 163840
    buffer_load_dwordx2 v[106:107], v104, s[72:75], s40 offen sc1
    v_add_u32 v130, 41984, v101
    ds_read_b128 v[4:7], v130 offset:0
    ds_read_b128 v[8:11], v130 offset:1024
    ds_read_b128 v[12:15], v130 offset:1536
    ds_read_b128 v[16:19], v130 offset:2560
    ds_read_b128 v[20:23], v130 offset:3584
    ds_read_b128 v[24:27], v130 offset:4096
    ds_read_b128 v[28:31], v130 offset:5120
    ds_read_b128 v[32:35], v130 offset:6144
    ds_read_b128 v[36:39], v130 offset:6656
    ds_read_b128 v[40:43], v130 offset:7680
    ds_read_b128 v[44:47], v130 offset:8704
    ds_read_b128 v[48:51], v130 offset:9216
    s_mul_i32 s16, s98, 192512
    s_mul_i32 s17, s99, 2560
    s_add_u32 s16, s16, s17
    s_waitcnt lgkmcnt(11)
    buffer_store_dwordx4 v[4:7], v101, s[12:15], s16 offen offset:0 sc1
    s_waitcnt lgkmcnt(10)
    buffer_store_dwordx4 v[8:11], v101, s[12:15], s16 offen offset:1024 sc1
    s_waitcnt lgkmcnt(9)
    buffer_store_dwordx4 v[12:15], v101, s[12:15], s16 offen offset:1536 sc1
    s_add_u32 s16, s16, 48128
    s_waitcnt lgkmcnt(8)
    buffer_store_dwordx4 v[16:19], v101, s[12:15], s16 offen offset:0 sc1
    s_waitcnt lgkmcnt(7)
    buffer_store_dwordx4 v[20:23], v101, s[12:15], s16 offen offset:1024 sc1
    s_waitcnt lgkmcnt(6)
    buffer_store_dwordx4 v[24:27], v101, s[12:15], s16 offen offset:1536 sc1
    s_add_u32 s16, s16, 48128
    s_waitcnt lgkmcnt(5)
    buffer_store_dwordx4 v[28:31], v101, s[12:15], s16 offen offset:0 sc1
    s_waitcnt lgkmcnt(4)
    buffer_store_dwordx4 v[32:35], v101, s[12:15], s16 offen offset:1024 sc1
    s_waitcnt lgkmcnt(3)
    buffer_store_dwordx4 v[36:39], v101, s[12:15], s16 offen offset:1536 sc1
    s_add_u32 s16, s16, 48128
    s_waitcnt lgkmcnt(2)
    buffer_store_dwordx4 v[40:43], v101, s[12:15], s16 offen offset:0 sc1
    s_waitcnt lgkmcnt(1)
    buffer_store_dwordx4 v[44:47], v101, s[12:15], s16 offen offset:1024 sc1
    s_waitcnt lgkmcnt(0)
    buffer_store_dwordx4 v[48:51], v101, s[12:15], s16 offen offset:1536 sc1
    s_add_u32 s16, s16, 48128
    s_lshl_b32 s16, s98, 3
    s_add_u32 s16, s16, s99
    s_lshl_b32 s16, s16, 7
    s_add_u32 s16, s16, 98304
    s_waitcnt vmcnt(12)
    v_cmp_ne_u64 vcc, s[96:97], v[106:107]
    s_cbranch_vccz L_parallel_sum__grouped_kv_mqa__mixer_gmlp__prompt_wfok_82
L_parallel_sum__grouped_kv_mqa__mixer_gmlp__prompt_pl_83:
    buffer_load_dwordx2 v[106:107], v104, s[72:75], s40 offen sc1
    s_waitcnt vmcnt(0)
    v_cmp_ne_u64 vcc, s[96:97], v[106:107]
    s_cbranch_vccz L_parallel_sum__grouped_kv_mqa__mixer_gmlp__prompt_pd_84
    s_sleep 4
    s_sub_u32 s70, s70, 1
    s_cbranch_scc0 L_parallel_sum__grouped_kv_mqa__mixer_gmlp__prompt_pl_83
L_parallel_sum__grouped_kv_mqa__mixer_gmlp__prompt_pd_84:
L_parallel_sum__grouped_kv_mqa__mixer_gmlp__prompt_wfok_82:
    s_add_u32 s28, s68, 0x012d0000
    s_addc_u32 s29, s69, 0
    s_mov_b32 s30, 0x001d6000
    s_mov_b32 s31, 0x00020000
    s_lshr_b32 s40, s2, 5
    s_mul_i32 s40, s40, 240640
    v_lshlrev_b32 v104, 4, v1
    s_mov_b32 m0, 0
    s_nop 0
    buffer_load_dwordx4 v104, s[28:31], s40 offen offset:0 sc1 lds
    buffer_load_dwordx4 v104, s[28:31], s40 offen offset:1024 sc1 lds
    buffer_load_dwordx4 v104, s[28:31], s40 offen offset:2048 sc1 lds
    buffer_load_dwordx4 v104, s[28:31], s40 offen offset:3072 sc1 lds
    s_mov_b32 m0, 4096
    s_add_u32 s40, s40, 4096
    buffer_load_dwordx4 v104, s[28:31], s40 offen offset:0 sc1 lds
    buffer_load_dwordx4 v104, s[28:31], s40 offen offset:1024 sc1 lds
    buffer_load_dwordx4 v104, s[28:31], s40 offen offset:2048 sc1 lds
    buffer_load_dwordx4 v104, s[28:31], s40 offen offset:3072 sc1 lds
    s_mov_b32 m0, 8192
    s_add_u32 s40, s40, 4096
    buffer_load_dwordx4 v104, s[28:31], s40 offen offset:0 sc1 lds
    buffer_load_dwordx4 v104, s[28:31], s40 offen offset:1024 sc1 lds
    buffer_load_dwordx4 v104, s[28:31], s40 offen offset:2048 sc1 lds
    buffer_load_dwordx4 v104, s[28:31], s40 offen offset:3072 sc1 lds
    s_waitcnt vmcnt(12)
    v_mov_b32 v132, s96
    v_mov_b32 v133, s97
    v_lshlrev_b32 v134, 3, v1
    s_mov_b64 exec, 0xffff
    buffer_store_dwordx2 v[132:133], v134, s[72:75], s16 offen sc1
    s_mov_b64 exec, -1
    s_mov_b32 m0, 12288
    s_add_u32 s40, s40, 4096
    buffer_load_dwordx4 v104, s[28:31], s40 offen offset:0 sc1 lds
    buffer_load_dwordx4 v104, s[28:31], s40 offen offset:1024 sc1 lds
    buffer_load_dwordx4 v104, s[28:31], s40 offen offset:2048 sc1 lds
    buffer_load_dwordx4 v104, s[28:31], s40 offen offset:3072 sc1 lds
    s_mov_b32 m0, 16384
    s_add_u32 s40, s40, 4096
    buffer_load_dwordx4 v104, s[28:31], s40 offen offset:0 sc1 lds
    buffer_load_dwordx4 v104, s[28:31], s40 offen offset:1024 sc1 lds
    buffer_load_dwordx4 v104, s[28:31], s40 offen offset:2048 sc1 lds
    buffer_load_dwordx4 v104, s[28:31], s40 offen offset:3072 sc1 lds
    s_mov_b32 m0, 20480
    s_add_u32 s40, s40, 4096
    buffer_load_dwordx4 v104, s[28:31], s40 offen offset:0 sc1 lds
    buffer_load_dwordx4 v104, s[28:31], s40 offen offset:1024 sc1 lds
    buffer_load_dwordx4 v104, s[28:31], s40 offen offset:2048 sc1 lds
    buffer_load_dwordx4 v104, s[28:31], s40 offen offset:3072 sc1 lds
    s_mov_b32 m0, 24576
    s_add_u32 s40, s40, 4096
    buffer_load_dwordx4 v104, s[28:31], s40 offen offset:0 sc1 lds
    buffer_load_dwordx4 v104, s[28:31], s40 offen offset:1024 sc1 lds
    buffer_load_dwordx4 v104, s[28:31], s40 offen offset:2048 sc1 lds
    buffer_load_dwordx4 v104, s[28:31], s40 offen offset:3072 sc1 lds
    s_mov_b32 m0, 28672
    s_add_u32 s40, s40, 4096
    buffer_load_dwordx4 v104, s[28:31], s40 offen offset:0 sc1 lds
    buffer_load_dwordx4 v104, s[28:31], s40 offen offset:1024 sc1 lds
    buffer_load_dwordx4 v104, s[28:31], s40 offen offset:2048 sc1 lds
    buffer_load_dwordx4 v104, s[28:31], s40 offen offset:3072 sc1 lds
    s_mov_b32 m0, 32768
    s_add_u32 s40, s40, 4096
    buffer_load_dwordx4 v104, s[28:31], s40 offen offset:0 sc1 lds
    buffer_load_dwordx4 v104, s[28:31], s40 offen offset:1024 sc1 lds
    buffer_load_dwordx4 v104, s[28:31], s40 offen offset:2048 sc1 lds
    buffer_load_dwordx4 v104, s[28:31], s40 offen offset:3072 sc1 lds
    s_mov_b32 m0, 36864
    s_add_u32 s40, s40, 4096
    buffer_load_dwordx4 v104, s[28:31], s40 offen offset:0 sc1 lds
    buffer_load_dwordx4 v104, s[28:31], s40 offen offset:1024 sc1 lds
    buffer_load_dwordx4 v104, s[28:31], s40 offen offset:2048 sc1 lds
    buffer_load_dwordx4 v104, s[28:31], s40 offen offset:3072 sc1 lds
    s_mov_b32 m0, 40960
    s_add_u32 s40, s40, 4096
    buffer_load_dwordx4 v104, s[28:31], s40 offen offset:0 sc1 lds
    buffer_load_dwordx4 v104, s[28:31], s40 offen offset:1024 sc1 lds
    buffer_load_dwordx4 v104, s[28:31], s40 offen offset:2048 sc1 lds
    buffer_load_dwordx4 v104, s[28:31], s40 offen offset:3072 sc1 lds
    s_mov_b32 m0, 45056
    s_add_u32 s40, s40, 4096
    buffer_load_dwordx4 v104, s[28:31], s40 offen offset:0 sc1 lds
    buffer_load_dwordx4 v104, s[28:31], s40 offen offset:1024 sc1 lds
    buffer_load_dwordx4 v104, s[28:31], s40 offen offset:2048 sc1 lds
    buffer_load_dwordx4 v104, s[28:31], s40 offen offset:3072 sc1 lds
    s_mov_b32 m0, 49152
    s_add_u32 s40, s40, 4096
    buffer_load_dwordx4 v104, s[28:31], s40 offen offset:0 sc1 lds
    buffer_load_dwordx4 v104, s[28:31], s40 offen offset:1024 sc1 lds
    buffer_load_dwordx4 v104, s[28:31], s40 offen offset:2048 sc1 lds
    buffer_load_dwordx4 v104, s[28:31], s40 offen offset:3072 sc1 lds
    s_mov_b32 m0, 53248
    s_add_u32 s40, s40, 4096
    buffer_load_dwordx4 v104, s[28:31], s40 offen offset:0 sc1 lds
    buffer_load_dwordx4 v104, s[28:31], s40 offen offset:1024 sc1 lds
    buffer_load_dwordx4 v104, s[28:31], s40 offen offset:2048 sc1 lds
    buffer_load_dwordx4 v104, s[28:31], s40 offen offset:3072 sc1 lds
    s_mov_b32 m0, 57344
    s_add_u32 s40, s40, 4096
    buffer_load_dwordx4 v104, s[28:31], s40 offen offset:0 sc1 lds
    buffer_load_dwordx4 v104, s[28:31], s40 offen offset:1024 sc1 lds
    buffer_load_dwordx4 v104, s[28:31], s40 offen offset:2048 sc1 lds
    buffer_load_dwordx4 v104, s[28:31], s40 offen offset:3072 sc1 lds
    v_mov_b32 v104, 163376
    v_mov_b32 v105, 10
    s_waitcnt vmcnt(0)
    ds_write_b32 v104, v105
    s_endpgm
L_parallel_sum__grouped_kv_mqa__mixer_gmlp__prompt_xs_74:
L_parallel_sum__grouped_kv_mqa__mixer_gmlp__prompt_spin_85:
    ds_read_b32 v128, v126
    s_waitcnt lgkmcnt(0)
    v_cmp_gt_u32 vcc, s16, v128
    s_cbranch_vccz L_parallel_sum__grouped_kv_mqa__mixer_gmlp__prompt_spun_86
    s_sleep 1
    s_sub_u32 s70, s70, 1
    s_cbranch_scc0 L_parallel_sum__grouped_kv_mqa__mixer_gmlp__prompt_spin_85
L_parallel_sum__grouped_kv_mqa__mixer_gmlp__prompt_spun_86:
    s_branch L_parallel_sum__grouped_kv_mqa__mixer_gmlp__prompt_xd_75
L_parallel_sum__grouped_kv_mqa__mixer_gmlp__prompt_rin2_66:
    s_mov_b32 s23, 0
    s_branch L_parallel_sum__grouped_kv_mqa__mixer_gmlp__prompt_rare_87
L_parallel_sum__grouped_kv_mqa__mixer_gmlp__prompt_rin6_67:
    s_mov_b32 s23, 1
L_parallel_sum__grouped_kv_mqa__mixer_gmlp__prompt_rare_87:
    s_nop 7
    s_nop 3
    v_frexp_exp_i32_f32 v133, v48
    v_add_u32 v133, 100, v133
    v_max_i32 v133, 0, v133
    v_cvt_f32_i32 v134, v133
    v_add_f32 v135, v124, v134
    v_sub_f32 v134, v135, v124
    v_mov_b32 v124, v135
    v_cvt_i32_f32 v133, v134
    v_sub_u32 v133, 0, v133
    v_ldexp_f32 v36, v36, v133
    v_ldexp_f32 v37, v37, v133
    v_ldexp_f32 v38, v38, v133
    v_ldexp_f32 v39, v39, v133
    v_ldexp_f32 v40, v40, v133
    v_ldexp_f32 v41, v41, v133
    v_ldexp_f32 v42, v42, v133
    v_ldexp_f32 v43, v43, v133
    v_ldexp_f32 v44, v44, v133
    v_ldexp_f32 v45, v45, v133
    v_ldexp_f32 v46, v46, v133
    v_ldexp_f32 v47, v47, v133
    v_ldexp_f32 v48, v48, v133
    v_ldexp_f32 v49, v49, v133
    v_ldexp_f32 v50, v50, v133
    v_ldexp_f32 v51, v51, v133
    v_sub_f32 v4, v4, v134
    v_sub_f32 v5, v5, v134
    v_sub_f32 v6, v6, v134
    v_sub_f32 v7, v7, v134
    v_sub_f32 v8, v8, v134
    v_sub_f32 v9, v9, v134
    v_sub_f32 v10, v10, v134
    v_sub_f32 v11, v11, v134
    v_sub_f32 v12, v12, v134
    v_sub_f32 v13, v13, v134
    v_sub_f32 v14, v14, v134
    v_sub_f32 v15, v15, v134
    v_sub_f32 v16, v16, v134
    v_sub_f32 v17, v17, v134
    v_sub_f32 v18, v18, v134
    v_sub_f32 v19, v19, v134
    v_sub_f32 v130, 0, v124
    v_and_b32 v131, s24, v130
    v_sub_f32 v130, v130, v131
    v_and_b32 v132, s24, v130
    v_sub_f32 v130, v130, v132
    v_lshrrev_b32 v131, 16, v131
    v_or_b32 v131, v131, v132
    v_cmp_eq_u32 vcc, 0, v103
    v_lshrrev_b32 v130, 16, v130
    s_nop 0
    v_cndmask_b32_e64 v121, v130, v131, vcc
    s_nop 1
    s_cmp_eq_u32 s23, 0
    s_cbranch_scc1 L_parallel_sum__grouped_kv_mqa__mixer_gmlp__prompt_rback2_70
    s_branch L_parallel_sum__grouped_kv_mqa__mixer_gmlp__prompt_rback6_71
L_parallel_sum__grouped_kv_mqa__mixer_gmlp__prompt_rin3_68:
    s_mov_b32 s23, 0
    s_branch L_parallel_sum__grouped_kv_mqa__mixer_gmlp__prompt_rare_88
L_parallel_sum__grouped_kv_mqa__mixer_gmlp__prompt_rin7_69:
    s_mov_b32 s23, 1
L_parallel_sum__grouped_kv_mqa__mixer_gmlp__prompt_rare_88:
    s_nop 7
    s_nop 3
    v_frexp_exp_i32_f32 v133, v64
    v_add_u32 v133, 100, v133
    v_max_i32 v133, 0, v133
    v_cvt_f32_i32 v134, v133
    v_add_f32 v135, v125, v134
    v_sub_f32 v134, v135, v125
    v_mov_b32 v125, v135
    v_cvt_i32_f32 v133, v134
    v_sub_u32_e64 v133, 0, v133
    v_ldexp_f32 v52, v52, v133
    v_ldexp_f32 v53, v53, v133
    v_ldexp_f32 v54, v54, v133
    v_ldexp_f32 v55, v55, v133
    v_ldexp_f32 v56, v56, v133
    v_ldexp_f32 v57, v57, v133
    v_ldexp_f32 v58, v58, v133
    v_ldexp_f32 v59, v59, v133
    v_ldexp_f32 v60, v60, v133
    v_ldexp_f32 v61, v61, v133
    v_ldexp_f32 v62, v62, v133
    v_ldexp_f32 v63, v63, v133
    v_ldexp_f32 v64, v64, v133
    v_ldexp_f32 v65, v65, v133
    v_ldexp_f32 v66, v66, v133
    v_ldexp_f32 v67, v67, v133
    v_sub_f32 v20, v20, v134
    v_sub_f32 v21, v21, v134
    v_sub_f32 v22, v22, v134
    v_sub_f32 v23, v23, v134
    v_sub_f32 v24, v24, v134
    v_sub_f32 v25, v25, v134
    v_sub_f32 v26, v26, v134
    v_sub_f32 v27, v27, v134
    v_sub_f32 v28, v28, v134
    v_sub_f32 v29, v29, v134
    v_sub_f32 v30, v30, v134
    v_sub_f32 v31, v31, v134
    v_sub_f32 v32, v32, v134
    v_sub_f32 v33, v33, v134
    v_sub_f32 v34, v34, v134
    v_sub_f32 v35, v35, v134
    v_sub_f32 v130, 0, v125
    v_and_b32 v131, s24, v130
    v_sub_f32 v130, v130, v131
    v_and_b32 v132, s24, v130
    v_sub_f32 v130, v130, v132
    v_lshrrev_b32 v131, 16, v131
    v_or_b32 v131, v131, v132
    v_cmp_eq_u32 vcc, 0, v103
    v_lshrrev_b32 v130, 16, v130
    s_nop 0
    v_cndmask_b32 v123, v130, v131, vcc
    s_nop 1
    s_cmp_eq_u32 s23, 0
    s_cbranch_scc1 L_parallel_sum__grouped_kv_mqa__mixer_gmlp__prompt_rback3_72
    s_branch L_parallel_sum__grouped_kv_mqa__mixer_gmlp__prompt_rback7_73
L_parallel_sum__grouped_kv_mqa__mixer_gmlp__prompt_slow_78:
    v_add_u32 v98, 0, v101
    v_lshlrev_b32 v99, 2, v1
    v_add_u32 v99, 0, v99
    v_min_u32 v100, 20, v102
    v_lshlrev_b32 v100, 4, v100
    v_mul_u32_u24 v130, 336, v103
    v_add_u32 v100, v100, v130
    v_add_u32 v100, 0, v100
    v_mov_b32 v121, 0
    v_mov_b32 v123, 0
    v_mov_b32 v124, 0xff7fffff
    v_mov_b32 v125, 0xff7fffff
    s_lshr_b32 s19, s3, 2
    s_mul_i32 s19, s19, 2688
    s_mov_b32 s20, s19
L_parallel_sum__grouped_kv_mqa__mixer_gmlp__prompt_p1_89:
    buffer_load_dwordx4 v[84:87], v98, s[8:11], s20 offen offset:0 sc1
    buffer_load_dword v96, v99, s[8:11], s20 offen offset:1024 sc1
    s_waitcnt vmcnt(0)
    v_mfma_f32_32x32x16_bf16 v[4:19], v[84:87], v[112:115], 0
    v_mfma_f32_32x32x8_bf16 v[4:19], v[96:97], v[120:121], v[4:19]
    v_mfma_f32_32x32x16_bf16 v[20:35], v[84:87], v[116:119], 0
    v_mfma_f32_32x32x8_bf16 v[20:35], v[96:97], v[122:123], v[20:35]
    s_nop 7
    s_nop 3
    v_max3_f32 v124, v124, v4, v5
    v_max3_f32 v124, v124, v6, v7
    v_max3_f32 v124, v124, v8, v9
    v_max3_f32 v124, v124, v10, v11
    v_max3_f32 v124, v124, v12, v13
    v_max3_f32 v124, v124, v14, v15
    v_max3_f32 v124, v124, v16, v17
    v_max3_f32 v124, v124, v18, v19
    v_max3_f32 v125, v125, v20, v21
    v_max3_f32 v125, v125, v22, v23
    v_max3_f32 v125, v125, v24, v25
    v_max3_f32 v125, v125, v26, v27
    v_max3_f32 v125, v125, v28, v29
    v_max3_f32 v125, v125, v30, v31
    v_max3_f32 v125, v125, v32, v33
    v_max3_f32 v125, v125, v34, v35
    s_add_u32 s20, s20, 5376
    s_cmp_lt_u32 s20, 172032
    s_cbranch_scc1 L_parallel_sum__grouped_kv_mqa__mixer_gmlp__prompt_p1_89
    v_mov_b32 v130, v124
    v_mov_b32 v131, v125
    s_nop 0
    v_permlane32_swap_b32 v124, v130
    v_permlane32_swap_b32 v125, v131
    v_max_f32 v124, v124, v130
    v_ceil_f32 v124, v124
    v_max_f32 v125, v125, v131
    v_ceil_f32 v125, v125
    v_sub_f32 v130, 0, v124
    v_and_b32 v131, s24, v130
    v_sub_f32 v130, v130, v131
    v_and_b32 v132, s24, v130
    v_sub_f32 v130, v130, v132
    v_lshrrev_b32 v131, 16, v131
    v_or_b32 v131, v131, v132
    v_cmp_eq_u32 vcc, 0, v103
    v_lshrrev_b32 v130, 16, v130
    s_nop 0
    v_cndmask_b32 v121, v130, v131, vcc
    s_nop 1
    v_sub_f32 v130, 0, v125
    v_and_b32 v131, s24, v130
    v_sub_f32 v130, v130, v131
    v_and_b32 v132, s24, v130
    v_sub_f32 v130, v130, v132
    v_lshrrev_b32 v131, 16, v131
    v_or_b32 v131, v131, v132
    v_cmp_eq_u32 vcc, 0, v103
    v_lshrrev_b32 v130, 16, v130
    s_nop 0
    v_cndmask_b32 v123, v130, v131, vcc
    s_nop 1
    v_mov_b32 v36, 0
    v_mov_b32 v37, 0
    v_mov_b32 v38, 0
    v_mov_b32 v39, 0
    v_mov_b32 v40, 0
    v_mov_b32 v41, 0
    v_mov_b32 v42, 0
    v_mov_b32 v43, 0
    v_mov_b32 v44, 0
    v_mov_b32 v45, 0
    v_mov_b32 v46, 0
    v_mov_b32 v47, 0
    v_mov_b32 v48, 0
    v_mov_b32 v49, 0
    v_mov_b32 v50, 0
    v_mov_b32 v51, 0
    v_mov_b32 v52, 0
    v_mov_b32 v53, 0
    v_mov_b32 v54, 0
    v_mov_b32 v55, 0
    v_mov_b32 v56, 0
    v_mov_b32 v57, 0
    v_mov_b32 v58, 0
    v_mov_b32 v59, 0
    v_mov_b32 v60, 0
    v_mov_b32 v61, 0
    v_mov_b32 v62, 0
    v_mov_b32 v63, 0
    v_mov_b32 v64, 0
    v_mov_b32 v65, 0
    v_mov_b32 v66, 0
    v_mov_b32 v67, 0
    s_mov_b32 s20, s19
L_parallel_sum__grouped_kv_mqa__mixer_gmlp__prompt_p2_90:
    buffer_load_dwordx4 v[84:87], v98, s[8:11], s20 offen offset:0 sc1
    buffer_load_dword v96, v99, s[8:11], s20 offen offset:1024 sc1
    buffer_load_dwordx4 v[88:91], v100, s[8:11], s20 offen offset:1280 sc1
    buffer_load_dwordx4 v[92:95], v100, s[8:11], s20 offen offset:1952 sc1
    s_waitcnt vmcnt(0)
    v_mfma_f32_32x32x16_bf16 v[4:19], v[84:87], v[112:115], 0
    v_mfma_f32_32x32x8_bf16 v[4:19], v[96:97], v[120:121], v[4:19]
    v_mfma_f32_32x32x16_bf16 v[20:35], v[84:87], v[116:119], 0
    v_mfma_f32_32x32x8_bf16 v[20:35], v[96:97], v[122:123], v[20:35]
    s_nop 7
    s_nop 3
    v_exp_f32 v4, v4
    v_exp_f32 v5, v5
    v_exp_f32 v6, v6
    v_exp_f32 v7, v7
    v_exp_f32 v8, v8
    v_exp_f32 v9, v9
    v_exp_f32 v10, v10
    v_exp_f32 v11, v11
    v_exp_f32 v12, v12
    v_exp_f32 v13, v13
    v_exp_f32 v14, v14
    v_exp_f32 v15, v15
    v_exp_f32 v16, v16
    v_exp_f32 v17, v17
    v_exp_f32 v18, v18
    v_exp_f32 v19, v19
    v_exp_f32 v20, v20
    v_exp_f32 v21, v21
    v_exp_f32 v22, v22
    v_exp_f32 v23, v23
    v_exp_f32 v24, v24
    v_exp_f32 v25, v25
    v_exp_f32 v26, v26
    v_exp_f32 v27, v27
    v_exp_f32 v28, v28
    v_exp_f32 v29, v29
    v_exp_f32 v30, v30
    v_exp_f32 v31, v31
    v_exp_f32 v32, v32
    v_exp_f32 v33, v33
    v_exp_f32 v34, v34
    v_exp_f32 v35, v35
    s_nop 0
    v_cvt_pk_bf16_f32 v68, v4, v5
    v_cvt_pk_bf16_f32 v69, v6, v7
    v_cvt_pk_bf16_f32 v70, v8, v9
    v_cvt_pk_bf16_f32 v71, v10, v11
    v_cvt_pk_bf16_f32 v72, v12, v13
    v_cvt_pk_bf16_f32 v73, v14, v15
    v_cvt_pk_bf16_f32 v74, v16, v17
    v_cvt_pk_bf16_f32 v75, v18, v19
    v_cvt_pk_bf16_f32 v76, v20, v21
    v_cvt_pk_bf16_f32 v77, v22, v23
    v_cvt_pk_bf16_f32 v78, v24, v25
    v_cvt_pk_bf16_f32 v79, v26, v27
    v_cvt_pk_bf16_f32 v80, v28, v29
    v_cvt_pk_bf16_f32 v81, v30, v31
    v_cvt_pk_bf16_f32 v82, v32, v33
    v_cvt_pk_bf16_f32 v83, v34, v35
    s_nop 1
    v_mfma_f32_32x32x16_bf16 v[36:51], v[88:91], v[68:71], v[36:51]
    v_mfma_f32_32x32x16_bf16 v[36:51], v[92:95], v[72:75], v[36:51]
    v_mfma_f32_32x32x16_bf16 v[52:67], v[88:91], v[76:79], v[52:67]
    v_mfma_f32_32x32x16_bf16 v[52:67], v[92:95], v[80:83], v[52:67]
    s_add_u32 s20, s20, 5376
    s_cmp_lt_u32 s20, 172032
    s_cbranch_scc1 L_parallel_sum__grouped_kv_mqa__mixer_gmlp__prompt_p2_90
    s_nop 7
    s_nop 3
    s_branch L_parallel_sum__grouped_kv_mqa__mixer_gmlp__prompt_afin_77
L_parallel_sum__grouped_kv_mqa__mixer_gmlp__prompt_gem_2:
    s_setprio 3
    s_sub_u32 s20, s3, 8
    v_lshrrev_b32 v144, 3, v1
    v_and_b32_e64 v145, 7, v1
    s_lshl_b32 s32, s6, 2
    s_add_u32 s32, s32, s20
    s_mul_i32 s23, s32, 40960
    s_lshl_b32 s26, s20, 12
    s_add_u32 s26, s26, 62976
    s_lshl_b32 s27, s20, 11
    s_add_u32 s27, s27, 112128
    v_lshrrev_b32 v144, 3, v1
    v_and_b32 v145, 7, v1
    v_add_u32_e64 v146, 0, v144
    v_bfe_u32 v147, v146, 1, 3
    v_xor_b32_e64 v147, v147, v145
    v_mul_u32_u24 v146, 1280, v146
    v_lshl_add_u32 v104, v147, 4, v146
    v_add_u32_e64 v146, 8, v144
    v_bfe_u32 v147, v146, 1, 3
    v_xor_b32_e64 v147, v147, v145
    v_mul_u32_u24 v146, 1280, v146
    v_lshl_add_u32 v105, v147, 4, v146
    v_subrev_u32 v105, 1024, v105
    s_mov_b32 s8, s44
    s_mov_b32 s9, s45
    s_mov_b32 s10, 0x00280000
    s_mov_b32 s11, 0x00020000
    s_lshl_b32 s23, s98, 2
    s_add_u32 s23, s23, s20
    s_mul_i32 s23, s23, 20480
    s_lshl_b32 s29, s20, 11
    s_add_u32 s29, s29, 20992
    s_mov_b32 s36, 0
    s_lshl_b32 s22, s36, 7
    s_add_u32 m0, s29, 0
    s_add_u32 s22, s23, s22
    buffer_load_dwordx4 v104, s[8:11], s22 offen offset:0 lds
    buffer_load_dwordx4 v105, s[8:11], s22 offen offset:1024 lds
    s_cmp_eq_u32 s99, 7
    s_cbranch_scc1 L_parallel_sum__grouped_kv_mqa__mixer_gmlp__prompt_rep_91
    v_add_u32 v144, 0, v1
    v_mul_u32_u24 v145, 5462, v144
    v_lshrrev_b32 v145, 16, v145
    v_mul_u32_u24 v146, 12, v145
    v_sub_u32_e64 v146, v144, v146
    v_mul_u32_u24 v145, 1280, v145
    v_lshl_add_u32 v106, v146, 4, v145
    v_add_u32_e64 v144, 64, v1
    v_mul_u32_u24 v145, 5462, v144
    v_lshrrev_b32 v145, 16, v145
    v_mul_u32_u24 v146, 12, v145
    v_sub_u32_e64 v146, v144, v146
    v_mul_u32_u24 v145, 1280, v145
    v_lshl_add_u32 v107, v146, 4, v145
    v_subrev_u32 v107, 1024, v107
    v_add_u32 v144, 128, v1
    v_mul_u32_u24 v145, 5462, v144
    v_lshrrev_b32 v145, 16, v145
    v_mul_u32_u24 v146, 12, v145
    v_sub_u32_e64 v146, v144, v146
    v_mul_u32_u24 v145, 1280, v145
    v_lshl_add_u32 v108, v146, 4, v145
    v_subrev_u32 v108, 2048, v108
    s_mov_b32 s12, s46
    s_mov_b32 s13, s47
    s_mov_b32 s14, 0x000c8000
    s_mov_b32 s15, 0x00020000
    s_mul_i32 s24, s20, 20480
    s_mul_i32 s32, s99, 160
    s_and_b32 s32, s32, 0xffffffc0
    s_add_u32 s24, s24, s32
    s_mov_b32 s25, 81920
    s_mul_i32 s30, s20, 3072
    s_add_u32 s30, s30, 29184
    s_mul_i32 s22, s36, s25
    s_add_u32 m0, s30, 0
    s_add_u32 s22, s22, s24
    buffer_load_dwordx4 v106, s[12:15], s22 offen offset:0 lds
    buffer_load_dwordx4 v107, s[12:15], s22 offen offset:1024 lds
    buffer_load_dwordx4 v108, s[12:15], s22 offen offset:2048 lds
    s_add_u32 s36, s36, 1
    s_cmp_eq_u32 s36, 10
    s_cmov_b32 s36, 0
    s_lshl_b32 s22, s36, 7
    s_add_u32 m0, s29, 20480
    s_add_u32 s22, s23, s22
    buffer_load_dwordx4 v104, s[8:11], s22 offen offset:0 lds
    buffer_load_dwordx4 v105, s[8:11], s22 offen offset:1024 lds
    s_mul_i32 s22, s36, s25
    s_add_u32 m0, s30, 20480
    s_add_u32 s22, s22, s24
    buffer_load_dwordx4 v106, s[12:15], s22 offen offset:0 lds
    buffer_load_dwordx4 v107, s[12:15], s22 offen offset:1024 lds
    buffer_load_dwordx4 v108, s[12:15], s22 offen offset:2048 lds
    s_add_u32 s36, s36, 1
    s_cmp_eq_u32 s36, 10
    s_cmov_b32 s36, 0
    s_lshl_b32 s22, s36, 7
    s_add_u32 m0, s29, 40960
    s_add_u32 s22, s23, s22
    buffer_load_dwordx4 v104, s[8:11], s22 offen offset:0 lds
    buffer_load_dwordx4 v105, s[8:11], s22 offen offset:1024 lds
    s_mul_i32 s22, s36, s25
    s_add_u32 m0, s30, 40960
    s_add_u32 s22, s22, s24
    buffer_load_dwordx4 v106, s[12:15], s22 offen offset:0 lds
    buffer_load_dwordx4 v107, s[12:15], s22 offen offset:1024 lds
    buffer_load_dwordx4 v108, s[12:15], s22 offen offset:2048 lds
    s_add_u32 s36, s36, 1
    s_cmp_eq_u32 s36, 10
    s_cmov_b32 s36, 0
    s_lshl_b32 s22, s36, 7
    s_add_u32 m0, s29, 61440
    s_add_u32 s22, s23, s22
    buffer_load_dwordx4 v104, s[8:11], s22 offen offset:0 lds
    buffer_load_dwordx4 v105, s[8:11], s22 offen offset:1024 lds
    s_mul_i32 s22, s36, s25
    s_add_u32 m0, s30, 61440
    s_add_u32 s22, s22, s24
    buffer_load_dwordx4 v106, s[12:15], s22 offen offset:0 lds
    buffer_load_dwordx4 v107, s[12:15], s22 offen offset:1024 lds
    buffer_load_dwordx4 v108, s[12:15], s22 offen offset:2048 lds
    s_add_u32 s36, s36, 1
    s_cmp_eq_u32 s36, 10
    s_cmov_b32 s36, 0
    s_lshl_b32 s33, s20, 2
    s_add_u32 s34, s33, 163360
    v_mov_b32 v2, s34
    s_add_u32 s34, s33, 163392
    v_mov_b32 v5, s34
    v_and_b32 v3, 3, v1
    v_lshlrev_b32_e64 v3, 2, v3
    v_add_u32 v6, 163392, v3
    v_lshlrev_b32_e64 v3, 6, v3
    v_add_u32 v3, 161280, v3
    v_mov_b32 v137, 0
    s_lshl_b32 s31, s20, 8
    s_lshl_b32 s71, s2, 10
    s_add_u32 s71, s71, s31
    s_add_u32 s31, s31, 161280
    v_and_b32 v134, 31, v1
    v_lshrrev_b32 v135, 5, v1
    s_mov_b32 s28, 0xffff0000
    s_mov_b32 s21, 0
    v_mov_b32 v7, 1
    v_mov_b32 v140, 0x3f803f80
    v_mov_b32 v141, 0x3f803f80
    s_lshl_b32 s33, s6, 7
    s_lshl_b32 s34, s20, 5
    s_add_u32 s33, s33, s34
    v_add_u32 v136, s33, v134
    v_bfe_u32 v145, v1, 1, 3
    v_lshrrev_b32 v146, 4, v1
    v_xor_b32 v145, v145, v146
    v_and_b32 v146, 15, v1
    v_lshlrev_b32 v146, 7, v146
    v_add_u32_e64 v146, s26, v146
    v_lshl_add_u32 v126, v145, 4, v146
    v_xor_b32_e64 v145, 4, v145
    v_lshl_add_u32 v127, v145, 4, v146
    s_add_u32 s40, s68, 0x00600000
    s_addc_u32 s41, s69, 0
    s_mov_b32 s42, 0x00040000
    s_mov_b32 s43, 0x00020000
    v_lshlrev_b32 v145, 2, v1
    buffer_store_dword v1, v145, s[40:43], s71 offen sc1
    s_waitcnt lgkmcnt(0)
    s_add_u32 s96, s96, 1
    v_bfe_u32 v144, v1, 2, 2
    v_lshrrev_b32_e64 v145, 4, v1
    v_lshl_add_u32 v144, v145, 3, v144
    v_lshlrev_b32 v144, 7, v144
    v_and_b32 v145, 3, v1
    v_lshl_add_u32 v144, v145, 3, v144
    v_add_u32 v144, 112128, v144
    v_bfe_u32 v145, v1, 3, 2
    v_xor_b32_e64 v146, 0, v145
    v_lshl_add_u32 v128, v146, 5, v144
    v_xor_b32_e64 v146, 1, v145
    v_lshl_add_u32 v129, v146, 5, v144
    v_xor_b32_e64 v146, 2, v145
    v_lshl_add_u32 v130, v146, 5, v144
    v_xor_b32_e64 v146, 3, v145
    v_lshl_add_u32 v131, v146, 5, v144
    v_lshrrev_b32 v144, 3, v1
    v_and_b32 v145, 7, v1
    v_bfe_u32 v146, v1, 4, 1
    v_lshlrev_b32 v146, 1, v146
    v_xor_b32 v145, v145, v146
    v_mul_u32_u24 v144, 3456, v144
    v_lshl_add_u32 v124, v145, 4, v144
    v_xor_b32_e64 v145, 4, v145
    v_lshl_add_u32 v125, v145, 4, v144
    v_add_u32 v125, 26624, v125
    v_lshrrev_b32 v144, 3, v1
    v_and_b32 v145, 7, v1
    v_add_u32_e64 v146, 0, v144
    v_bfe_u32 v147, v146, 1, 3
    v_xor_b32_e64 v147, v147, v145
    v_mul_u32_u24 v146, 1280, v146
    v_lshl_add_u32 v120, v147, 4, v146
    v_add_u32_e64 v146, 8, v144
    v_bfe_u32 v147, v146, 1, 3
    v_xor_b32_e64 v147, v147, v145
    v_mul_u32_u24 v146, 1280, v146
    v_lshl_add_u32 v121, v147, 4, v146
    v_subrev_u32 v121, 1024, v121
    v_add_u32_e64 v146, 16, v144
    v_bfe_u32 v147, v146, 1, 3
    v_xor_b32_e64 v147, v147, v145
    v_mul_u32_u24 v146, 1280, v146
    v_lshl_add_u32 v122, v147, 4, v146
    v_subrev_u32 v122, 2048, v122
    v_add_u32_e64 v146, 24, v144
    v_bfe_u32 v147, v146, 1, 3
    v_xor_b32_e64 v147, v147, v145
    v_mul_u32_u24 v146, 1280, v146
    v_lshl_add_u32 v123, v147, 4, v146
    v_subrev_u32 v123, 3072, v123
    v_lshl_add_u32 v110, v1, 4, s29
    v_add_u32 v111, 61440, v110
    v_mov_b32 v64, 0
    v_mov_b32 v65, 0
    v_mov_b32 v66, 0
    v_mov_b32 v67, 0
    v_mov_b32 v68, 0
    v_mov_b32 v69, 0
    v_mov_b32 v70, 0
    v_mov_b32 v71, 0
    v_mov_b32 v72, 0
    v_mov_b32 v73, 0
    v_mov_b32 v74, 0
    v_mov_b32 v75, 0
    v_mov_b32 v76, 0
    v_mov_b32 v77, 0
    v_mov_b32 v78, 0
    v_mov_b32 v79, 0
    s_waitcnt vmcnt(10)
    s_barrier
    ds_read_b128 v[40:43], v110 offset:0
    ds_read_b128 v[44:47], v110 offset:1024
    s_lshl_b32 s22, s36, 7
    s_add_u32 m0, s29, 81920
    s_add_u32 s22, s23, s22
    buffer_load_dwordx4 v104, s[8:11], s22 offen offset:0 lds
    buffer_load_dwordx4 v105, s[8:11], s22 offen offset:1024 lds
    s_mul_i32 s22, s36, s25
    s_add_u32 m0, s30, 81920
    s_add_u32 s22, s22, s24
    buffer_load_dwordx4 v106, s[12:15], s22 offen offset:0 lds
    buffer_load_dwordx4 v107, s[12:15], s22 offen offset:1024 lds
    buffer_load_dwordx4 v108, s[12:15], s22 offen offset:2048 lds
    s_add_u32 s36, s36, 1
    s_cmp_eq_u32 s36, 10
    s_cmov_b32 s36, 0
    s_waitcnt lgkmcnt(0)
    v_mfma_f32_4x4x4_16b_bf16 v[64:67], v[140:141], v[40:41], v[64:67]
    v_mfma_f32_4x4x4_16b_bf16 v[68:71], v[40:41], v[40:41], v[68:71]
    v_mfma_f32_4x4x4_16b_bf16 v[72:75], v[140:141], v[44:45], v[72:75]
    v_mfma_f32_4x4x4_16b_bf16 v[76:79], v[44:45], v[44:45], v[76:79]
    v_mfma_f32_4x4x4_16b_bf16 v[64:67], v[140:141], v[42:43], v[64:67]
    v_mfma_f32_4x4x4_16b_bf16 v[68:71], v[42:43], v[42:43], v[68:71]
    v_mfma_f32_4x4x4_16b_bf16 v[72:75], v[140:141], v[46:47], v[72:75]
    v_mfma_f32_4x4x4_16b_bf16 v[76:79], v[46:47], v[46:47], v[76:79]
    ds_read_b128 v[40:43], v110 offset:20480
    ds_read_b128 v[44:47], v110 offset:21504
    s_lshl_b32 s22, s36, 7
    s_add_u32 m0, s29, 102400
    s_add_u32 s22, s23, s22
    buffer_load_dwordx4 v104, s[8:11], s22 offen offset:0 lds
    buffer_load_dwordx4 v105, s[8:11], s22 offen offset:1024 lds
    s_mul_i32 s22, s36, s25
    s_add_u32 m0, s30, 102400
    s_add_u32 s22, s22, s24
    buffer_load_dwordx4 v106, s[12:15], s22 offen offset:0 lds
    buffer_load_dwordx4 v107, s[12:15], s22 offen offset:1024 lds
    buffer_load_dwordx4 v108, s[12:15], s22 offen offset:2048 lds
    s_add_u32 s36, s36, 1
    s_cmp_eq_u32 s36, 10
    s_cmov_b32 s36, 0
    s_waitcnt lgkmcnt(0)
    v_mfma_f32_4x4x4_16b_bf16 v[64:67], v[140:141], v[40:41], v[64:67]
    v_mfma_f32_4x4x4_16b_bf16 v[68:71], v[40:41], v[40:41], v[68:71]
    v_mfma_f32_4x4x4_16b_bf16 v[72:75], v[140:141], v[44:45], v[72:75]
    v_mfma_f32_4x4x4_16b_bf16 v[76:79], v[44:45], v[44:45], v[76:79]
    v_mfma_f32_4x4x4_16b_bf16 v[64:67], v[140:141], v[42:43], v[64:67]
    v_mfma_f32_4x4x4_16b_bf16 v[68:71], v[42:43], v[42:43], v[68:71]
    v_mfma_f32_4x4x4_16b_bf16 v[72:75], v[140:141], v[46:47], v[72:75]
    v_mfma_f32_4x4x4_16b_bf16 v[76:79], v[46:47], v[46:47], v[76:79]
    s_waitcnt vmcnt(10)
    s_barrier
    ds_read_b128 v[40:43], v110 offset:40960
    ds_read_b128 v[44:47], v110 offset:41984
    s_lshl_b32 s22, s36, 7
    s_add_u32 m0, s29, 0
    s_add_u32 s22, s23, s22
    buffer_load_dwordx4 v104, s[8:11], s22 offen offset:0 lds
    buffer_load_dwordx4 v105, s[8:11], s22 offen offset:1024 lds
    s_mul_i32 s22, s36, s25
    s_add_u32 m0, s30, 0
    s_add_u32 s22, s22, s24
    buffer_load_dwordx4 v106, s[12:15], s22 offen offset:0 lds
    buffer_load_dwordx4 v107, s[12:15], s22 offen offset:1024 lds
    buffer_load_dwordx4 v108, s[12:15], s22 offen offset:2048 lds
    s_add_u32 s36, s36, 1
    s_cmp_eq_u32 s36, 10
    s_cmov_b32 s36, 0
    s_waitcnt lgkmcnt(0)
    v_mfma_f32_4x4x4_16b_bf16 v[64:67], v[140:141], v[40:41], v[64:67]
    v_mfma_f32_4x4x4_16b_bf16 v[68:71], v[40:41], v[40:41], v[68:71]
    v_mfma_f32_4x4x4_16b_bf16 v[72:75], v[140:141], v[44:45], v[72:75]
    v_mfma_f32_4x4x4_16b_bf16 v[76:79], v[44:45], v[44:45], v[76:79]
    v_mfma_f32_4x4x4_16b_bf16 v[64:67], v[140:141], v[42:43], v[64:67]
    v_mfma_f32_4x4x4_16b_bf16 v[68:71], v[42:43], v[42:43], v[68:71]
    v_mfma_f32_4x4x4_16b_bf16 v[72:75], v[140:141], v[46:47], v[72:75]
    v_mfma_f32_4x4x4_16b_bf16 v[76:79], v[46:47], v[46:47], v[76:79]
    ds_read_b128 v[40:43], v111 offset:0
    ds_read_b128 v[44:47], v111 offset:1024
    s_lshl_b32 s22, s36, 7
    s_add_u32 m0, s29, 20480
    s_add_u32 s22, s23, s22
    buffer_load_dwordx4 v104, s[8:11], s22 offen offset:0 lds
    buffer_load_dwordx4 v105, s[8:11], s22 offen offset:1024 lds
    s_mul_i32 s22, s36, s25
    s_add_u32 m0, s30, 20480
    s_add_u32 s22, s22, s24
    buffer_load_dwordx4 v106, s[12:15], s22 offen offset:0 lds
    buffer_load_dwordx4 v107, s[12:15], s22 offen offset:1024 lds
    buffer_load_dwordx4 v108, s[12:15], s22 offen offset:2048 lds
    s_add_u32 s36, s36, 1
    s_cmp_eq_u32 s36, 10
    s_cmov_b32 s36, 0
    s_waitcnt lgkmcnt(0)
    v_mfma_f32_4x4x4_16b_bf16 v[64:67], v[140:141], v[40:41], v[64:67]
    v_mfma_f32_4x4x4_16b_bf16 v[68:71], v[40:41], v[40:41], v[68:71]
    v_mfma_f32_4x4x4_16b_bf16 v[72:75], v[140:141], v[44:45], v[72:75]
    v_mfma_f32_4x4x4_16b_bf16 v[76:79], v[44:45], v[44:45], v[76:79]
    v_mfma_f32_4x4x4_16b_bf16 v[64:67], v[140:141], v[42:43], v[64:67]
    v_mfma_f32_4x4x4_16b_bf16 v[68:71], v[42:43], v[42:43], v[68:71]
    v_mfma_f32_4x4x4_16b_bf16 v[72:75], v[140:141], v[46:47], v[72:75]
    v_mfma_f32_4x4x4_16b_bf16 v[76:79], v[46:47], v[46:47], v[76:79]
    s_waitcnt vmcnt(10)
    s_barrier
    ds_read_b128 v[40:43], v111 offset:20480
    ds_read_b128 v[44:47], v111 offset:21504
    s_lshl_b32 s22, s36, 7
    s_add_u32 m0, s29, 40960
    s_add_u32 s22, s23, s22
    buffer_load_dwordx4 v104, s[8:11], s22 offen offset:0 lds
    buffer_load_dwordx4 v105, s[8:11], s22 offen offset:1024 lds
    s_mul_i32 s22, s36, s25
    s_add_u32 m0, s30, 40960
    s_add_u32 s22, s22, s24
    buffer_load_dwordx4 v106, s[12:15], s22 offen offset:0 lds
    buffer_load_dwordx4 v107, s[12:15], s22 offen offset:1024 lds
    buffer_load_dwordx4 v108, s[12:15], s22 offen offset:2048 lds
    s_add_u32 s36, s36, 1
    s_cmp_eq_u32 s36, 10
    s_cmov_b32 s36, 0
    s_waitcnt lgkmcnt(0)
    v_mfma_f32_4x4x4_16b_bf16 v[64:67], v[140:141], v[40:41], v[64:67]
    v_mfma_f32_4x4x4_16b_bf16 v[68:71], v[40:41], v[40:41], v[68:71]
    v_mfma_f32_4x4x4_16b_bf16 v[72:75], v[140:141], v[44:45], v[72:75]
    v_mfma_f32_4x4x4_16b_bf16 v[76:79], v[44:45], v[44:45], v[76:79]
    v_mfma_f32_4x4x4_16b_bf16 v[64:67], v[140:141], v[42:43], v[64:67]
    v_mfma_f32_4x4x4_16b_bf16 v[68:71], v[42:43], v[42:43], v[68:71]
    v_mfma_f32_4x4x4_16b_bf16 v[72:75], v[140:141], v[46:47], v[72:75]
    v_mfma_f32_4x4x4_16b_bf16 v[76:79], v[46:47], v[46:47], v[76:79]
    ds_read_b128 v[40:43], v111 offset:40960
    ds_read_b128 v[44:47], v111 offset:41984
    s_lshl_b32 s22, s36, 7
    s_add_u32 m0, s29, 61440
    s_add_u32 s22, s23, s22
    buffer_load_dwordx4 v104, s[8:11], s22 offen offset:0 lds
    buffer_load_dwordx4 v105, s[8:11], s22 offen offset:1024 lds
    s_mul_i32 s22, s36, s25
    s_add_u32 m0, s30, 61440
    s_add_u32 s22, s22, s24
    buffer_load_dwordx4 v106, s[12:15], s22 offen offset:0 lds
    buffer_load_dwordx4 v107, s[12:15], s22 offen offset:1024 lds
    buffer_load_dwordx4 v108, s[12:15], s22 offen offset:2048 lds
    s_add_u32 s36, s36, 1
    s_cmp_eq_u32 s36, 10
    s_cmov_b32 s36, 0
    s_waitcnt lgkmcnt(0)
    v_mfma_f32_4x4x4_16b_bf16 v[64:67], v[140:141], v[40:41], v[64:67]
    v_mfma_f32_4x4x4_16b_bf16 v[68:71], v[40:41], v[40:41], v[68:71]
    v_mfma_f32_4x4x4_16b_bf16 v[72:75], v[140:141], v[44:45], v[72:75]
    v_mfma_f32_4x4x4_16b_bf16 v[76:79], v[44:45], v[44:45], v[76:79]
    v_mfma_f32_4x4x4_16b_bf16 v[64:67], v[140:141], v[42:43], v[64:67]
    v_mfma_f32_4x4x4_16b_bf16 v[68:71], v[42:43], v[42:43], v[68:71]
    v_mfma_f32_4x4x4_16b_bf16 v[72:75], v[140:141], v[46:47], v[72:75]
    v_mfma_f32_4x4x4_16b_bf16 v[76:79], v[46:47], v[46:47], v[76:79]
    s_waitcnt vmcnt(10)
    s_barrier
    ds_read_b128 v[40:43], v110 offset:0
    ds_read_b128 v[44:47], v110 offset:1024
    s_waitcnt lgkmcnt(0)
    v_mfma_f32_4x4x4_16b_bf16 v[64:67], v[140:141], v[40:41], v[64:67]
    v_mfma_f32_4x4x4_16b_bf16 v[68:71], v[40:41], v[40:41], v[68:71]
    v_mfma_f32_4x4x4_16b_bf16 v[72:75], v[140:141], v[44:45], v[72:75]
    v_mfma_f32_4x4x4_16b_bf16 v[76:79], v[44:45], v[44:45], v[76:79]
    v_mfma_f32_4x4x4_16b_bf16 v[64:67], v[140:141], v[42:43], v[64:67]
    v_mfma_f32_4x4x4_16b_bf16 v[68:71], v[42:43], v[42:43], v[68:71]
    v_mfma_f32_4x4x4_16b_bf16 v[72:75], v[140:141], v[46:47], v[72:75]
    v_mfma_f32_4x4x4_16b_bf16 v[76:79], v[46:47], v[46:47], v[76:79]
    ds_read_b128 v[40:43], v110 offset:20480
    ds_read_b128 v[44:47], v110 offset:21504
    s_waitcnt lgkmcnt(0)
    v_mfma_f32_4x4x4_16b_bf16 v[64:67], v[140:141], v[40:41], v[64:67]
    v_mfma_f32_4x4x4_16b_bf16 v[68:71], v[40:41], v[40:41], v[68:71]
    v_mfma_f32_4x4x4_16b_bf16 v[72:75], v[140:141], v[44:45], v[72:75]
    v_mfma_f32_4x4x4_16b_bf16 v[76:79], v[44:45], v[44:45], v[76:79]
    v_mfma_f32_4x4x4_16b_bf16 v[64:67], v[140:141], v[42:43], v[64:67]
    v_mfma_f32_4x4x4_16b_bf16 v[68:71], v[42:43], v[42:43], v[68:71]
    v_mfma_f32_4x4x4_16b_bf16 v[72:75], v[140:141], v[46:47], v[72:75]
    v_mfma_f32_4x4x4_16b_bf16 v[76:79], v[46:47], v[46:47], v[76:79]
    s_waitcnt vmcnt(0)
    s_barrier
    ds_read_b128 v[40:43], v110 offset:40960
    ds_read_b128 v[44:47], v110 offset:41984
    s_waitcnt lgkmcnt(0)
    v_mfma_f32_4x4x4_16b_bf16 v[64:67], v[140:141], v[40:41], v[64:67]
    v_mfma_f32_4x4x4_16b_bf16 v[68:71], v[40:41], v[40:41], v[68:71]
    v_mfma_f32_4x4x4_16b_bf16 v[72:75], v[140:141], v[44:45], v[72:75]
    v_mfma_f32_4x4x4_16b_bf16 v[76:79], v[44:45], v[44:45], v[76:79]
    v_mfma_f32_4x4x4_16b_bf16 v[64:67], v[140:141], v[42:43], v[64:67]
    v_mfma_f32_4x4x4_16b_bf16 v[68:71], v[42:43], v[42:43], v[68:71]
    v_mfma_f32_4x4x4_16b_bf16 v[72:75], v[140:141], v[46:47], v[72:75]
    v_mfma_f32_4x4x4_16b_bf16 v[76:79], v[46:47], v[46:47], v[76:79]
    ds_read_b128 v[40:43], v111 offset:0
    ds_read_b128 v[44:47], v111 offset:1024
    s_lshl_b32 s35, s6, 2
    s_add_u32 s35, s35, s20
    s_lshl_b32 s35, s35, 9
    v_lshlrev_b32 v148, 7, v1
    s_mov_b64 exec, 0xf
    buffer_load_dwordx2 v[152:153], v148, s[72:75], s35 offen sc1
    s_mov_b64 exec, -1
    s_waitcnt lgkmcnt(0)
    v_mfma_f32_4x4x4_16b_bf16 v[64:67], v[140:141], v[40:41], v[64:67]
    v_mfma_f32_4x4x4_16b_bf16 v[68:71], v[40:41], v[40:41], v[68:71]
    v_mfma_f32_4x4x4_16b_bf16 v[72:75], v[140:141], v[44:45], v[72:75]
    v_mfma_f32_4x4x4_16b_bf16 v[76:79], v[44:45], v[44:45], v[76:79]
    v_mfma_f32_4x4x4_16b_bf16 v[64:67], v[140:141], v[42:43], v[64:67]
    v_mfma_f32_4x4x4_16b_bf16 v[68:71], v[42:43], v[42:43], v[68:71]
    v_mfma_f32_4x4x4_16b_bf16 v[72:75], v[140:141], v[46:47], v[72:75]
    v_mfma_f32_4x4x4_16b_bf16 v[76:79], v[46:47], v[46:47], v[76:79]
    v_and_b32 v80, 3, v1
    s_nop 2
    v_cmp_eq_u32 vcc, 1, v80
    s_nop 1
    v_cndmask_b32 v68, v68, v69, vcc
    v_cndmask_b32 v76, v76, v77, vcc
    v_cmp_eq_u32 vcc, 2, v80
    s_nop 1
    v_cndmask_b32 v68, v68, v70, vcc
    v_cndmask_b32 v76, v76, v78, vcc
    v_cmp_eq_u32 vcc, 3, v80
    s_nop 1
    v_cndmask_b32 v68, v68, v71, vcc
    v_cndmask_b32 v76, v76, v79, vcc
    v_add_f32_dpp v64, v64, v64 quad_perm:[1,0,3,2] row_mask:0xf bank_mask:0xf
    v_add_f32_dpp v72, v72, v72 quad_perm:[1,0,3,2] row_mask:0xf bank_mask:0xf
    v_add_f32_dpp v68, v68, v68 quad_perm:[1,0,3,2] row_mask:0xf bank_mask:0xf
    v_add_f32_dpp v76, v76, v76 quad_perm:[1,0,3,2] row_mask:0xf bank_mask:0xf
    v_add_f32_dpp v64, v64, v64 quad_perm:[2,3,0,1] row_mask:0xf bank_mask:0xf
    v_add_f32_dpp v72, v72, v72 quad_perm:[2,3,0,1] row_mask:0xf bank_mask:0xf
    v_add_f32_dpp v68, v68, v68 quad_perm:[2,3,0,1] row_mask:0xf bank_mask:0xf
    v_add_f32_dpp v76, v76, v76 quad_perm:[2,3,0,1] row_mask:0xf bank_mask:0xf
    v_add_f32_dpp v64, v64, v64 row_half_mirror row_mask:0xf bank_mask:0xf
    v_add_f32_dpp v72, v72, v72 row_half_mirror row_mask:0xf bank_mask:0xf
    v_add_f32_dpp v68, v68, v68 row_half_mirror row_mask:0xf bank_mask:0xf
    v_add_f32_dpp v76, v76, v76 row_half_mirror row_mask:0xf bank_mask:0xf
    v_mul_f32 v64, 0x3acccccd, v64
    v_mul_f32 v72, 0x3acccccd, v72
    v_mul_f32 v68, 0x3acccccd, v68
    v_mul_f32 v76, 0x3acccccd, v76
    v_fma_f32 v68, -v64, v64, v68
    v_max_f32_e64 v68, 0, v68
    v_add_f32 v68, 0x3727c5ac, v68
    v_rsq_f32_e64 v68, v68
    v_fma_f32 v76, -v72, v72, v76
    v_max_f32_e64 v76, 0, v76
    v_add_f32 v76, 0x3727c5ac, v76
    v_rsq_f32 v76, v76
    s_lshl_b32 s32, s20, 6
    s_add_u32 s32, s32, 54272
    v_lshrrev_b32_e64 v80, 3, v1
    v_lshl_add_u32 v80, v80, 2, s32
    ds_write_b32 v80, v64
    ds_write_b32 v80, v68 offset:256
    ds_write_b32 v80, v72 offset:32
    ds_write_b32 v80, v76 offset:288
    s_waitcnt lgkmcnt(0)
    s_barrier
    s_mov_b32 s12, s56
    s_mov_b32 s13, s57
    s_mov_b32 s14, 0x0021c000
    s_mov_b32 s15, 0x00020000
    s_mul_i32 s24, s20, 55296
    s_lshl_b32 s32, s7, 7
    s_add_u32 s24, s24, s32
    s_add_u32 s24, s24, 1664
    s_mov_b32 s25, 221184
    s_add_u32 m0, s27, 32768
    s_nop 0
    buffer_load_dwordx4 v124, s[12:15], s24 offen offset:0  lds
    buffer_load_dwordx4 v125, s[12:15], s24 offen offset:1024  lds
    s_add_u32 s24, s24, s25
    s_add_u32 s8, s68, 0x00280000
    s_addc_u32 s9, s69, 0
    s_mov_b32 s10, 0x00280000
    s_mov_b32 s11, 0x00020000
    s_lshl_b32 s23, s6, 2
    s_add_u32 s23, s23, s20
    s_mul_i32 s23, s23, 40960
    s_mov_b32 s22, s23
    s_waitcnt vmcnt(2)
    s_mov_b64 exec, 0xf
    v_cmp_ne_u64 vcc, s[96:97], v[152:153]
    s_mov_b64 exec, -1
    s_cbranch_vccz L_parallel_sum__grouped_kv_mqa__mixer_gmlp__prompt_xo_97
    s_mov_b64 exec, 0x0000000f
L_parallel_sum__grouped_kv_mqa__mixer_gmlp__prompt_pl_98:
    buffer_load_dwordx2 v[152:153], v148, s[72:75], s35 offen sc1
    s_waitcnt vmcnt(0)
    v_cmp_ne_u64 vcc, s[96:97], v[152:153]
    s_cbranch_vccz L_parallel_sum__grouped_kv_mqa__mixer_gmlp__prompt_pd_99
    s_sleep 2
    s_sub_u32 s70, s70, 1
    s_cbranch_scc0 L_parallel_sum__grouped_kv_mqa__mixer_gmlp__prompt_pl_98
L_parallel_sum__grouped_kv_mqa__mixer_gmlp__prompt_pd_99:
    s_mov_b64 exec, -1
L_parallel_sum__grouped_kv_mqa__mixer_gmlp__prompt_xo_97:
    s_add_u32 m0, s26, 0x00004000
    s_nop 0
    buffer_load_dwordx4 v120, s[8:11], s22 offen offset:0 sc1 lds
    buffer_load_dwordx4 v121, s[8:11], s22 offen offset:1024 sc1 lds
    buffer_load_dwordx4 v122, s[8:11], s22 offen offset:2048 sc1 lds
    buffer_load_dwordx4 v123, s[8:11], s22 offen offset:3072 sc1 lds
    s_add_u32 s22, s22, 128
    s_add_u32 s71, s71, 24
    s_mov_b32 m0, s31
    s_add_u32 s71, s71, 4
    buffer_load_dword v137, s[40:43], s71 offen lds
    s_add_u32 m0, s27, 40960
    s_nop 0
    buffer_load_dwordx4 v124, s[12:15], s24 offen offset:0  lds
    buffer_load_dwordx4 v125, s[12:15], s24 offen offset:1024  lds
    s_add_u32 s24, s24, s25
    s_mov_b32 m0, s31
    s_add_u32 s71, s71, 4
    buffer_load_dword v137, s[40:43], s71 offen lds
    s_add_u32 m0, s26, 0x00008000
    s_nop 0
    buffer_load_dwordx4 v120, s[8:11], s22 offen offset:0 sc1 lds
    buffer_load_dwordx4 v121, s[8:11], s22 offen offset:1024 sc1 lds
    buffer_load_dwordx4 v122, s[8:11], s22 offen offset:2048 sc1 lds
    buffer_load_dwordx4 v123, s[8:11], s22 offen offset:3072 sc1 lds
    s_add_u32 s22, s22, 128
    s_add_u32 m0, s27, 0
    s_nop 0
    buffer_load_dwordx4 v124, s[12:15], s24 offen offset:0  lds
    buffer_load_dwordx4 v125, s[12:15], s24 offen offset:1024  lds
    s_add_u32 s24, s24, s25
    s_add_u32 m0, s27, 8192
    s_nop 0
    buffer_load_dwordx4 v124, s[12:15], s24 offen offset:0  lds
    buffer_load_dwordx4 v125, s[12:15], s24 offen offset:1024  lds
    s_add_u32 s24, s24, s25
    s_mov_b32 m0, s31
    s_add_u32 s71, s71, 4
    buffer_load_dword v137, s[40:43], s71 offen lds
    s_add_u32 m0, s26, 0x00000000
    s_nop 0
    buffer_load_dwordx4 v120, s[8:11], s22 offen offset:0 sc1 lds
    buffer_load_dwordx4 v121, s[8:11], s22 offen offset:1024 sc1 lds
    buffer_load_dwordx4 v122, s[8:11], s22 offen offset:2048 sc1 lds
    buffer_load_dwordx4 v123, s[8:11], s22 offen offset:3072 sc1 lds
    s_add_u32 s22, s22, 128
    s_waitcnt vmcnt(17)
L_parallel_sum__grouped_kv_mqa__mixer_gmlp__prompt_gspin_100:
    ds_read_b32 v4, v3
    s_waitcnt lgkmcnt(0)
    v_cmp_gt_u32 vcc, 7, v4
    s_cbranch_vccz L_parallel_sum__grouped_kv_mqa__mixer_gmlp__prompt_gspun_101
    s_sleep 1
    s_sub_u32 s70, s70, 1
    s_cbranch_scc0 L_parallel_sum__grouped_kv_mqa__mixer_gmlp__prompt_gspin_100
L_parallel_sum__grouped_kv_mqa__mixer_gmlp__prompt_gspun_101:
    ds_read_b128 v[40:43], v126 offset:16384
    ds_read_b128 v[44:47], v126 offset:18432
    ds_read_b64_tr_b16 v[48:49], v128 offset:32768
    ds_read_b64_tr_b16 v[50:51], v128 offset:33280
    ds_read_b64_tr_b16 v[52:53], v129 offset:32768
    ds_read_b64_tr_b16 v[54:55], v129 offset:33280
    ds_read_b64_tr_b16 v[56:57], v130 offset:32768
    ds_read_b64_tr_b16 v[58:59], v130 offset:33280
    ds_read_b64_tr_b16 v[60:61], v131 offset:32768
    ds_read_b64_tr_b16 v[62:63], v131 offset:33280
L_parallel_sum__grouped_kv_mqa__mixer_gmlp__prompt_b10_92:
    s_waitcnt lgkmcnt(0)
    v_mfma_f32_16x16x32_bf16 v[8:11], v[48:51], v[40:43], 0
    v_mfma_f32_16x16x32_bf16 v[16:19], v[48:51], v[44:47], 0
    ds_read_b128 v[64:67], v127 offset:16384
    ds_read_b128 v[68:71], v127 offset:18432
    ds_read_b64_tr_b16 v[72:73], v128 offset:36864
    ds_read_b64_tr_b16 v[74:75], v128 offset:37376
    ds_read_b64_tr_b16 v[76:77], v129 offset:36864
    ds_read_b64_tr_b16 v[78:79], v129 offset:37376
    v_mfma_f32_16x16x32_bf16 v[12:15], v[52:55], v[40:43], 0
    v_mfma_f32_16x16x32_bf16 v[20:23], v[52:55], v[44:47], 0
    ds_read_b64_tr_b16 v[80:81], v130 offset:36864
    ds_read_b64_tr_b16 v[82:83], v130 offset:37376
    ds_read_b64_tr_b16 v[84:85], v131 offset:36864
    ds_read_b64_tr_b16 v[86:87], v131 offset:37376
    ds_read_b32 v4, v3
    s_setprio 0
    v_mfma_f32_16x16x32_bf16 v[24:27], v[56:59], v[40:43], 0
    v_mfma_f32_16x16x32_bf16 v[32:35], v[56:59], v[44:47], 0
    s_setprio 3
    v_mfma_f32_16x16x32_bf16 v[28:31], v[60:63], v[40:43], 0
    v_mfma_f32_16x16x32_bf16 v[36:39], v[60:63], v[44:47], 0
    s_add_u32 m0, s27, 16384
    s_waitcnt vmcnt(9) lgkmcnt(0)
    v_cmp_gt_u32 vcc, 8, v4
    s_cbranch_vccnz L_parallel_sum__grouped_kv_mqa__mixer_gmlp__prompt_gslow_103
L_parallel_sum__grouped_kv_mqa__mixer_gmlp__prompt_gok_102:
    v_mfma_f32_16x16x32_bf16 v[8:11], v[72:75], v[64:67], v[8:11]
    v_mfma_f32_16x16x32_bf16 v[16:19], v[72:75], v[68:71], v[16:19]
    ds_read_b128 v[40:43], v126 offset:32768
    ds_read_b128 v[44:47], v126 offset:34816
    ds_read_b64_tr_b16 v[48:49], v128 offset:40960
    ds_read_b64_tr_b16 v[50:51], v128 offset:41472
    ds_read_b64_tr_b16 v[52:53], v129 offset:40960
    s_setprio 0
    buffer_load_dwordx4 v124, s[12:15], s24 offen offset:0  lds
    s_setprio 3
    v_mfma_f32_16x16x32_bf16 v[12:15], v[76:79], v[64:67], v[12:15]
    v_mfma_f32_16x16x32_bf16 v[20:23], v[76:79], v[68:71], v[20:23]
    ds_read_b64_tr_b16 v[54:55], v129 offset:41472
    ds_read_b64_tr_b16 v[56:57], v130 offset:40960
    ds_read_b64_tr_b16 v[58:59], v130 offset:41472
    ds_read_b64_tr_b16 v[60:61], v131 offset:40960
    ds_read_b64_tr_b16 v[62:63], v131 offset:41472
    s_setprio 0
    buffer_load_dwordx4 v125, s[12:15], s24 offen offset:1024  lds
    s_add_u32 s24, s24, s25
    s_mov_b32 m0, s31
    s_add_u32 s71, s71, 4
    buffer_load_dword v137, s[40:43], s71 offen lds
    s_add_u32 m0, s26, 16384
    v_mfma_f32_16x16x32_bf16 v[24:27], v[80:83], v[64:67], v[24:27]
    v_mfma_f32_16x16x32_bf16 v[32:35], v[80:83], v[68:71], v[32:35]
    buffer_load_dwordx4 v120, s[8:11], s22 offen offset:0 sc1 lds
    s_setprio 3
    v_mfma_f32_16x16x32_bf16 v[28:31], v[84:87], v[64:67], v[28:31]
    v_mfma_f32_16x16x32_bf16 v[36:39], v[84:87], v[68:71], v[36:39]
    s_setprio 0
    buffer_load_dwordx4 v121, s[8:11], s22 offen offset:1024 sc1 lds
    s_setprio 3
    s_waitcnt lgkmcnt(0)
    v_mfma_f32_16x16x32_bf16 v[8:11], v[48:51], v[40:43], v[8:11]
    v_mfma_f32_16x16x32_bf16 v[16:19], v[48:51], v[44:47], v[16:19]
    ds_read_b128 v[64:67], v127 offset:32768
    ds_read_b128 v[68:71], v127 offset:34816
    ds_read_b64_tr_b16 v[72:73], v128 offset:45056
    ds_read_b64_tr_b16 v[74:75], v128 offset:45568
    ds_read_b64_tr_b16 v[76:77], v129 offset:45056
    ds_read_b64_tr_b16 v[78:79], v129 offset:45568
    s_setprio 0
    buffer_load_dwordx4 v122, s[8:11], s22 offen offset:2048 sc1 lds
    s_setprio 3
    v_mfma_f32_16x16x32_bf16 v[12:15], v[52:55], v[40:43], v[12:15]
    v_mfma_f32_16x16x32_bf16 v[20:23], v[52:55], v[44:47], v[20:23]
    ds_read_b64_tr_b16 v[80:81], v130 offset:45056
    ds_read_b64_tr_b16 v[82:83], v130 offset:45568
    ds_read_b64_tr_b16 v[84:85], v131 offset:45056
    ds_read_b64_tr_b16 v[86:87], v131 offset:45568
    ds_read_b32 v4, v3
    s_setprio 0
    buffer_load_dwordx4 v123, s[8:11], s22 offen offset:3072 sc1 lds
    s_add_u32 s22, s22, 128
    s_nop 0
    v_mfma_f32_16x16x32_bf16 v[24:27], v[56:59], v[40:43], v[24:27]
    v_mfma_f32_16x16x32_bf16 v[32:35], v[56:59], v[44:47], v[32:35]
    s_setprio 3
    v_mfma_f32_16x16x32_bf16 v[28:31], v[60:63], v[40:43], v[28:31]
    v_mfma_f32_16x16x32_bf16 v[36:39], v[60:63], v[44:47], v[36:39]
    s_add_u32 m0, s27, 24576
    s_waitcnt vmcnt(7) lgkmcnt(0)
    v_cmp_gt_u32 vcc, 9, v4
    s_cbranch_vccnz L_parallel_sum__grouped_kv_mqa__mixer_gmlp__prompt_gslow_105
L_parallel_sum__grouped_kv_mqa__mixer_gmlp__prompt_gok_104:
    v_mfma_f32_16x16x32_bf16 v[8:11], v[72:75], v[64:67], v[8:11]
    v_mfma_f32_16x16x32_bf16 v[16:19], v[72:75], v[68:71], v[16:19]
    ds_read_b128 v[40:43], v126 offset:0
    ds_read_b128 v[44:47], v126 offset:2048
    ds_read_b64_tr_b16 v[48:49], v128 offset:0
    ds_read_b64_tr_b16 v[50:51], v128 offset:512
    ds_read_b64_tr_b16 v[52:53], v129 offset:0
    s_setprio 0
    buffer_load_dwordx4 v124, s[12:15], s24 offen offset:0  lds
    s_setprio 3
    v_mfma_f32_16x16x32_bf16 v[12:15], v[76:79], v[64:67], v[12:15]
    v_mfma_f32_16x16x32_bf16 v[20:23], v[76:79], v[68:71], v[20:23]
    ds_read_b64_tr_b16 v[54:55], v129 offset:512
    ds_read_b64_tr_b16 v[56:57], v130 offset:0
    ds_read_b64_tr_b16 v[58:59], v130 offset:512
    ds_read_b64_tr_b16 v[60:61], v131 offset:0
    ds_read_b64_tr_b16 v[62:63], v131 offset:512
    s_setprio 0
    buffer_load_dwordx4 v125, s[12:15], s24 offen offset:1024  lds
    s_add_u32 s24, s24, s25
    s_mov_b32 m0, s31
    s_add_u32 s71, s71, 4
    buffer_load_dword v137, s[40:43], s71 offen lds
    s_add_u32 m0, s26, 32768
    v_mfma_f32_16x16x32_bf16 v[24:27], v[80:83], v[64:67], v[24:27]
    v_mfma_f32_16x16x32_bf16 v[32:35], v[80:83], v[68:71], v[32:35]
    buffer_load_dwordx4 v120, s[8:11], s22 offen offset:0 sc1 lds
    s_setprio 3
    v_mfma_f32_16x16x32_bf16 v[28:31], v[84:87], v[64:67], v[28:31]
    v_mfma_f32_16x16x32_bf16 v[36:39], v[84:87], v[68:71], v[36:39]
    s_setprio 0
    buffer_load_dwordx4 v121, s[8:11], s22 offen offset:1024 sc1 lds
    s_setprio 3
    s_waitcnt lgkmcnt(0)
    v_mfma_f32_16x16x32_bf16 v[8:11], v[48:51], v[40:43], v[8:11]
    v_mfma_f32_16x16x32_bf16 v[16:19], v[48:51], v[44:47], v[16:19]
    ds_read_b128 v[64:67], v127 offset:0
    ds_read_b128 v[68:71], v127 offset:2048
    ds_read_b64_tr_b16 v[72:73], v128 offset:4096
    ds_read_b64_tr_b16 v[74:75], v128 offset:4608
    ds_read_b64_tr_b16 v[76:77], v129 offset:4096
    ds_read_b64_tr_b16 v[78:79], v129 offset:4608
    s_setprio 0
    buffer_load_dwordx4 v122, s[8:11], s22 offen offset:2048 sc1 lds
    s_setprio 3
    v_mfma_f32_16x16x32_bf16 v[12:15], v[52:55], v[40:43], v[12:15]
    v_mfma_f32_16x16x32_bf16 v[20:23], v[52:55], v[44:47], v[20:23]
    ds_read_b64_tr_b16 v[80:81], v130 offset:4096
    ds_read_b64_tr_b16 v[82:83], v130 offset:4608
    ds_read_b64_tr_b16 v[84:85], v131 offset:4096
    ds_read_b64_tr_b16 v[86:87], v131 offset:4608
    ds_read_b32 v4, v3
    s_setprio 0
    buffer_load_dwordx4 v123, s[8:11], s22 offen offset:3072 sc1 lds
    s_add_u32 s22, s22, 128
    s_nop 0
    v_mfma_f32_16x16x32_bf16 v[24:27], v[56:59], v[40:43], v[24:27]
    v_mfma_f32_16x16x32_bf16 v[32:35], v[56:59], v[44:47], v[32:35]
    s_setprio 3
    v_mfma_f32_16x16x32_bf16 v[28:31], v[60:63], v[40:43], v[28:31]
    v_mfma_f32_16x16x32_bf16 v[36:39], v[60:63], v[44:47], v[36:39]
    s_add_u32 m0, s27, 32768
    s_waitcnt vmcnt(7) lgkmcnt(0)
    v_cmp_gt_u32 vcc, 10, v4
    s_cbranch_vccnz L_parallel_sum__grouped_kv_mqa__mixer_gmlp__prompt_gslow_107
L_parallel_sum__grouped_kv_mqa__mixer_gmlp__prompt_gok_106:
    v_mfma_f32_16x16x32_bf16 v[8:11], v[72:75], v[64:67], v[8:11]
    v_mfma_f32_16x16x32_bf16 v[16:19], v[72:75], v[68:71], v[16:19]
    ds_read_b128 v[40:43], v126 offset:16384
    ds_read_b128 v[44:47], v126 offset:18432
    ds_read_b64_tr_b16 v[48:49], v128 offset:8192
    ds_read_b64_tr_b16 v[50:51], v128 offset:8704
    ds_read_b64_tr_b16 v[52:53], v129 offset:8192
    s_setprio 0
    buffer_load_dwordx4 v124, s[12:15], s24 offen offset:0  lds
    s_setprio 3
    v_mfma_f32_16x16x32_bf16 v[12:15], v[76:79], v[64:67], v[12:15]
    v_mfma_f32_16x16x32_bf16 v[20:23], v[76:79], v[68:71], v[20:23]
    ds_read_b64_tr_b16 v[54:55], v129 offset:8704
    ds_read_b64_tr_b16 v[56:57], v130 offset:8192
    ds_read_b64_tr_b16 v[58:59], v130 offset:8704
    ds_read_b64_tr_b16 v[60:61], v131 offset:8192
    ds_read_b64_tr_b16 v[62:63], v131 offset:8704
    s_setprio 0
    buffer_load_dwordx4 v125, s[12:15], s24 offen offset:1024  lds
    s_add_u32 s24, s24, s25
    s_mov_b32 m0, s31
    s_add_u32 s71, s71, 4
    buffer_load_dword v137, s[40:43], s71 offen lds
    s_add_u32 m0, s26, 0
    v_mfma_f32_16x16x32_bf16 v[24:27], v[80:83], v[64:67], v[24:27]
    v_mfma_f32_16x16x32_bf16 v[32:35], v[80:83], v[68:71], v[32:35]
    buffer_load_dwordx4 v120, s[8:11], s22 offen offset:0 sc1 lds
    s_setprio 3
    v_mfma_f32_16x16x32_bf16 v[28:31], v[84:87], v[64:67], v[28:31]
    v_mfma_f32_16x16x32_bf16 v[36:39], v[84:87], v[68:71], v[36:39]
    s_setprio 0
    buffer_load_dwordx4 v121, s[8:11], s22 offen offset:1024 sc1 lds
    s_setprio 3
    s_waitcnt lgkmcnt(0)
    v_mfma_f32_16x16x32_bf16 v[8:11], v[48:51], v[40:43], v[8:11]
    v_mfma_f32_16x16x32_bf16 v[16:19], v[48:51], v[44:47], v[16:19]
    ds_read_b128 v[64:67], v127 offset:16384
    ds_read_b128 v[68:71], v127 offset:18432
    ds_read_b64_tr_b16 v[72:73], v128 offset:12288
    ds_read_b64_tr_b16 v[74:75], v128 offset:12800
    ds_read_b64_tr_b16 v[76:77], v129 offset:12288
    ds_read_b64_tr_b16 v[78:79], v129 offset:12800
    s_setprio 0
    buffer_load_dwordx4 v122, s[8:11], s22 offen offset:2048 sc1 lds
    s_setprio 3
    v_mfma_f32_16x16x32_bf16 v[12:15], v[52:55], v[40:43], v[12:15]
    v_mfma_f32_16x16x32_bf16 v[20:23], v[52:55], v[44:47], v[20:23]
    ds_read_b64_tr_b16 v[80:81], v130 offset:12288
    ds_read_b64_tr_b16 v[82:83], v130 offset:12800
    ds_read_b64_tr_b16 v[84:85], v131 offset:12288
    ds_read_b64_tr_b16 v[86:87], v131 offset:12800
    ds_read_b32 v4, v3
    s_setprio 0
    buffer_load_dwordx4 v123, s[8:11], s22 offen offset:3072 sc1 lds
    s_add_u32 s22, s22, 128
    s_nop 0
    v_mfma_f32_16x16x32_bf16 v[24:27], v[56:59], v[40:43], v[24:27]
    v_mfma_f32_16x16x32_bf16 v[32:35], v[56:59], v[44:47], v[32:35]
    s_setprio 3
    v_mfma_f32_16x16x32_bf16 v[28:31], v[60:63], v[40:43], v[28:31]
    v_mfma_f32_16x16x32_bf16 v[36:39], v[60:63], v[44:47], v[36:39]
    s_add_u32 m0, s27, 40960
    s_waitcnt vmcnt(7) lgkmcnt(0)
    v_cmp_gt_u32 vcc, 11, v4
    s_cbranch_vccnz L_parallel_sum__grouped_kv_mqa__mixer_gmlp__prompt_gslow_109
L_parallel_sum__grouped_kv_mqa__mixer_gmlp__prompt_gok_108:
    v_mfma_f32_16x16x32_bf16 v[8:11], v[72:75], v[64:67], v[8:11]
    v_mfma_f32_16x16x32_bf16 v[16:19], v[72:75], v[68:71], v[16:19]
    ds_read_b128 v[40:43], v126 offset:32768
    ds_read_b128 v[44:47], v126 offset:34816
    ds_read_b64_tr_b16 v[48:49], v128 offset:16384
    ds_read_b64_tr_b16 v[50:51], v128 offset:16896
    ds_read_b64_tr_b16 v[52:53], v129 offset:16384
    s_setprio 0
    buffer_load_dwordx4 v124, s[12:15], s24 offen offset:0  lds
    s_setprio 3
    v_mfma_f32_16x16x32_bf16 v[12:15], v[76:79], v[64:67], v[12:15]
    v_mfma_f32_16x16x32_bf16 v[20:23], v[76:79], v[68:71], v[20:23]
    ds_read_b64_tr_b16 v[54:55], v129 offset:16896
    ds_read_b64_tr_b16 v[56:57], v130 offset:16384
    ds_read_b64_tr_b16 v[58:59], v130 offset:16896
    ds_read_b64_tr_b16 v[60:61], v131 offset:16384
    ds_read_b64_tr_b16 v[62:63], v131 offset:16896
    s_setprio 0
    buffer_load_dwordx4 v125, s[12:15], s24 offen offset:1024  lds
    s_add_u32 s24, s24, s25
    s_mov_b32 m0, s31
    s_add_u32 s71, s71, 4
    buffer_load_dword v137, s[40:43], s71 offen lds
    s_add_u32 m0, s26, 16384
    v_mfma_f32_16x16x32_bf16 v[24:27], v[80:83], v[64:67], v[24:27]
    v_mfma_f32_16x16x32_bf16 v[32:35], v[80:83], v[68:71], v[32:35]
    buffer_load_dwordx4 v120, s[8:11], s22 offen offset:0 sc1 lds
    s_setprio 3
    v_mfma_f32_16x16x32_bf16 v[28:31], v[84:87], v[64:67], v[28:31]
    v_mfma_f32_16x16x32_bf16 v[36:39], v[84:87], v[68:71], v[36:39]
    s_setprio 0
    buffer_load_dwordx4 v121, s[8:11], s22 offen offset:1024 sc1 lds
    s_setprio 3
    s_waitcnt lgkmcnt(0)
    v_mfma_f32_16x16x32_bf16 v[8:11], v[48:51], v[40:43], v[8:11]
    v_mfma_f32_16x16x32_bf16 v[16:19], v[48:51], v[44:47], v[16:19]
    ds_read_b128 v[64:67], v127 offset:32768
    ds_read_b128 v[68:71], v127 offset:34816
    ds_read_b64_tr_b16 v[72:73], v128 offset:20480
    ds_read_b64_tr_b16 v[74:75], v128 offset:20992
    ds_read_b64_tr_b16 v[76:77], v129 offset:20480
    ds_read_b64_tr_b16 v[78:79], v129 offset:20992
    s_setprio 0
    buffer_load_dwordx4 v122, s[8:11], s22 offen offset:2048 sc1 lds
    s_setprio 3
    v_mfma_f32_16x16x32_bf16 v[12:15], v[52:55], v[40:43], v[12:15]
    v_mfma_f32_16x16x32_bf16 v[20:23], v[52:55], v[44:47], v[20:23]
    ds_read_b64_tr_b16 v[80:81], v130 offset:20480
    ds_read_b64_tr_b16 v[82:83], v130 offset:20992
    ds_read_b64_tr_b16 v[84:85], v131 offset:20480
    ds_read_b64_tr_b16 v[86:87], v131 offset:20992
    ds_read_b32 v4, v3
    s_setprio 0
    buffer_load_dwordx4 v123, s[8:11], s22 offen offset:3072 sc1 lds
    s_add_u32 s22, s22, 128
    s_nop 0
    v_mfma_f32_16x16x32_bf16 v[24:27], v[56:59], v[40:43], v[24:27]
    v_mfma_f32_16x16x32_bf16 v[32:35], v[56:59], v[44:47], v[32:35]
    s_setprio 3
    v_mfma_f32_16x16x32_bf16 v[28:31], v[60:63], v[40:43], v[28:31]
    v_mfma_f32_16x16x32_bf16 v[36:39], v[60:63], v[44:47], v[36:39]
    s_add_u32 m0, s27, 0
    s_waitcnt vmcnt(7) lgkmcnt(0)
    v_cmp_gt_u32 vcc, 12, v4
    s_cbranch_vccnz L_parallel_sum__grouped_kv_mqa__mixer_gmlp__prompt_gslow_111
L_parallel_sum__grouped_kv_mqa__mixer_gmlp__prompt_gok_110:
    v_mfma_f32_16x16x32_bf16 v[8:11], v[72:75], v[64:67], v[8:11]
    v_mfma_f32_16x16x32_bf16 v[16:19], v[72:75], v[68:71], v[16:19]
    ds_read_b128 v[40:43], v126 offset:0
    ds_read_b128 v[44:47], v126 offset:2048
    ds_read_b64_tr_b16 v[48:49], v128 offset:24576
    ds_read_b64_tr_b16 v[50:51], v128 offset:25088
    ds_read_b64_tr_b16 v[52:53], v129 offset:24576
    s_setprio 0
    buffer_load_dwordx4 v124, s[12:15], s24 offen offset:0  lds
    s_setprio 3
    v_mfma_f32_16x16x32_bf16 v[12:15], v[76:79], v[64:67], v[12:15]
    v_mfma_f32_16x16x32_bf16 v[20:23], v[76:79], v[68:71], v[20:23]
    ds_read_b64_tr_b16 v[54:55], v129 offset:25088
    ds_read_b64_tr_b16 v[56:57], v130 offset:24576
    ds_read_b64_tr_b16 v[58:59], v130 offset:25088
    ds_read_b64_tr_b16 v[60:61], v131 offset:24576
    ds_read_b64_tr_b16 v[62:63], v131 offset:25088
    s_setprio 0
    buffer_load_dwordx4 v125, s[12:15], s24 offen offset:1024  lds
    s_add_u32 s24, s24, s25
    s_mov_b32 m0, s31
    s_add_u32 s71, s71, 4
    buffer_load_dword v137, s[40:43], s71 offen lds
    s_add_u32 m0, s26, 32768
    v_mfma_f32_16x16x32_bf16 v[24:27], v[80:83], v[64:67], v[24:27]
    v_mfma_f32_16x16x32_bf16 v[32:35], v[80:83], v[68:71], v[32:35]
    buffer_load_dwordx4 v120, s[8:11], s22 offen offset:0 sc1 lds
    s_setprio 3
    v_mfma_f32_16x16x32_bf16 v[28:31], v[84:87], v[64:67], v[28:31]
    v_mfma_f32_16x16x32_bf16 v[36:39], v[84:87], v[68:71], v[36:39]
    s_setprio 0
    buffer_load_dwordx4 v121, s[8:11], s22 offen offset:1024 sc1 lds
    s_setprio 3
    s_waitcnt lgkmcnt(0)
    v_mfma_f32_16x16x32_bf16 v[8:11], v[48:51], v[40:43], v[8:11]
    v_mfma_f32_16x16x32_bf16 v[16:19], v[48:51], v[44:47], v[16:19]
    ds_read_b128 v[64:67], v127 offset:0
    ds_read_b128 v[68:71], v127 offset:2048
    ds_read_b64_tr_b16 v[72:73], v128 offset:28672
    ds_read_b64_tr_b16 v[74:75], v128 offset:29184
    ds_read_b64_tr_b16 v[76:77], v129 offset:28672
    ds_read_b64_tr_b16 v[78:79], v129 offset:29184
    s_setprio 0
    buffer_load_dwordx4 v122, s[8:11], s22 offen offset:2048 sc1 lds
    s_setprio 3
    v_mfma_f32_16x16x32_bf16 v[12:15], v[52:55], v[40:43], v[12:15]
    v_mfma_f32_16x16x32_bf16 v[20:23], v[52:55], v[44:47], v[20:23]
    ds_read_b64_tr_b16 v[80:81], v130 offset:28672
    ds_read_b64_tr_b16 v[82:83], v130 offset:29184
    ds_read_b64_tr_b16 v[84:85], v131 offset:28672
    ds_read_b64_tr_b16 v[86:87], v131 offset:29184
    ds_read_b32 v4, v3
    s_setprio 0
    buffer_load_dwordx4 v123, s[8:11], s22 offen offset:3072 sc1 lds
    s_add_u32 s22, s22, 128
    s_nop 0
    v_mfma_f32_16x16x32_bf16 v[24:27], v[56:59], v[40:43], v[24:27]
    v_mfma_f32_16x16x32_bf16 v[32:35], v[56:59], v[44:47], v[32:35]
    s_setprio 3
    v_mfma_f32_16x16x32_bf16 v[28:31], v[60:63], v[40:43], v[28:31]
    v_mfma_f32_16x16x32_bf16 v[36:39], v[60:63], v[44:47], v[36:39]
    s_add_u32 m0, s27, 8192
    s_waitcnt vmcnt(7) lgkmcnt(0)
    v_cmp_gt_u32 vcc, 13, v4
    s_cbranch_vccnz L_parallel_sum__grouped_kv_mqa__mixer_gmlp__prompt_gslow_113
L_parallel_sum__grouped_kv_mqa__mixer_gmlp__prompt_gok_112:
    v_mfma_f32_16x16x32_bf16 v[8:11], v[72:75], v[64:67], v[8:11]
    v_mfma_f32_16x16x32_bf16 v[16:19], v[72:75], v[68:71], v[16:19]
    ds_read_b128 v[40:43], v126 offset:16384
    ds_read_b128 v[44:47], v126 offset:18432
    ds_read_b64_tr_b16 v[48:49], v128 offset:32768
    ds_read_b64_tr_b16 v[50:51], v128 offset:33280
    ds_read_b64_tr_b16 v[52:53], v129 offset:32768
    s_setprio 0
    buffer_load_dwordx4 v124, s[12:15], s24 offen offset:0  lds
    s_setprio 3
    v_mfma_f32_16x16x32_bf16 v[12:15], v[76:79], v[64:67], v[12:15]
    v_mfma_f32_16x16x32_bf16 v[20:23], v[76:79], v[68:71], v[20:23]
    ds_read_b64_tr_b16 v[54:55], v129 offset:33280
    ds_read_b64_tr_b16 v[56:57], v130 offset:32768
    ds_read_b64_tr_b16 v[58:59], v130 offset:33280
    ds_read_b64_tr_b16 v[60:61], v131 offset:32768
    ds_read_b64_tr_b16 v[62:63], v131 offset:33280
    s_setprio 0
    buffer_load_dwordx4 v125, s[12:15], s24 offen offset:1024  lds
    s_add_u32 s24, s24, s25
    s_mov_b32 m0, s31
    s_add_u32 s71, s71, 4
    buffer_load_dword v137, s[40:43], s71 offen lds
    s_add_u32 m0, s26, 0
    v_mfma_f32_16x16x32_bf16 v[24:27], v[80:83], v[64:67], v[24:27]
    v_mfma_f32_16x16x32_bf16 v[32:35], v[80:83], v[68:71], v[32:35]
    buffer_load_dwordx4 v120, s[8:11], s22 offen offset:0 sc1 lds
    s_setprio 3
    v_mfma_f32_16x16x32_bf16 v[28:31], v[84:87], v[64:67], v[28:31]
    v_mfma_f32_16x16x32_bf16 v[36:39], v[84:87], v[68:71], v[36:39]
    s_setprio 0
    buffer_load_dwordx4 v121, s[8:11], s22 offen offset:1024 sc1 lds
    s_setprio 3
    s_mov_b32 s12, s56
    s_mov_b32 s13, s57
    s_mov_b32 s14, 0x0021c000
    s_mov_b32 s15, 0x00020000
    s_mul_i32 s24, s20, 55296
    s_lshl_b32 s32, s7, 7
    s_add_u32 s24, s24, s32
    s_add_u32 s24, s24, 0
    s_mov_b32 s25, 221184
    s_waitcnt lgkmcnt(0)
    v_mfma_f32_16x16x32_bf16 v[8:11], v[48:51], v[40:43], v[8:11]
    v_mfma_f32_16x16x32_bf16 v[16:19], v[48:51], v[44:47], v[16:19]
    ds_read_b128 v[64:67], v127 offset:16384
    ds_read_b128 v[68:71], v127 offset:18432
    ds_read_b64_tr_b16 v[72:73], v128 offset:36864
    ds_read_b64_tr_b16 v[74:75], v128 offset:37376
    ds_read_b64_tr_b16 v[76:77], v129 offset:36864
    ds_read_b64_tr_b16 v[78:79], v129 offset:37376
    s_setprio 0
    buffer_load_dwordx4 v122, s[8:11], s22 offen offset:2048 sc1 lds
    s_setprio 3
    v_mfma_f32_16x16x32_bf16 v[12:15], v[52:55], v[40:43], v[12:15]
    v_mfma_f32_16x16x32_bf16 v[20:23], v[52:55], v[44:47], v[20:23]
    ds_read_b64_tr_b16 v[80:81], v130 offset:36864
    ds_read_b64_tr_b16 v[82:83], v130 offset:37376
    ds_read_b64_tr_b16 v[84:85], v131 offset:36864
    ds_read_b64_tr_b16 v[86:87], v131 offset:37376
    ds_read_b32 v4, v3
    s_setprio 0
    buffer_load_dwordx4 v123, s[8:11], s22 offen offset:3072 sc1 lds
    s_add_u32 s22, s22, 128
    s_nop 0
    v_mfma_f32_16x16x32_bf16 v[24:27], v[56:59], v[40:43], v[24:27]
    v_mfma_f32_16x16x32_bf16 v[32:35], v[56:59], v[44:47], v[32:35]
    s_setprio 3
    v_mfma_f32_16x16x32_bf16 v[28:31], v[60:63], v[40:43], v[28:31]
    v_mfma_f32_16x16x32_bf16 v[36:39], v[60:63], v[44:47], v[36:39]
    s_add_u32 m0, s27, 16384
    s_waitcnt vmcnt(7) lgkmcnt(0)
    v_cmp_gt_u32 vcc, 14, v4
    s_cbranch_vccnz L_parallel_sum__grouped_kv_mqa__mixer_gmlp__prompt_gslow_115
L_parallel_sum__grouped_kv_mqa__mixer_gmlp__prompt_gok_114:
    v_mfma_f32_16x16x32_bf16 v[8:11], v[72:75], v[64:67], v[8:11]
    v_mfma_f32_16x16x32_bf16 v[16:19], v[72:75], v[68:71], v[16:19]
    ds_read_b128 v[40:43], v126 offset:32768
    ds_read_b128 v[44:47], v126 offset:34816
    ds_read_b64_tr_b16 v[48:49], v128 offset:40960
    ds_read_b64_tr_b16 v[50:51], v128 offset:41472
    ds_read_b64_tr_b16 v[52:53], v129 offset:40960
    s_setprio 0
    buffer_load_dwordx4 v124, s[12:15], s24 offen offset:0  lds
    s_setprio 3
    v_mfma_f32_16x16x32_bf16 v[12:15], v[76:79], v[64:67], v[12:15]
    v_mfma_f32_16x16x32_bf16 v[20:23], v[76:79], v[68:71], v[20:23]
    ds_read_b64_tr_b16 v[54:55], v129 offset:41472
    ds_read_b64_tr_b16 v[56:57], v130 offset:40960
    ds_read_b64_tr_b16 v[58:59], v130 offset:41472
    ds_read_b64_tr_b16 v[60:61], v131 offset:40960
    ds_read_b64_tr_b16 v[62:63], v131 offset:41472
    s_setprio 0
    buffer_load_dwordx4 v125, s[12:15], s24 offen offset:1024  lds
    s_add_u32 s24, s24, s25
    s_mov_b32 m0, s31
    s_add_u32 s71, s71, 4
    buffer_load_dword v137, s[40:43], s71 offen lds
    s_add_u32 m0, s26, 16384
    v_mfma_f32_16x16x32_bf16 v[24:27], v[80:83], v[64:67], v[24:27]
    v_mfma_f32_16x16x32_bf16 v[32:35], v[80:83], v[68:71], v[32:35]
    buffer_load_dwordx4 v120, s[8:11], s22 offen offset:0 sc1 lds
    buffer_load_dwordx4 v121, s[8:11], s22 offen offset:1024 sc1 lds
    s_setprio 3
    v_mfma_f32_16x16x32_bf16 v[28:31], v[84:87], v[64:67], v[28:31]
    v_mfma_f32_16x16x32_bf16 v[36:39], v[84:87], v[68:71], v[36:39]
    s_setprio 0
    buffer_load_dwordx4 v122, s[8:11], s22 offen offset:2048 sc1 lds
    buffer_load_dwordx4 v123, s[8:11], s22 offen offset:3072 sc1 lds
    s_setprio 3
    s_add_u32 s22, s22, 128
    s_mov_b32 s22, s23
    s_waitcnt lgkmcnt(0)
    v_mfma_f32_16x16x32_bf16 v[8:11], v[48:51], v[40:43], v[8:11]
    v_mfma_f32_16x16x32_bf16 v[16:19], v[48:51], v[44:47], v[16:19]
    ds_read_b128 v[64:67], v127 offset:32768
    ds_read_b128 v[68:71], v127 offset:34816
    ds_read_b64_tr_b16 v[72:73], v128 offset:45056
    ds_read_b64_tr_b16 v[74:75], v128 offset:45568
    ds_read_b64_tr_b16 v[76:77], v129 offset:45056
    ds_read_b64_tr_b16 v[78:79], v129 offset:45568
    v_mfma_f32_16x16x32_bf16 v[12:15], v[52:55], v[40:43], v[12:15]
    v_mfma_f32_16x16x32_bf16 v[20:23], v[52:55], v[44:47], v[20:23]
    ds_read_b64_tr_b16 v[80:81], v130 offset:45056
    ds_read_b64_tr_b16 v[82:83], v130 offset:45568
    ds_read_b64_tr_b16 v[84:85], v131 offset:45056
    ds_read_b64_tr_b16 v[86:87], v131 offset:45568
    ds_read_b32 v4, v3
    s_setprio 0
    v_mfma_f32_16x16x32_bf16 v[24:27], v[56:59], v[40:43], v[24:27]
    v_mfma_f32_16x16x32_bf16 v[32:35], v[56:59], v[44:47], v[32:35]
    s_setprio 3
    v_mfma_f32_16x16x32_bf16 v[28:31], v[60:63], v[40:43], v[28:31]
    v_mfma_f32_16x16x32_bf16 v[36:39], v[60:63], v[44:47], v[36:39]
    s_add_u32 m0, s27, 24576
    s_waitcnt vmcnt(7) lgkmcnt(0)
    v_cmp_gt_u32 vcc, 15, v4
    s_cbranch_vccnz L_parallel_sum__grouped_kv_mqa__mixer_gmlp__prompt_gslow_117
L_parallel_sum__grouped_kv_mqa__mixer_gmlp__prompt_gok_116:
    v_mfma_f32_16x16x32_bf16 v[8:11], v[72:75], v[64:67], v[8:11]
    v_mfma_f32_16x16x32_bf16 v[16:19], v[72:75], v[68:71], v[16:19]
    ds_read_b128 v[40:43], v126 offset:0
    ds_read_b128 v[44:47], v126 offset:2048
    ds_read_b64_tr_b16 v[48:49], v128 offset:0
    ds_read_b64_tr_b16 v[50:51], v128 offset:512
    ds_read_b64_tr_b16 v[52:53], v129 offset:0
    s_setprio 0
    buffer_load_dwordx4 v124, s[12:15], s24 offen offset:0  lds
    s_setprio 3
    v_mfma_f32_16x16x32_bf16 v[12:15], v[76:79], v[64:67], v[12:15]
    v_mfma_f32_16x16x32_bf16 v[20:23], v[76:79], v[68:71], v[20:23]
    ds_read_b64_tr_b16 v[54:55], v129 offset:512
    ds_read_b64_tr_b16 v[56:57], v130 offset:0
    ds_read_b64_tr_b16 v[58:59], v130 offset:512
    ds_read_b64_tr_b16 v[60:61], v131 offset:0
    ds_read_b64_tr_b16 v[62:63], v131 offset:512
    s_setprio 0
    buffer_load_dwordx4 v125, s[12:15], s24 offen offset:1024  lds
    s_add_u32 s24, s24, s25
    s_mov_b32 m0, s31
    s_add_u32 s71, s71, 4
    buffer_load_dword v137, s[40:43], s71 offen lds
    s_add_u32 m0, s26, 32768
    v_mfma_f32_16x16x32_bf16 v[24:27], v[80:83], v[64:67], v[24:27]
    v_mfma_f32_16x16x32_bf16 v[32:35], v[80:83], v[68:71], v[32:35]
    buffer_load_dwordx4 v120, s[8:11], s22 offen offset:0 sc1 lds
    s_setprio 3
    v_mfma_f32_16x16x32_bf16 v[28:31], v[84:87], v[64:67], v[28:31]
    v_mfma_f32_16x16x32_bf16 v[36:39], v[84:87], v[68:71], v[36:39]
    s_setprio 0
    buffer_load_dwordx4 v121, s[8:11], s22 offen offset:1024 sc1 lds
    s_setprio 3
    s_waitcnt lgkmcnt(0)
    v_mfma_f32_16x16x32_bf16 v[8:11], v[48:51], v[40:43], v[8:11]
    v_mfma_f32_16x16x32_bf16 v[16:19], v[48:51], v[44:47], v[16:19]
    ds_read_b128 v[64:67], v127 offset:0
    ds_read_b128 v[68:71], v127 offset:2048
    ds_read_b64_tr_b16 v[72:73], v128 offset:4096
    ds_read_b64_tr_b16 v[74:75], v128 offset:4608
    ds_read_b64_tr_b16 v[76:77], v129 offset:4096
    ds_read_b64_tr_b16 v[78:79], v129 offset:4608
    s_setprio 0
    buffer_load_dwordx4 v122, s[8:11], s22 offen offset:2048 sc1 lds
    s_setprio 3
    v_mfma_f32_16x16x32_bf16 v[12:15], v[52:55], v[40:43], v[12:15]
    v_mfma_f32_16x16x32_bf16 v[20:23], v[52:55], v[44:47], v[20:23]
    ds_read_b64_tr_b16 v[80:81], v130 offset:4096
    ds_read_b64_tr_b16 v[82:83], v130 offset:4608
    ds_read_b64_tr_b16 v[84:85], v131 offset:4096
    ds_read_b64_tr_b16 v[86:87], v131 offset:4608
    ds_read_b32 v4, v3
    s_setprio 0
    buffer_load_dwordx4 v123, s[8:11], s22 offen offset:3072 sc1 lds
    s_add_u32 s22, s22, 128
    s_nop 0
    v_mfma_f32_16x16x32_bf16 v[24:27], v[56:59], v[40:43], v[24:27]
    v_mfma_f32_16x16x32_bf16 v[32:35], v[56:59], v[44:47], v[32:35]
    s_setprio 3
    v_mfma_f32_16x16x32_bf16 v[28:31], v[60:63], v[40:43], v[28:31]
    v_mfma_f32_16x16x32_bf16 v[36:39], v[60:63], v[44:47], v[36:39]
    s_add_u32 m0, s27, 32768
    s_waitcnt vmcnt(7) lgkmcnt(0)
    v_cmp_gt_u32 vcc, 16, v4
    s_cbranch_vccnz L_parallel_sum__grouped_kv_mqa__mixer_gmlp__prompt_gslow_119
L_parallel_sum__grouped_kv_mqa__mixer_gmlp__prompt_gok_118:
    v_mfma_f32_16x16x32_bf16 v[8:11], v[72:75], v[64:67], v[8:11]
    v_mfma_f32_16x16x32_bf16 v[16:19], v[72:75], v[68:71], v[16:19]
    ds_read_b128 v[40:43], v126 offset:16384
    ds_read_b128 v[44:47], v126 offset:18432
    ds_read_b64_tr_b16 v[48:49], v128 offset:8192
    ds_read_b64_tr_b16 v[50:51], v128 offset:8704
    ds_read_b64_tr_b16 v[52:53], v129 offset:8192
    s_setprio 0
    buffer_load_dwordx4 v124, s[12:15], s24 offen offset:0  lds
    s_setprio 3
    v_mfma_f32_16x16x32_bf16 v[12:15], v[76:79], v[64:67], v[12:15]
    v_mfma_f32_16x16x32_bf16 v[20:23], v[76:79], v[68:71], v[20:23]
    ds_read_b64_tr_b16 v[54:55], v129 offset:8704
    ds_read_b64_tr_b16 v[56:57], v130 offset:8192
    ds_read_b64_tr_b16 v[58:59], v130 offset:8704
    ds_read_b64_tr_b16 v[60:61], v131 offset:8192
    ds_read_b64_tr_b16 v[62:63], v131 offset:8704
    s_setprio 0
    buffer_load_dwordx4 v125, s[12:15], s24 offen offset:1024  lds
    s_add_u32 s24, s24, s25
    s_mov_b32 m0, s31
    s_add_u32 s71, s71, 4
    buffer_load_dword v137, s[40:43], s71 offen lds
    s_add_u32 m0, s26, 0
    v_mfma_f32_16x16x32_bf16 v[24:27], v[80:83], v[64:67], v[24:27]
    v_mfma_f32_16x16x32_bf16 v[32:35], v[80:83], v[68:71], v[32:35]
    buffer_load_dwordx4 v120, s[8:11], s22 offen offset:0 sc1 lds
    s_setprio 3
    v_mfma_f32_16x16x32_bf16 v[28:31], v[84:87], v[64:67], v[28:31]
    v_mfma_f32_16x16x32_bf16 v[36:39], v[84:87], v[68:71], v[36:39]
    s_setprio 0
    buffer_load_dwordx4 v121, s[8:11], s22 offen offset:1024 sc1 lds
    s_setprio 3
    s_waitcnt lgkmcnt(0)
    v_mfma_f32_16x16x32_bf16 v[8:11], v[48:51], v[40:43], v[8:11]
    v_mfma_f32_16x16x32_bf16 v[16:19], v[48:51], v[44:47], v[16:19]
    ds_read_b128 v[64:67], v127 offset:16384
    ds_read_b128 v[68:71], v127 offset:18432
    ds_read_b64_tr_b16 v[72:73], v128 offset:12288
    ds_read_b64_tr_b16 v[74:75], v128 offset:12800
    ds_read_b64_tr_b16 v[76:77], v129 offset:12288
    ds_read_b64_tr_b16 v[78:79], v129 offset:12800
    s_setprio 0
    buffer_load_dwordx4 v122, s[8:11], s22 offen offset:2048 sc1 lds
    s_setprio 3
    v_mfma_f32_16x16x32_bf16 v[12:15], v[52:55], v[40:43], v[12:15]
    v_mfma_f32_16x16x32_bf16 v[20:23], v[52:55], v[44:47], v[20:23]
    ds_read_b64_tr_b16 v[80:81], v130 offset:12288
    ds_read_b64_tr_b16 v[82:83], v130 offset:12800
    ds_read_b64_tr_b16 v[84:85], v131 offset:12288
    ds_read_b64_tr_b16 v[86:87], v131 offset:12800
    ds_read_b32 v4, v3
    s_setprio 0
    buffer_load_dwordx4 v123, s[8:11], s22 offen offset:3072 sc1 lds
    s_add_u32 s22, s22, 128
    s_nop 0
    v_mfma_f32_16x16x32_bf16 v[24:27], v[56:59], v[40:43], v[24:27]
    v_mfma_f32_16x16x32_bf16 v[32:35], v[56:59], v[44:47], v[32:35]
    s_setprio 3
    v_mfma_f32_16x16x32_bf16 v[28:31], v[60:63], v[40:43], v[28:31]
    v_mfma_f32_16x16x32_bf16 v[36:39], v[60:63], v[44:47], v[36:39]
    s_add_u32 m0, s27, 40960
    s_waitcnt vmcnt(7) lgkmcnt(0)
    v_cmp_gt_u32 vcc, 17, v4
    s_cbranch_vccnz L_parallel_sum__grouped_kv_mqa__mixer_gmlp__prompt_gslow_121
L_parallel_sum__grouped_kv_mqa__mixer_gmlp__prompt_gok_120:
    v_mfma_f32_16x16x32_bf16 v[8:11], v[72:75], v[64:67], v[8:11]
    v_mfma_f32_16x16x32_bf16 v[16:19], v[72:75], v[68:71], v[16:19]
    ds_read_b128 v[40:43], v126 offset:32768
    ds_read_b128 v[44:47], v126 offset:34816
    ds_read_b64_tr_b16 v[48:49], v128 offset:16384
    ds_read_b64_tr_b16 v[50:51], v128 offset:16896
    ds_read_b64_tr_b16 v[52:53], v129 offset:16384
    s_setprio 0
    buffer_load_dwordx4 v124, s[12:15], s24 offen offset:0  lds
    s_setprio 3
    v_mfma_f32_16x16x32_bf16 v[12:15], v[76:79], v[64:67], v[12:15]
    v_mfma_f32_16x16x32_bf16 v[20:23], v[76:79], v[68:71], v[20:23]
    ds_read_b64_tr_b16 v[54:55], v129 offset:16896
    ds_read_b64_tr_b16 v[56:57], v130 offset:16384
    ds_read_b64_tr_b16 v[58:59], v130 offset:16896
    ds_read_b64_tr_b16 v[60:61], v131 offset:16384
    ds_read_b64_tr_b16 v[62:63], v131 offset:16896
    s_setprio 0
    buffer_load_dwordx4 v125, s[12:15], s24 offen offset:1024  lds
    s_add_u32 s24, s24, s25
    s_mov_b32 m0, s31
    s_add_u32 s71, s71, 4
    buffer_load_dword v137, s[40:43], s71 offen lds
    s_add_u32 m0, s26, 16384
    v_mfma_f32_16x16x32_bf16 v[24:27], v[80:83], v[64:67], v[24:27]
    v_mfma_f32_16x16x32_bf16 v[32:35], v[80:83], v[68:71], v[32:35]
    buffer_load_dwordx4 v120, s[8:11], s22 offen offset:0 sc1 lds
    s_setprio 3
    v_mfma_f32_16x16x32_bf16 v[28:31], v[84:87], v[64:67], v[28:31]
    v_mfma_f32_16x16x32_bf16 v[36:39], v[84:87], v[68:71], v[36:39]
    s_setprio 0
    buffer_load_dwordx4 v121, s[8:11], s22 offen offset:1024 sc1 lds
    s_setprio 3
    v_mov_b32 v156, 0xbdd2d3e8
    v_mov_b32 v157, 0xc0135761
    v_mov_b32 v154, 0
    v_mov_b32 v155, 0
    v_mov_b32 v150, 0
    v_mov_b32 v151, 0
    s_nop 1
    s_cmp_eq_u32 s7, 0
    s_cbranch_scc1 L_parallel_sum__grouped_kv_mqa__mixer_gmlp__prompt_s0_122
    v_mul_f32 v64, v8, v8
    v_mul_f32 v65, v9, v9
    v_mul_f32 v66, v10, v10
    v_mul_f32 v67, v11, v11
    v_mul_f32 v68, v12, v12
    v_mul_f32 v69, v13, v13
    v_mul_f32 v70, v14, v14
    v_mul_f32_e64 v71, v15, v15
    v_fmaak_f32 v64, v156, v64, 0xc0135761
    v_fmaak_f32 v65, v156, v65, 0xc0135761
    v_fmaak_f32 v66, v156, v66, 0xc0135761
    v_fmaak_f32 v67, v156, v67, 0xc0135761
    v_fmaak_f32 v68, v156, v68, 0xc0135761
    v_fmaak_f32 v69, v156, v69, 0xc0135761
    v_fmaak_f32 v70, v156, v70, 0xc0135761
    v_fmaak_f32 v71, v156, v71, 0xc0135761
    v_mul_f32 v64, v64, v8
    v_mul_f32 v65, v65, v9
    v_mul_f32 v66, v66, v10
    v_mul_f32 v67, v67, v11
    v_mul_f32 v68, v68, v12
    v_mul_f32 v69, v69, v13
    v_mul_f32 v70, v70, v14
    v_mul_f32 v71, v71, v15
    v_exp_f32 v64, v64
    v_exp_f32 v65, v65
    v_exp_f32 v66, v66
    v_exp_f32 v67, v67
    v_exp_f32 v68, v68
    v_exp_f32 v69, v69
    v_exp_f32 v70, v70
    v_exp_f32 v71, v71
    v_add_f32 v64, 1.0, v64
    v_add_f32 v65, 1.0, v65
    v_add_f32 v66, 1.0, v66
    v_add_f32 v67, 1.0, v67
    v_add_f32 v68, 1.0, v68
    v_add_f32 v69, 1.0, v69
    v_add_f32 v70, 1.0, v70
    v_add_f32 v71, 1.0, v71
    v_rcp_f32 v64, v64
    v_rcp_f32 v65, v65
    v_rcp_f32 v66, v66
    v_rcp_f32 v67, v67
    v_rcp_f32 v68, v68
    v_rcp_f32 v69, v69
    v_rcp_f32 v70, v70
    v_rcp_f32 v71, v71
    v_mul_f32 v64, v64, v8
    v_mul_f32 v65, v65, v9
    v_mul_f32 v66, v66, v10
    v_mul_f32 v67, v67, v11
    v_mul_f32 v68, v68, v12
    v_mul_f32 v69, v69, v13
    v_mul_f32 v70, v70, v14
    v_mul_f32 v71, v71, v15
    v_cvt_pk_bf16_f32 v104, v64, v65
    v_cvt_pk_bf16_f32 v105, v66, v67
    v_cvt_pk_bf16_f32 v106, v68, v69
    v_cvt_pk_bf16_f32 v107, v70, v71
    v_add_f32 v154, v154, v64
    v_fmac_f32 v155, v64, v64
    v_add_f32 v154, v154, v65
    v_fmac_f32 v155, v65, v65
    v_add_f32 v154, v154, v66
    v_fmac_f32 v155, v66, v66
    v_add_f32 v154, v154, v67
    v_fmac_f32 v155, v67, v67
    v_add_f32 v154, v154, v68
    v_fmac_f32 v155, v68, v68
    v_add_f32 v154, v154, v69
    v_fmac_f32 v155, v69, v69
    v_add_f32 v154, v154, v70
    v_fmac_f32 v155, v70, v70
    v_add_f32 v154, v154, v71
    v_fmac_f32 v155, v71, v71
    v_mul_f32 v64, v16, v16
    v_mul_f32 v65, v17, v17
    v_mul_f32 v66, v18, v18
    v_mul_f32 v67, v19, v19
    v_mul_f32 v68, v20, v20
    v_mul_f32 v69, v21, v21
    v_mul_f32 v70, v22, v22
    v_mul_f32 v71, v23, v23
    v_fmaak_f32 v64, v156, v64, 0xc0135761
    v_fmaak_f32 v65, v156, v65, 0xc0135761
    v_fmaak_f32 v66, v156, v66, 0xc0135761
    v_fmaak_f32 v67, v156, v67, 0xc0135761
    v_fmaak_f32 v68, v156, v68, 0xc0135761
    v_fmaak_f32 v69, v156, v69, 0xc0135761
    v_fmaak_f32 v70, v156, v70, 0xc0135761
    v_fmaak_f32 v71, v156, v71, 0xc0135761
    v_mul_f32 v64, v64, v16
    v_mul_f32 v65, v65, v17
    v_mul_f32 v66, v66, v18
    v_mul_f32 v67, v67, v19
    v_mul_f32 v68, v68, v20
    v_mul_f32 v69, v69, v21
    v_mul_f32 v70, v70, v22
    v_mul_f32 v71, v71, v23
    v_exp_f32 v64, v64
    v_exp_f32 v65, v65
    v_exp_f32 v66, v66
    v_exp_f32 v67, v67
    v_exp_f32 v68, v68
    v_exp_f32 v69, v69
    v_exp_f32 v70, v70
    v_exp_f32 v71, v71
    v_add_f32 v64, 1.0, v64
    v_add_f32 v65, 1.0, v65
    v_add_f32 v66, 1.0, v66
    v_add_f32 v67, 1.0, v67
    v_add_f32 v68, 1.0, v68
    v_add_f32 v69, 1.0, v69
    v_add_f32 v70, 1.0, v70
    v_add_f32 v71, 1.0, v71
    v_rcp_f32 v64, v64
    v_rcp_f32 v65, v65
    v_rcp_f32 v66, v66
    v_rcp_f32 v67, v67
    v_rcp_f32 v68, v68
    v_rcp_f32 v69, v69
    v_rcp_f32 v70, v70
    v_rcp_f32 v71, v71
    v_mul_f32 v64, v64, v16
    v_mul_f32 v65, v65, v17
    v_mul_f32 v66, v66, v18
    v_mul_f32 v67, v67, v19
    v_mul_f32 v68, v68, v20
    v_mul_f32 v69, v69, v21
    v_mul_f32 v70, v70, v22
    v_mul_f32 v71, v71, v23
    v_cvt_pk_bf16_f32 v108, v64, v65
    v_cvt_pk_bf16_f32 v109, v66, v67
    v_cvt_pk_bf16_f32 v110, v68, v69
    v_cvt_pk_bf16_f32 v111, v70, v71
    v_add_f32 v150, v150, v64
    v_fmac_f32 v151, v64, v64
    v_add_f32 v150, v150, v65
    v_fmac_f32 v151, v65, v65
    v_add_f32 v150, v150, v66
    v_fmac_f32 v151, v66, v66
    v_add_f32 v150, v150, v67
    v_fmac_f32 v151, v67, v67
    v_add_f32 v150, v150, v68
    v_fmac_f32 v151, v68, v68
    v_add_f32 v150, v150, v69
    v_fmac_f32 v151, v69, v69
    v_add_f32 v150, v150, v70
    v_fmac_f32 v151, v70, v70
    v_add_f32 v150, v150, v71
    v_fmac_f32 v151, v71, v71
L_parallel_sum__grouped_kv_mqa__mixer_gmlp__prompt_s0_122:
    v_mul_f32 v64, v24, v24
    v_mul_f32 v65, v25, v25
    v_mul_f32 v66, v26, v26
    v_mul_f32 v67, v27, v27
    v_mul_f32 v68, v28, v28
    v_mul_f32 v69, v29, v29
    v_mul_f32 v70, v30, v30
    v_mul_f32 v71, v31, v31
    v_fmaak_f32 v64, v156, v64, 0xc0135761
    v_fmaak_f32 v65, v156, v65, 0xc0135761
    v_fmaak_f32 v66, v156, v66, 0xc0135761
    v_fmaak_f32 v67, v156, v67, 0xc0135761
    v_fmaak_f32 v68, v156, v68, 0xc0135761
    v_fmaak_f32 v69, v156, v69, 0xc0135761
    v_fmaak_f32 v70, v156, v70, 0xc0135761
    v_fmaak_f32 v71, v156, v71, 0xc0135761
    v_mul_f32 v64, v64, v24
    v_mul_f32 v65, v65, v25
    v_mul_f32 v66, v66, v26
    v_mul_f32 v67, v67, v27
    v_mul_f32 v68, v68, v28
    v_mul_f32 v69, v69, v29
    v_mul_f32 v70, v70, v30
    v_mul_f32 v71, v71, v31
    v_exp_f32 v64, v64
    v_exp_f32 v65, v65
    v_exp_f32 v66, v66
    v_exp_f32 v67, v67
    v_exp_f32 v68, v68
    v_exp_f32 v69, v69
    v_exp_f32 v70, v70
    v_exp_f32 v71, v71
    v_add_f32 v64, 1.0, v64
    v_add_f32 v65, 1.0, v65
    v_add_f32 v66, 1.0, v66
    v_add_f32 v67, 1.0, v67
    v_add_f32 v68, 1.0, v68
    v_add_f32 v69, 1.0, v69
    v_add_f32 v70, 1.0, v70
    v_add_f32 v71, 1.0, v71
    v_rcp_f32 v64, v64
    v_rcp_f32 v65, v65
    v_rcp_f32 v66, v66
    v_rcp_f32 v67, v67
    v_rcp_f32 v68, v68
    v_rcp_f32 v69, v69
    v_rcp_f32 v70, v70
    v_rcp_f32 v71, v71
    v_mul_f32 v64, v64, v24
    v_mul_f32 v65, v65, v25
    v_mul_f32 v66, v66, v26
    v_mul_f32 v67, v67, v27
    v_mul_f32 v68, v68, v28
    v_mul_f32 v69, v69, v29
    v_mul_f32 v70, v70, v30
    v_mul_f32 v71, v71, v31
    v_cvt_pk_bf16_f32 v112, v64, v65
    v_cvt_pk_bf16_f32 v113, v66, v67
    v_cvt_pk_bf16_f32 v114, v68, v69
    v_cvt_pk_bf16_f32 v115, v70, v71
    v_add_f32 v154, v154, v64
    v_fmac_f32 v155, v64, v64
    v_add_f32 v154, v154, v65
    v_fmac_f32 v155, v65, v65
    v_add_f32 v154, v154, v66
    v_fmac_f32 v155, v66, v66
    v_add_f32 v154, v154, v67
    v_fmac_f32 v155, v67, v67
    v_add_f32 v154, v154, v68
    v_fmac_f32 v155, v68, v68
    v_add_f32 v154, v154, v69
    v_fmac_f32 v155, v69, v69
    v_add_f32 v154, v154, v70
    v_fmac_f32 v155, v70, v70
    v_add_f32 v154, v154, v71
    v_fmac_f32 v155, v71, v71
    v_mul_f32 v64, v32, v32
    v_mul_f32 v65, v33, v33
    v_mul_f32 v66, v34, v34
    v_mul_f32 v67, v35, v35
    v_mul_f32 v68, v36, v36
    v_mul_f32 v69, v37, v37
    v_mul_f32 v70, v38, v38
    v_mul_f32 v71, v39, v39
    v_fmaak_f32 v64, v156, v64, 0xc0135761
    v_fmaak_f32 v65, v156, v65, 0xc0135761
    v_fmaak_f32 v66, v156, v66, 0xc0135761
    v_fmaak_f32 v67, v156, v67, 0xc0135761
    v_fmaak_f32 v68, v156, v68, 0xc0135761
    v_fmaak_f32 v69, v156, v69, 0xc0135761
    v_fmaak_f32 v70, v156, v70, 0xc0135761
    v_fmaak_f32 v71, v156, v71, 0xc0135761
    v_mul_f32 v64, v64, v32
    v_mul_f32 v65, v65, v33
    v_mul_f32 v66, v66, v34
    v_mul_f32 v67, v67, v35
    v_mul_f32 v68, v68, v36
    v_mul_f32 v69, v69, v37
    v_mul_f32 v70, v70, v38
    v_mul_f32 v71, v71, v39
    v_exp_f32 v64, v64
    v_exp_f32 v65, v65
    v_exp_f32 v66, v66
    v_exp_f32 v67, v67
    v_exp_f32 v68, v68
    v_exp_f32 v69, v69
    v_exp_f32 v70, v70
    v_exp_f32 v71, v71
    v_add_f32 v64, 1.0, v64
    v_add_f32 v65, 1.0, v65
    v_add_f32 v66, 1.0, v66
    v_add_f32 v67, 1.0, v67
    v_add_f32 v68, 1.0, v68
    v_add_f32 v69, 1.0, v69
    v_add_f32 v70, 1.0, v70
    v_add_f32 v71, 1.0, v71
    v_rcp_f32 v64, v64
    v_rcp_f32 v65, v65
    v_rcp_f32 v66, v66
    v_rcp_f32 v67, v67
    v_rcp_f32 v68, v68
    v_rcp_f32 v69, v69
    v_rcp_f32 v70, v70
    v_rcp_f32 v71, v71
    v_mul_f32 v64, v64, v32
    v_mul_f32 v65, v65, v33
    v_mul_f32 v66, v66, v34
    v_mul_f32 v67, v67, v35
    v_mul_f32 v68, v68, v36
    v_mul_f32 v69, v69, v37
    v_mul_f32 v70, v70, v38
    v_mul_f32 v71, v71, v39
    v_cvt_pk_bf16_f32 v116, v64, v65
    v_cvt_pk_bf16_f32 v117, v66, v67
    v_cvt_pk_bf16_f32 v118, v68, v69
    v_cvt_pk_bf16_f32 v119, v70, v71
    v_add_f32 v150, v150, v64
    v_fmac_f32 v151, v64, v64
    v_add_f32 v150, v150, v65
    v_fmac_f32 v151, v65, v65
    v_add_f32 v150, v150, v66
    v_fmac_f32 v151, v66, v66
    v_add_f32 v150, v150, v67
    v_fmac_f32 v151, v67, v67
    v_add_f32 v150, v150, v68
    v_fmac_f32 v151, v68, v68
    v_add_f32 v150, v150, v69
    v_fmac_f32 v151, v69, v69
    v_add_f32 v150, v150, v70
    v_fmac_f32 v151, v70, v70
    v_add_f32 v150, v150, v71
    v_fmac_f32 v151, v71, v71
    s_add_u32 s16, s68, 0x00580000
    s_addc_u32 s17, s69, 0
    s_mov_b32 s18, 0x00070000
    s_mov_b32 s19, 0x00020000
    v_permlane16_swap_b32 v154, v150
    v_permlane16_swap_b32 v155, v151
    v_add_f32 v154, v154, v150
    v_add_f32 v155, v155, v151
    v_mov_b32 v146, v154
    v_mov_b32 v147, v155
    s_mul_i32 s32, s6, 14
    s_add_u32 s32, s32, s7
    v_permlane32_swap_b32 v154, v146
    v_permlane32_swap_b32 v155, v147
    s_lshl_b32 s32, s32, 11
    s_lshl_b32 s33, s20, 9
    v_add_f32 v148, v154, v146
    v_add_f32 v150, v155, v147
    v_mov_b32 v149, s96
    v_mov_b32_e64 v151, s96
    v_lshlrev_b32 v146, 4, v134
    s_add_u32 s32, s32, s33
    buffer_store_dwordx4 v[148:151], v146, s[16:19], s32 offen sc1
    s_nop 0
    s_waitcnt lgkmcnt(0)
    v_mfma_f32_16x16x32_bf16 v[8:11], v[48:51], v[40:43], 0
    v_mfma_f32_16x16x32_bf16 v[16:19], v[48:51], v[44:47], 0
    ds_read_b128 v[64:67], v127 offset:32768
    ds_read_b128 v[68:71], v127 offset:34816
    ds_read_b64_tr_b16 v[72:73], v128 offset:20480
    ds_read_b64_tr_b16 v[74:75], v128 offset:20992
    ds_read_b64_tr_b16 v[76:77], v129 offset:20480
    ds_read_b64_tr_b16 v[78:79], v129 offset:20992
    s_setprio 0
    buffer_load_dwordx4 v122, s[8:11], s22 offen offset:2048 sc1 lds
    s_setprio 3
    v_mfma_f32_16x16x32_bf16 v[12:15], v[52:55], v[40:43], 0
    v_mfma_f32_16x16x32_bf16 v[20:23], v[52:55], v[44:47], 0
    ds_read_b64_tr_b16 v[80:81], v130 offset:20480
    ds_read_b64_tr_b16 v[82:83], v130 offset:20992
    ds_read_b64_tr_b16 v[84:85], v131 offset:20480
    ds_read_b64_tr_b16 v[86:87], v131 offset:20992
    ds_read_b32 v4, v3
    s_setprio 0
    buffer_load_dwordx4 v123, s[8:11], s22 offen offset:3072 sc1 lds
    s_add_u32 s22, s22, 128
    s_nop 0
    v_mfma_f32_16x16x32_bf16 v[24:27], v[56:59], v[40:43], 0
    v_mfma_f32_16x16x32_bf16 v[32:35], v[56:59], v[44:47], 0
    s_setprio 3
    v_mfma_f32_16x16x32_bf16 v[28:31], v[60:63], v[40:43], 0
    v_mfma_f32_16x16x32_bf16 v[36:39], v[60:63], v[44:47], 0
    s_add_u32 m0, s27, 0
    s_waitcnt vmcnt(8) lgkmcnt(0)
    v_cmp_gt_u32 vcc, 18, v4
    s_cbranch_vccnz L_parallel_sum__grouped_kv_mqa__mixer_gmlp__prompt_gslow_124
L_parallel_sum__grouped_kv_mqa__mixer_gmlp__prompt_gok_123:
    v_mfma_f32_16x16x32_bf16 v[8:11], v[72:75], v[64:67], v[8:11]
    v_mfma_f32_16x16x32_bf16 v[16:19], v[72:75], v[68:71], v[16:19]
    ds_read_b128 v[40:43], v126 offset:0
    ds_read_b128 v[44:47], v126 offset:2048
    ds_read_b64_tr_b16 v[48:49], v128 offset:24576
    ds_read_b64_tr_b16 v[50:51], v128 offset:25088
    ds_read_b64_tr_b16 v[52:53], v129 offset:24576
    s_setprio 0
    buffer_load_dwordx4 v124, s[12:15], s24 offen offset:0  lds
    s_setprio 3
    v_mfma_f32_16x16x32_bf16 v[12:15], v[76:79], v[64:67], v[12:15]
    v_mfma_f32_16x16x32_bf16 v[20:23], v[76:79], v[68:71], v[20:23]
    ds_read_b64_tr_b16 v[54:55], v129 offset:25088
    ds_read_b64_tr_b16 v[56:57], v130 offset:24576
    ds_read_b64_tr_b16 v[58:59], v130 offset:25088
    ds_read_b64_tr_b16 v[60:61], v131 offset:24576
    ds_read_b64_tr_b16 v[62:63], v131 offset:25088
    s_setprio 0
    buffer_load_dwordx4 v125, s[12:15], s24 offen offset:1024  lds
    s_add_u32 s24, s24, s25
    s_mov_b32 m0, s31
    s_add_u32 s71, s71, 4
    buffer_load_dword v137, s[40:43], s71 offen lds
    s_add_u32 m0, s26, 32768
    v_mfma_f32_16x16x32_bf16 v[24:27], v[80:83], v[64:67], v[24:27]
    v_mfma_f32_16x16x32_bf16 v[32:35], v[80:83], v[68:71], v[32:35]
    buffer_load_dwordx4 v120, s[8:11], s22 offen offset:0 sc1 lds
    s_setprio 3
    v_mfma_f32_16x16x32_bf16 v[28:31], v[84:87], v[64:67], v[28:31]
    v_mfma_f32_16x16x32_bf16 v[36:39], v[84:87], v[68:71], v[36:39]
    s_setprio 0
    buffer_load_dwordx4 v121, s[8:11], s22 offen offset:1024 sc1 lds
    s_setprio 3
    s_waitcnt lgkmcnt(0)
    v_mfma_f32_16x16x32_bf16 v[8:11], v[48:51], v[40:43], v[8:11]
    v_mfma_f32_16x16x32_bf16 v[16:19], v[48:51], v[44:47], v[16:19]
    ds_read_b128 v[64:67], v127 offset:0
    ds_read_b128 v[68:71], v127 offset:2048
    ds_read_b64_tr_b16 v[72:73], v128 offset:28672
    ds_read_b64_tr_b16 v[74:75], v128 offset:29184
    ds_read_b64_tr_b16 v[76:77], v129 offset:28672
    ds_read_b64_tr_b16 v[78:79], v129 offset:29184
    s_setprio 0
    buffer_load_dwordx4 v122, s[8:11], s22 offen offset:2048 sc1 lds
    s_setprio 3
    v_mfma_f32_16x16x32_bf16 v[12:15], v[52:55], v[40:43], v[12:15]
    v_mfma_f32_16x16x32_bf16 v[20:23], v[52:55], v[44:47], v[20:23]
    ds_read_b64_tr_b16 v[80:81], v130 offset:28672
    ds_read_b64_tr_b16 v[82:83], v130 offset:29184
    ds_read_b64_tr_b16 v[84:85], v131 offset:28672
    ds_read_b64_tr_b16 v[86:87], v131 offset:29184
    ds_read_b32 v4, v3
    s_setprio 0
    buffer_load_dwordx4 v123, s[8:11], s22 offen offset:3072 sc1 lds
    s_add_u32 s22, s22, 128
    s_nop 0
    v_mfma_f32_16x16x32_bf16 v[24:27], v[56:59], v[40:43], v[24:27]
    v_mfma_f32_16x16x32_bf16 v[32:35], v[56:59], v[44:47], v[32:35]
    s_setprio 3
    v_mfma_f32_16x16x32_bf16 v[28:31], v[60:63], v[40:43], v[28:31]
    v_mfma_f32_16x16x32_bf16 v[36:39], v[60:63], v[44:47], v[36:39]
    s_add_u32 m0, s27, 8192
    s_waitcnt vmcnt(7) lgkmcnt(0)
    v_cmp_gt_u32 vcc, 19, v4
    s_cbranch_vccnz L_parallel_sum__grouped_kv_mqa__mixer_gmlp__prompt_gslow_126
L_parallel_sum__grouped_kv_mqa__mixer_gmlp__prompt_gok_125:
    v_mfma_f32_16x16x32_bf16 v[8:11], v[72:75], v[64:67], v[8:11]
    v_mfma_f32_16x16x32_bf16 v[16:19], v[72:75], v[68:71], v[16:19]
    ds_read_b128 v[40:43], v126 offset:16384
    ds_read_b128 v[44:47], v126 offset:18432
    ds_read_b64_tr_b16 v[48:49], v128 offset:32768
    ds_read_b64_tr_b16 v[50:51], v128 offset:33280
    ds_read_b64_tr_b16 v[52:53], v129 offset:32768
    s_setprio 0
    buffer_load_dwordx4 v124, s[12:15], s24 offen offset:0  lds
    s_setprio 3
    v_mfma_f32_16x16x32_bf16 v[12:15], v[76:79], v[64:67], v[12:15]
    v_mfma_f32_16x16x32_bf16 v[20:23], v[76:79], v[68:71], v[20:23]
    ds_read_b64_tr_b16 v[54:55], v129 offset:33280
    ds_read_b64_tr_b16 v[56:57], v130 offset:32768
    ds_read_b64_tr_b16 v[58:59], v130 offset:33280
    ds_read_b64_tr_b16 v[60:61], v131 offset:32768
    ds_read_b64_tr_b16 v[62:63], v131 offset:33280
    s_setprio 0
    buffer_load_dwordx4 v125, s[12:15], s24 offen offset:1024  lds
    s_add_u32 s24, s24, s25
    s_mov_b32 m0, s31
    s_add_u32 s71, s71, 4
    buffer_load_dword v137, s[40:43], s71 offen lds
    s_add_u32 m0, s26, 0
    v_mfma_f32_16x16x32_bf16 v[24:27], v[80:83], v[64:67], v[24:27]
    v_mfma_f32_16x16x32_bf16 v[32:35], v[80:83], v[68:71], v[32:35]
    buffer_load_dwordx4 v120, s[8:11], s22 offen offset:0 sc1 lds
    s_setprio 3
    v_mfma_f32_16x16x32_bf16 v[28:31], v[84:87], v[64:67], v[28:31]
    v_mfma_f32_16x16x32_bf16 v[36:39], v[84:87], v[68:71], v[36:39]
    s_setprio 0
    buffer_load_dwordx4 v121, s[8:11], s22 offen offset:1024 sc1 lds
    s_setprio 3
    s_waitcnt lgkmcnt(0)
    v_mfma_f32_16x16x32_bf16 v[8:11], v[48:51], v[40:43], v[8:11]
    v_mfma_f32_16x16x32_bf16 v[16:19], v[48:51], v[44:47], v[16:19]
    ds_read_b128 v[64:67], v127 offset:16384
    ds_read_b128 v[68:71], v127 offset:18432
    ds_read_b64_tr_b16 v[72:73], v128 offset:36864
    ds_read_b64_tr_b16 v[74:75], v128 offset:37376
    ds_read_b64_tr_b16 v[76:77], v129 offset:36864
    ds_read_b64_tr_b16 v[78:79], v129 offset:37376
    s_setprio 0
    buffer_load_dwordx4 v122, s[8:11], s22 offen offset:2048 sc1 lds
    s_setprio 3
    v_mfma_f32_16x16x32_bf16 v[12:15], v[52:55], v[40:43], v[12:15]
    v_mfma_f32_16x16x32_bf16 v[20:23], v[52:55], v[44:47], v[20:23]
    ds_read_b64_tr_b16 v[80:81], v130 offset:36864
    ds_read_b64_tr_b16 v[82:83], v130 offset:37376
    ds_read_b64_tr_b16 v[84:85], v131 offset:36864
    ds_read_b64_tr_b16 v[86:87], v131 offset:37376
    ds_read_b32 v4, v3
    s_setprio 0
    buffer_load_dwordx4 v123, s[8:11], s22 offen offset:3072 sc1 lds
    s_add_u32 s22, s22, 128
    s_nop 0
    v_mfma_f32_16x16x32_bf16 v[24:27], v[56:59], v[40:43], v[24:27]
    v_mfma_f32_16x16x32_bf16 v[32:35], v[56:59], v[44:47], v[32:35]
    s_setprio 3
    v_mfma_f32_16x16x32_bf16 v[28:31], v[60:63], v[40:43], v[28:31]
    v_mfma_f32_16x16x32_bf16 v[36:39], v[60:63], v[44:47], v[36:39]
    s_add_u32 m0, s27, 16384
    s_waitcnt vmcnt(7) lgkmcnt(0)
    v_cmp_gt_u32 vcc, 20, v4
    s_cbranch_vccnz L_parallel_sum__grouped_kv_mqa__mixer_gmlp__prompt_gslow_128
L_parallel_sum__grouped_kv_mqa__mixer_gmlp__prompt_gok_127:
    v_mfma_f32_16x16x32_bf16 v[8:11], v[72:75], v[64:67], v[8:11]
    v_mfma_f32_16x16x32_bf16 v[16:19], v[72:75], v[68:71], v[16:19]
    ds_read_b128 v[40:43], v126 offset:32768
    ds_read_b128 v[44:47], v126 offset:34816
    ds_read_b64_tr_b16 v[48:49], v128 offset:40960
    ds_read_b64_tr_b16 v[50:51], v128 offset:41472
    ds_read_b64_tr_b16 v[52:53], v129 offset:40960
    s_setprio 0
    buffer_load_dwordx4 v124, s[12:15], s24 offen offset:0  lds
    s_setprio 3
    v_mfma_f32_16x16x32_bf16 v[12:15], v[76:79], v[64:67], v[12:15]
    v_mfma_f32_16x16x32_bf16 v[20:23], v[76:79], v[68:71], v[20:23]
    ds_read_b64_tr_b16 v[54:55], v129 offset:41472
    ds_read_b64_tr_b16 v[56:57], v130 offset:40960
    ds_read_b64_tr_b16 v[58:59], v130 offset:41472
    ds_read_b64_tr_b16 v[60:61], v131 offset:40960
    ds_read_b64_tr_b16 v[62:63], v131 offset:41472
    s_setprio 0
    buffer_load_dwordx4 v125, s[12:15], s24 offen offset:1024  lds
    s_add_u32 s24, s24, s25
    s_mov_b32 m0, s31
    s_add_u32 s71, s71, 4
    buffer_load_dword v137, s[40:43], s71 offen lds
    s_add_u32 m0, s26, 16384
    v_mfma_f32_16x16x32_bf16 v[24:27], v[80:83], v[64:67], v[24:27]
    v_mfma_f32_16x16x32_bf16 v[32:35], v[80:83], v[68:71], v[32:35]
    buffer_load_dwordx4 v120, s[8:11], s22 offen offset:0 sc1 lds
    s_setprio 3
    v_mfma_f32_16x16x32_bf16 v[28:31], v[84:87], v[64:67], v[28:31]
    v_mfma_f32_16x16x32_bf16 v[36:39], v[84:87], v[68:71], v[36:39]
    s_setprio 0
    buffer_load_dwordx4 v121, s[8:11], s22 offen offset:1024 sc1 lds
    s_setprio 3
    v_mul_u32_u24 v158, 14336, v135
    v_lshl_add_u32 v158, v134, 4, v158
    s_mul_i32 s34, s6, 28672
    s_lshl_b32 s33, s20, 9
    s_add_u32 s34, s34, s33
    s_add_u32 s35, s34, 0
    buffer_load_dwordx4 v[88:91], v158, s[16:19], s35 offen offset:0 sc1
    buffer_load_dwordx4 v[92:95], v158, s[16:19], s35 offen offset:2048 sc1
    s_add_u32 s35, s34, 4096
    buffer_load_dwordx4 v[96:99], v158, s[16:19], s35 offen offset:0 sc1
    buffer_load_dwordx4 v[100:103], v158, s[16:19], s35 offen offset:2048 sc1
    s_add_u32 s35, s34, 8192
    buffer_load_dwordx4 v[72:75], v158, s[16:19], s35 offen offset:0 sc1
    buffer_load_dwordx4 v[76:79], v158, s[16:19], s35 offen offset:2048 sc1
    s_add_u32 s35, s34, 12288
    buffer_load_dwordx4 v[80:83], v158, s[16:19], s35 offen offset:0 sc1
    v_and_b32 v146, 15, v1
    v_lshrrev_b32 v147, 4, v1
    v_lshlrev_b32 v147, 2, v147
    v_sub_u32 v146, v146, v147
    v_mov_b32 v147, 0x3f80
    v_mov_b32 v148, 0x3f800000
    v_mov_b32 v64, 0
    v_mov_b32 v65, 0
    v_mov_b32 v68, 0
    v_mov_b32 v69, 0
    v_cmp_eq_u32 vcc, 0, v146
    v_cmp_eq_u32 s[32:33], 1, v146
    s_nop 0
    v_cndmask_b32 v66, 0, v147, vcc
    v_cndmask_b32 v66, v66, v148, s[32:33]
    v_cmp_eq_u32_e64 vcc, 2, v146
    v_cmp_eq_u32 s[32:33], 3, v146
    s_nop 0
    v_cndmask_b32 v67, 0, v147, vcc
    v_cndmask_b32 v67, v67, v148, s[32:33]
L_parallel_sum__grouped_kv_mqa__mixer_gmlp__prompt_gl_129:
    s_waitcnt vmcnt(0)
    v_xor_b32 v148, s96, v89
    v_xor_b32 v150, s96, v93
    v_or_b32 v148, v148, v150
    v_xor_b32 v150, s96, v97
    v_or_b32 v148, v148, v150
    v_xor_b32 v150, s96, v101
    v_or_b32 v148, v148, v150
    v_xor_b32 v150, s96, v73
    v_or_b32 v148, v148, v150
    v_xor_b32 v150, s96, v77
    v_or_b32 v148, v148, v150
    v_xor_b32 v150, s96, v81
    v_or_b32 v148, v148, v150
    v_xor_b32 v149, s96, v91
    v_xor_b32 v150, s96, v95
    v_or_b32 v149, v149, v150
    v_xor_b32 v150, s96, v99
    v_or_b32 v149, v149, v150
    v_xor_b32 v150, s96, v103
    v_or_b32 v149, v149, v150
    v_xor_b32 v150, s96, v75
    v_or_b32 v149, v149, v150
    v_xor_b32 v150, s96, v79
    v_or_b32 v149, v149, v150
    v_xor_b32 v150, s96, v83
    v_or_b32 v149, v149, v150
    v_or_b32 v148, v148, v149
    v_cmp_ne_u32 vcc, 0, v148
    s_cbranch_vccz L_parallel_sum__grouped_kv_mqa__mixer_gmlp__prompt_gd_130
    s_sleep 2
    s_add_u32 s35, s34, 0
    buffer_load_dwordx4 v[88:91], v158, s[16:19], s35 offen offset:0 sc1
    buffer_load_dwordx4 v[92:95], v158, s[16:19], s35 offen offset:2048 sc1
    s_add_u32 s35, s34, 4096
    buffer_load_dwordx4 v[96:99], v158, s[16:19], s35 offen offset:0 sc1
    buffer_load_dwordx4 v[100:103], v158, s[16:19], s35 offen offset:2048 sc1
    s_add_u32 s35, s34, 8192
    buffer_load_dwordx4 v[72:75], v158, s[16:19], s35 offen offset:0 sc1
    buffer_load_dwordx4 v[76:79], v158, s[16:19], s35 offen offset:2048 sc1
    s_add_u32 s35, s34, 12288
    buffer_load_dwordx4 v[80:83], v158, s[16:19], s35 offen offset:0 sc1
    s_sub_u32 s70, s70, 1
    s_cbranch_scc0 L_parallel_sum__grouped_kv_mqa__mixer_gmlp__prompt_gl_129
    s_waitcnt vmcnt(0)
L_parallel_sum__grouped_kv_mqa__mixer_gmlp__prompt_gd_130:
    v_add_f32 v88, v88, v92
    v_add_f32 v90, v90, v94
    v_add_f32 v88, v88, v96
    v_add_f32 v90, v90, v98
    v_add_f32 v88, v88, v100
    v_add_f32 v90, v90, v102
    v_add_f32 v88, v88, v72
    v_add_f32 v90, v90, v74
    v_add_f32 v88, v88, v76
    v_add_f32 v90, v90, v78
    v_add_f32 v88, v88, v80
    v_add_f32 v90, v90, v82
    v_mov_b32 v89, v90
    s_add_u32 s16, s68, 0x00970000
    s_addc_u32 s17, s69, 0
    s_mov_b32 s18, 0x00360000
    s_mov_b32 s19, 0x00020000
    v_mov_b32 v90, v88
    v_mov_b32 v91, v89
    v_lshlrev_b32 v146, 4, v1
    s_lshl_b32 s32, s7, 18
    v_permlane32_swap_b32 v88, v90
    v_permlane32_swap_b32 v89, v91
    v_add_f32 v154, v88, v90
    v_add_f32_e64 v155, v89, v91
    v_mul_f32 v154, 0x3a97b426, v154
    v_mul_f32 v155, 0x3a97b426, v155
    v_fma_f32 v155, -v154, v154, v155
    v_max_f32_e64 v155, 0, v155
    v_add_f32 v155, 0x3727c5ac, v155
    v_rsq_f32 v155, v155
    s_lshl_b32 s33, s6, 12
    s_add_u32 s32, s32, s33
    v_mul_f32 v154, v154, v155
    v_mov_b32 v151, v155
    v_mov_b32 v150, v154
    s_lshl_b32 s33, s20, 10
    s_add_u32 s32, s32, s33
    v_permlane16_swap_b32 v155, v151
    v_permlane16_swap_b32 v154, v150
    s_add_u32 s33, s32, 0x10000
    v_lshlrev_b32 v148, 16, v112
    v_and_b32 v149, s28, v112
    v_fma_f32 v148, v148, v155, -v154
    v_fma_f32 v149, v149, v155, -v154
    v_cvt_pk_bf16_f32 v112, v148, v149
    v_lshlrev_b32 v148, 16, v113
    v_and_b32 v149, s28, v113
    v_fma_f32 v148, v148, v155, -v154
    v_fma_f32 v149, v149, v155, -v154
    v_cvt_pk_bf16_f32 v113, v148, v149
    v_lshlrev_b32 v148, 16, v114
    v_and_b32 v149, s28, v114
    v_fma_f32 v148, v148, v155, -v154
    v_fma_f32 v149, v149, v155, -v154
    v_cvt_pk_bf16_f32 v114, v148, v149
    v_lshlrev_b32 v148, 16, v115
    v_and_b32 v149, s28, v115
    v_fma_f32 v148, v148, v155, -v154
    v_fma_f32 v149, v149, v155, -v154
    v_cvt_pk_bf16_f32 v115, v148, v149
    v_lshlrev_b32 v148, 16, v116
    v_and_b32 v149, s28, v116
    v_fma_f32 v148, v148, v151, -v150
    v_fma_f32 v149, v149, v151, -v150
    v_cvt_pk_bf16_f32 v116, v148, v149
    v_lshlrev_b32 v148, 16, v117
    v_and_b32 v149, s28, v117
    v_fma_f32 v148, v148, v151, -v150
    v_fma_f32 v149, v149, v151, -v150
    v_cvt_pk_bf16_f32 v117, v148, v149
    v_lshlrev_b32 v148, 16, v118
    v_and_b32 v149, s28, v118
    v_fma_f32 v148, v148, v151, -v150
    v_fma_f32 v149, v149, v151, -v150
    v_cvt_pk_bf16_f32 v118, v148, v149
    v_lshlrev_b32 v148, 16, v119
    v_and_b32 v149, s28, v119
    v_fma_f32 v148, v148, v151, -v150
    v_fma_f32 v149, v149, v151, -v150
    v_cvt_pk_bf16_f32 v119, v148, v149
    s_nop 1
    v_mfma_f32_16x16x32_bf16 v[72:75], v[112:115], v[66:69], 0
    v_mfma_f32_16x16x32_bf16 v[76:79], v[116:119], v[66:69], 0
    v_mfma_f32_16x16x32_bf16 v[80:83], v[112:115], v[64:67], 0
    v_mfma_f32_16x16x32_bf16 v[84:87], v[116:119], v[64:67], 0
    s_nop 4
    v_cvt_pk_bf16_f32 v112, v72, v73
    v_cvt_pk_bf16_f32 v113, v74, v75
    v_cvt_pk_bf16_f32 v114, v76, v77
    v_cvt_pk_bf16_f32 v115, v78, v79
    v_cvt_pk_bf16_f32 v116, v80, v81
    v_cvt_pk_bf16_f32 v117, v82, v83
    v_cvt_pk_bf16_f32 v118, v84, v85
    v_cvt_pk_bf16_f32 v119, v86, v87
    s_nop 0
    v_permlane32_swap_b32 v112, v114
    v_permlane32_swap_b32 v113, v115
    v_permlane32_swap_b32 v116, v118
    v_permlane32_swap_b32 v117, v119
    v_permlane16_swap_b32 v112, v114
    v_permlane16_swap_b32 v113, v115
    v_permlane16_swap_b32 v116, v118
    v_permlane16_swap_b32 v117, v119
    buffer_store_dwordx4 v[112:115], v146, s[16:19], s32 offen sc1
    buffer_store_dwordx4 v[116:119], v146, s[16:19], s33 offen sc1
    s_cmp_eq_u32 s7, 0
    s_cbranch_scc1 L_parallel_sum__grouped_kv_mqa__mixer_gmlp__prompt_s1_131
    s_sub_u32 s32, s32, 0x20000
    s_add_u32 s33, s32, 0x10000
    v_lshlrev_b32 v148, 16, v104
    v_and_b32_e64 v149, s28, v104
    v_fma_f32 v148, v148, v155, -v154
    v_fma_f32 v149, v149, v155, -v154
    v_cvt_pk_bf16_f32 v104, v148, v149
    v_lshlrev_b32 v148, 16, v105
    v_and_b32 v149, s28, v105
    v_fma_f32 v148, v148, v155, -v154
    v_fma_f32 v149, v149, v155, -v154
    v_cvt_pk_bf16_f32 v105, v148, v149
    v_lshlrev_b32 v148, 16, v106
    v_and_b32 v149, s28, v106
    v_fma_f32 v148, v148, v155, -v154
    v_fma_f32 v149, v149, v155, -v154
    v_cvt_pk_bf16_f32 v106, v148, v149
    v_lshlrev_b32 v148, 16, v107
    v_and_b32 v149, s28, v107
    v_fma_f32 v148, v148, v155, -v154
    v_fma_f32 v149, v149, v155, -v154
    v_cvt_pk_bf16_f32 v107, v148, v149
    v_lshlrev_b32 v148, 16, v108
    v_and_b32 v149, s28, v108
    v_fma_f32 v148, v148, v151, -v150
    v_fma_f32 v149, v149, v151, -v150
    v_cvt_pk_bf16_f32 v108, v148, v149
    v_lshlrev_b32 v148, 16, v109
    v_and_b32 v149, s28, v109
    v_fma_f32 v148, v148, v151, -v150
    v_fma_f32 v149, v149, v151, -v150
    v_cvt_pk_bf16_f32 v109, v148, v149
    v_lshlrev_b32 v148, 16, v110
    v_and_b32 v149, s28, v110
    v_fma_f32 v148, v148, v151, -v150
    v_fma_f32 v149, v149, v151, -v150
    v_cvt_pk_bf16_f32 v110, v148, v149
    v_lshlrev_b32 v148, 16, v111
    v_and_b32 v149, s28, v111
    v_fma_f32 v148, v148, v151, -v150
    v_fma_f32 v149, v149, v151, -v150
    v_cvt_pk_bf16_f32 v111, v148, v149
    s_nop 1
    v_mfma_f32_16x16x32_bf16 v[72:75], v[104:107], v[66:69], 0
    v_mfma_f32_16x16x32_bf16 v[76:79], v[108:111], v[66:69], 0
    v_mfma_f32_16x16x32_bf16 v[80:83], v[104:107], v[64:67], 0
    v_mfma_f32_16x16x32_bf16 v[84:87], v[108:111], v[64:67], 0
    s_nop 4
    v_cvt_pk_bf16_f32 v104, v72, v73
    v_cvt_pk_bf16_f32 v105, v74, v75
    v_cvt_pk_bf16_f32 v106, v76, v77
    v_cvt_pk_bf16_f32 v107, v78, v79
    v_cvt_pk_bf16_f32 v108, v80, v81
    v_cvt_pk_bf16_f32 v109, v82, v83
    v_cvt_pk_bf16_f32 v110, v84, v85
    v_cvt_pk_bf16_f32 v111, v86, v87
    s_nop 0
    v_permlane32_swap_b32 v104, v106
    v_permlane32_swap_b32 v105, v107
    v_permlane32_swap_b32 v108, v110
    v_permlane32_swap_b32 v109, v111
    v_permlane16_swap_b32 v104, v106
    v_permlane16_swap_b32 v105, v107
    v_permlane16_swap_b32 v108, v110
    v_permlane16_swap_b32 v109, v111
    buffer_store_dwordx4 v[104:107], v146, s[16:19], s32 offen sc1
    buffer_store_dwordx4 v[108:111], v146, s[16:19], s33 offen sc1
L_parallel_sum__grouped_kv_mqa__mixer_gmlp__prompt_s1_131:
    s_waitcnt lgkmcnt(0)
    v_mfma_f32_16x16x32_bf16 v[8:11], v[48:51], v[40:43], v[8:11]
    v_mfma_f32_16x16x32_bf16 v[16:19], v[48:51], v[44:47], v[16:19]
    ds_read_b128 v[64:67], v127 offset:32768
    ds_read_b128 v[68:71], v127 offset:34816
    ds_read_b64_tr_b16 v[72:73], v128 offset:45056
    ds_read_b64_tr_b16 v[74:75], v128 offset:45568
    ds_read_b64_tr_b16 v[76:77], v129 offset:45056
    ds_read_b64_tr_b16 v[78:79], v129 offset:45568
    s_setprio 0
    buffer_load_dwordx4 v122, s[8:11], s22 offen offset:2048 sc1 lds
    s_setprio 3
    v_mfma_f32_16x16x32_bf16 v[12:15], v[52:55], v[40:43], v[12:15]
    v_mfma_f32_16x16x32_bf16 v[20:23], v[52:55], v[44:47], v[20:23]
    ds_read_b64_tr_b16 v[80:81], v130 offset:45056
    ds_read_b64_tr_b16 v[82:83], v130 offset:45568
    ds_read_b64_tr_b16 v[84:85], v131 offset:45056
    ds_read_b64_tr_b16 v[86:87], v131 offset:45568
    ds_read_b32 v4, v3
    s_setprio 0
    buffer_load_dwordx4 v123, s[8:11], s22 offen offset:3072 sc1 lds
    s_add_u32 s22, s22, 128
    s_nop 0
    v_mfma_f32_16x16x32_bf16 v[24:27], v[56:59], v[40:43], v[24:27]
    v_mfma_f32_16x16x32_bf16 v[32:35], v[56:59], v[44:47], v[32:35]
    s_setprio 3
    v_mfma_f32_16x16x32_bf16 v[28:31], v[60:63], v[40:43], v[28:31]
    v_mfma_f32_16x16x32_bf16 v[36:39], v[60:63], v[44:47], v[36:39]
    s_add_u32 m0, s27, 24576
    s_waitcnt vmcnt(9) lgkmcnt(0)
    v_cmp_gt_u32 vcc, 21, v4
    s_cbranch_vccnz L_parallel_sum__grouped_kv_mqa__mixer_gmlp__prompt_gslow_133
L_parallel_sum__grouped_kv_mqa__mixer_gmlp__prompt_gok_132:
    v_mfma_f32_16x16x32_bf16 v[8:11], v[72:75], v[64:67], v[8:11]
    v_mfma_f32_16x16x32_bf16 v[16:19], v[72:75], v[68:71], v[16:19]
    ds_read_b128 v[40:43], v126 offset:0
    ds_read_b128 v[44:47], v126 offset:2048
    ds_read_b64_tr_b16 v[48:49], v128 offset:0
    ds_read_b64_tr_b16 v[50:51], v128 offset:512
    ds_read_b64_tr_b16 v[52:53], v129 offset:0
    s_setprio 0
    buffer_load_dwordx4 v124, s[12:15], s24 offen offset:0  lds
    s_setprio 3
    v_mfma_f32_16x16x32_bf16 v[12:15], v[76:79], v[64:67], v[12:15]
    v_mfma_f32_16x16x32_bf16 v[20:23], v[76:79], v[68:71], v[20:23]
    ds_read_b64_tr_b16 v[54:55], v129 offset:512
    ds_read_b64_tr_b16 v[56:57], v130 offset:0
    ds_read_b64_tr_b16 v[58:59], v130 offset:512
    ds_read_b64_tr_b16 v[60:61], v131 offset:0
    ds_read_b64_tr_b16 v[62:63], v131 offset:512
    s_setprio 0
    buffer_load_dwordx4 v125, s[12:15], s24 offen offset:1024  lds
    s_add_u32 s24, s24, s25
    s_mov_b32 m0, s31
    s_add_u32 s71, s71, 4
    buffer_load_dword v137, s[40:43], s71 offen lds
    s_add_u32 m0, s26, 32768
    v_mfma_f32_16x16x32_bf16 v[24:27], v[80:83], v[64:67], v[24:27]
    v_mfma_f32_16x16x32_bf16 v[32:35], v[80:83], v[68:71], v[32:35]
    buffer_load_dwordx4 v120, s[8:11], s22 offen offset:0 sc1 lds
    s_setprio 3
    v_mfma_f32_16x16x32_bf16 v[28:31], v[84:87], v[64:67], v[28:31]
    v_mfma_f32_16x16x32_bf16 v[36:39], v[84:87], v[68:71], v[36:39]
    s_setprio 0
    buffer_load_dwordx4 v121, s[8:11], s22 offen offset:1024 sc1 lds
    s_setprio 3
    s_waitcnt vmcnt(7)
    s_add_u32 s21, s21, 1
    v_mov_b32 v4, s21
    ds_write_b32 v5, v4
L_parallel_sum__grouped_kv_mqa__mixer_gmlp__prompt_gspin_134:
    ds_read_b32 v4, v6
    s_waitcnt lgkmcnt(0)
    v_cmp_gt_u32 vcc, s21, v4
    s_cbranch_vccz L_parallel_sum__grouped_kv_mqa__mixer_gmlp__prompt_gspun_135
    s_sleep 1
    s_sub_u32 s70, s70, 1
    s_cbranch_scc0 L_parallel_sum__grouped_kv_mqa__mixer_gmlp__prompt_gspin_134
L_parallel_sum__grouped_kv_mqa__mixer_gmlp__prompt_gspun_135:
    s_cmp_lg_u32 s20, 0
    s_cbranch_scc1 L_parallel_sum__grouped_kv_mqa__mixer_gmlp__prompt_nf_136
    s_lshl_b32 s32, s6, 11
    s_lshl_b32 s33, s7, 7
    s_add_u32 s32, s32, s33
    s_add_u32 s32, s32, 65536
    v_mov_b32 v146, s96
    v_mov_b32 v147, s97
    v_lshlrev_b32 v144, 3, v1
    s_mov_b64 exec, 0xffff
    buffer_store_dwordx2 v[146:147], v144, s[72:75], s32 offen sc1
    s_mov_b64 exec, -1
L_parallel_sum__grouped_kv_mqa__mixer_gmlp__prompt_nf_136:
    s_waitcnt lgkmcnt(0)
    v_mfma_f32_16x16x32_bf16 v[8:11], v[48:51], v[40:43], v[8:11]
    v_mfma_f32_16x16x32_bf16 v[16:19], v[48:51], v[44:47], v[16:19]
    ds_read_b128 v[64:67], v127 offset:0
    ds_read_b128 v[68:71], v127 offset:2048
    ds_read_b64_tr_b16 v[72:73], v128 offset:4096
    ds_read_b64_tr_b16 v[74:75], v128 offset:4608
    ds_read_b64_tr_b16 v[76:77], v129 offset:4096
    ds_read_b64_tr_b16 v[78:79], v129 offset:4608
    s_setprio 0
    buffer_load_dwordx4 v122, s[8:11], s22 offen offset:2048 sc1 lds
    s_setprio 3
    v_mfma_f32_16x16x32_bf16 v[12:15], v[52:55], v[40:43], v[12:15]
    v_mfma_f32_16x16x32_bf16 v[20:23], v[52:55], v[44:47], v[20:23]
    ds_read_b64_tr_b16 v[80:81], v130 offset:4096
    ds_read_b64_tr_b16 v[82:83], v130 offset:4608
    ds_read_b64_tr_b16 v[84:85], v131 offset:4096
    ds_read_b64_tr_b16 v[86:87], v131 offset:4608
    ds_read_b32 v4, v3
    s_setprio 0
    buffer_load_dwordx4 v123, s[8:11], s22 offen offset:3072 sc1 lds
    s_add_u32 s22, s22, 128
    s_nop 0
    v_mfma_f32_16x16x32_bf16 v[24:27], v[56:59], v[40:43], v[24:27]
    v_mfma_f32_16x16x32_bf16 v[32:35], v[56:59], v[44:47], v[32:35]
    s_setprio 3
    v_mfma_f32_16x16x32_bf16 v[28:31], v[60:63], v[40:43], v[28:31]
    v_mfma_f32_16x16x32_bf16 v[36:39], v[60:63], v[44:47], v[36:39]
    s_add_u32 m0, s27, 32768
    s_waitcnt vmcnt(7) lgkmcnt(0)
    v_cmp_gt_u32 vcc, 22, v4
    s_cbranch_vccnz L_parallel_sum__grouped_kv_mqa__mixer_gmlp__prompt_gslow_138
L_parallel_sum__grouped_kv_mqa__mixer_gmlp__prompt_gok_137:
    v_mfma_f32_16x16x32_bf16 v[8:11], v[72:75], v[64:67], v[8:11]
    v_mfma_f32_16x16x32_bf16 v[16:19], v[72:75], v[68:71], v[16:19]
    ds_read_b128 v[40:43], v126 offset:16384
    ds_read_b128 v[44:47], v126 offset:18432
    ds_read_b64_tr_b16 v[48:49], v128 offset:8192
    ds_read_b64_tr_b16 v[50:51], v128 offset:8704
    ds_read_b64_tr_b16 v[52:53], v129 offset:8192
    s_setprio 0
    buffer_load_dwordx4 v124, s[12:15], s24 offen offset:0  lds
    s_setprio 3
    v_mfma_f32_16x16x32_bf16 v[12:15], v[76:79], v[64:67], v[12:15]
    v_mfma_f32_16x16x32_bf16 v[20:23], v[76:79], v[68:71], v[20:23]
    ds_read_b64_tr_b16 v[54:55], v129 offset:8704
    ds_read_b64_tr_b16 v[56:57], v130 offset:8192
    ds_read_b64_tr_b16 v[58:59], v130 offset:8704
    ds_read_b64_tr_b16 v[60:61], v131 offset:8192
    ds_read_b64_tr_b16 v[62:63], v131 offset:8704
    s_setprio 0
    buffer_load_dwordx4 v125, s[12:15], s24 offen offset:1024  lds
    s_add_u32 s24, s24, s25
    s_mov_b32 m0, s31
    s_add_u32 s71, s71, 4
    buffer_load_dword v137, s[40:43], s71 offen lds
    s_add_u32 m0, s26, 0
    v_mfma_f32_16x16x32_bf16 v[24:27], v[80:83], v[64:67], v[24:27]
    v_mfma_f32_16x16x32_bf16 v[32:35], v[80:83], v[68:71], v[32:35]
    buffer_load_dwordx4 v120, s[8:11], s22 offen offset:0 sc1 lds
    s_setprio 3
    v_mfma_f32_16x16x32_bf16 v[28:31], v[84:87], v[64:67], v[28:31]
    v_mfma_f32_16x16x32_bf16 v[36:39], v[84:87], v[68:71], v[36:39]
    s_setprio 0
    buffer_load_dwordx4 v121, s[8:11], s22 offen offset:1024 sc1 lds
    s_setprio 3
    s_waitcnt lgkmcnt(0)
    v_mfma_f32_16x16x32_bf16 v[8:11], v[48:51], v[40:43], v[8:11]
    v_mfma_f32_16x16x32_bf16 v[16:19], v[48:51], v[44:47], v[16:19]
    ds_read_b128 v[64:67], v127 offset:16384
    ds_read_b128 v[68:71], v127 offset:18432
    ds_read_b64_tr_b16 v[72:73], v128 offset:12288
    ds_read_b64_tr_b16 v[74:75], v128 offset:12800
    ds_read_b64_tr_b16 v[76:77], v129 offset:12288
    ds_read_b64_tr_b16 v[78:79], v129 offset:12800
    s_setprio 0
    buffer_load_dwordx4 v122, s[8:11], s22 offen offset:2048 sc1 lds
    s_setprio 3
    v_mfma_f32_16x16x32_bf16 v[12:15], v[52:55], v[40:43], v[12:15]
    v_mfma_f32_16x16x32_bf16 v[20:23], v[52:55], v[44:47], v[20:23]
    ds_read_b64_tr_b16 v[80:81], v130 offset:12288
    ds_read_b64_tr_b16 v[82:83], v130 offset:12800
    ds_read_b64_tr_b16 v[84:85], v131 offset:12288
    ds_read_b64_tr_b16 v[86:87], v131 offset:12800
    ds_read_b32 v4, v3
    s_setprio 0
    buffer_load_dwordx4 v123, s[8:11], s22 offen offset:3072 sc1 lds
    s_add_u32 s22, s22, 128
    s_nop 0
    v_mfma_f32_16x16x32_bf16 v[24:27], v[56:59], v[40:43], v[24:27]
    v_mfma_f32_16x16x32_bf16 v[32:35], v[56:59], v[44:47], v[32:35]
    s_setprio 3
    v_mfma_f32_16x16x32_bf16 v[28:31], v[60:63], v[40:43], v[28:31]
    v_mfma_f32_16x16x32_bf16 v[36:39], v[60:63], v[44:47], v[36:39]
    s_add_u32 m0, s27, 40960
    s_waitcnt vmcnt(7) lgkmcnt(0)
    v_cmp_gt_u32 vcc, 23, v4
    s_cbranch_vccnz L_parallel_sum__grouped_kv_mqa__mixer_gmlp__prompt_gslow_140
L_parallel_sum__grouped_kv_mqa__mixer_gmlp__prompt_gok_139:
    v_mfma_f32_16x16x32_bf16 v[8:11], v[72:75], v[64:67], v[8:11]
    v_mfma_f32_16x16x32_bf16 v[16:19], v[72:75], v[68:71], v[16:19]
    ds_read_b128 v[40:43], v126 offset:32768
    ds_read_b128 v[44:47], v126 offset:34816
    ds_read_b64_tr_b16 v[48:49], v128 offset:16384
    ds_read_b64_tr_b16 v[50:51], v128 offset:16896
    ds_read_b64_tr_b16 v[52:53], v129 offset:16384
    s_setprio 0
    buffer_load_dwordx4 v124, s[12:15], s24 offen offset:0  lds
    s_setprio 3
    v_mfma_f32_16x16x32_bf16 v[12:15], v[76:79], v[64:67], v[12:15]
    v_mfma_f32_16x16x32_bf16 v[20:23], v[76:79], v[68:71], v[20:23]
    ds_read_b64_tr_b16 v[54:55], v129 offset:16896
    ds_read_b64_tr_b16 v[56:57], v130 offset:16384
    ds_read_b64_tr_b16 v[58:59], v130 offset:16896
    ds_read_b64_tr_b16 v[60:61], v131 offset:16384
    ds_read_b64_tr_b16 v[62:63], v131 offset:16896
    s_setprio 0
    buffer_load_dwordx4 v125, s[12:15], s24 offen offset:1024  lds
    s_add_u32 s24, s24, s25
    s_mov_b32 m0, s31
    s_add_u32 s71, s71, 4
    buffer_load_dword v137, s[40:43], s71 offen lds
    s_add_u32 m0, s26, 16384
    v_mfma_f32_16x16x32_bf16 v[24:27], v[80:83], v[64:67], v[24:27]
    v_mfma_f32_16x16x32_bf16 v[32:35], v[80:83], v[68:71], v[32:35]
    buffer_load_dwordx4 v120, s[8:11], s22 offen offset:0 sc1 lds
    s_setprio 3
    v_mfma_f32_16x16x32_bf16 v[28:31], v[84:87], v[64:67], v[28:31]
    v_mfma_f32_16x16x32_bf16 v[36:39], v[84:87], v[68:71], v[36:39]
    s_setprio 0
    buffer_load_dwordx4 v121, s[8:11], s22 offen offset:1024 sc1 lds
    s_setprio 3
    s_waitcnt lgkmcnt(0)
    v_mfma_f32_16x16x32_bf16 v[8:11], v[48:51], v[40:43], v[8:11]
    v_mfma_f32_16x16x32_bf16 v[16:19], v[48:51], v[44:47], v[16:19]
    ds_read_b128 v[64:67], v127 offset:32768
    ds_read_b128 v[68:71], v127 offset:34816
    ds_read_b64_tr_b16 v[72:73], v128 offset:20480
    ds_read_b64_tr_b16 v[74:75], v128 offset:20992
    ds_read_b64_tr_b16 v[76:77], v129 offset:20480
    ds_read_b64_tr_b16 v[78:79], v129 offset:20992
    s_setprio 0
    buffer_load_dwordx4 v122, s[8:11], s22 offen offset:2048 sc1 lds
    s_setprio 3
    v_mfma_f32_16x16x32_bf16 v[12:15], v[52:55], v[40:43], v[12:15]
    v_mfma_f32_16x16x32_bf16 v[20:23], v[52:55], v[44:47], v[20:23]
    ds_read_b64_tr_b16 v[80:81], v130 offset:20480
    ds_read_b64_tr_b16 v[82:83], v130 offset:20992
    ds_read_b64_tr_b16 v[84:85], v131 offset:20480
    ds_read_b64_tr_b16 v[86:87], v131 offset:20992
    ds_read_b32 v4, v3
    s_setprio 0
    buffer_load_dwordx4 v123, s[8:11], s22 offen offset:3072 sc1 lds
    s_add_u32 s22, s22, 128
    s_nop 0
    v_mfma_f32_16x16x32_bf16 v[24:27], v[56:59], v[40:43], v[24:27]
    v_mfma_f32_16x16x32_bf16 v[32:35], v[56:59], v[44:47], v[32:35]
    s_setprio 3
    v_mfma_f32_16x16x32_bf16 v[28:31], v[60:63], v[40:43], v[28:31]
    v_mfma_f32_16x16x32_bf16 v[36:39], v[60:63], v[44:47], v[36:39]
    s_waitcnt vmcnt(7) lgkmcnt(0)
    v_cmp_gt_u32 vcc, 24, v4
    s_cbranch_vccnz L_parallel_sum__grouped_kv_mqa__mixer_gmlp__prompt_gslow_142
L_parallel_sum__grouped_kv_mqa__mixer_gmlp__prompt_gok_141:
    v_mfma_f32_16x16x32_bf16 v[8:11], v[72:75], v[64:67], v[8:11]
    v_mfma_f32_16x16x32_bf16 v[16:19], v[72:75], v[68:71], v[16:19]
    ds_read_b128 v[40:43], v126 offset:0
    ds_read_b128 v[44:47], v126 offset:2048
    ds_read_b64_tr_b16 v[48:49], v128 offset:24576
    ds_read_b64_tr_b16 v[50:51], v128 offset:25088
    ds_read_b64_tr_b16 v[52:53], v129 offset:24576
    v_mfma_f32_16x16x32_bf16 v[12:15], v[76:79], v[64:67], v[12:15]
    v_mfma_f32_16x16x32_bf16 v[20:23], v[76:79], v[68:71], v[20:23]
    ds_read_b64_tr_b16 v[54:55], v129 offset:25088
    ds_read_b64_tr_b16 v[56:57], v130 offset:24576
    ds_read_b64_tr_b16 v[58:59], v130 offset:25088
    ds_read_b64_tr_b16 v[60:61], v131 offset:24576
    ds_read_b64_tr_b16 v[62:63], v131 offset:25088
    s_setprio 0
    s_mov_b32 m0, s31
    s_add_u32 s71, s71, 4
    buffer_load_dword v137, s[40:43], s71 offen lds
    s_add_u32 m0, s26, 32768
    v_mfma_f32_16x16x32_bf16 v[24:27], v[80:83], v[64:67], v[24:27]
    v_mfma_f32_16x16x32_bf16 v[32:35], v[80:83], v[68:71], v[32:35]
    buffer_load_dwordx4 v120, s[8:11], s22 offen offset:0 sc1 lds
    buffer_load_dwordx4 v121, s[8:11], s22 offen offset:1024 sc1 lds
    s_setprio 3
    v_mfma_f32_16x16x32_bf16 v[28:31], v[84:87], v[64:67], v[28:31]
    v_mfma_f32_16x16x32_bf16 v[36:39], v[84:87], v[68:71], v[36:39]
    s_setprio 0
    buffer_load_dwordx4 v122, s[8:11], s22 offen offset:2048 sc1 lds
    buffer_load_dwordx4 v123, s[8:11], s22 offen offset:3072 sc1 lds
    s_setprio 3
    s_add_u32 s22, s22, 128
    v_lshrrev_b32 v144, 3, v1
    v_and_b32 v145, 7, v1
    v_add_u32 v146, 0, v144
    v_bfe_u32 v147, v146, 1, 3
    v_xor_b32_e64 v147, v147, v145
    v_mul_u32_u24 v146, 4096, v146
    v_lshl_add_u32 v120, v147, 4, v146
    v_add_u32_e64 v146, 8, v144
    v_bfe_u32 v147, v146, 1, 3
    v_xor_b32_e64 v147, v147, v145
    v_mul_u32_u24 v146, 4096, v146
    v_lshl_add_u32 v121, v147, 4, v146
    v_subrev_u32 v121, 1024, v121
    v_add_u32_e64 v146, 16, v144
    v_bfe_u32 v147, v146, 1, 3
    v_xor_b32_e64 v147, v147, v145
    v_mul_u32_u24 v146, 4096, v146
    v_lshl_add_u32 v122, v147, 4, v146
    v_subrev_u32 v122, 2048, v122
    v_add_u32_e64 v146, 24, v144
    v_bfe_u32 v147, v146, 1, 3
    v_xor_b32_e64 v147, v147, v145
    v_mul_u32_u24 v146, 4096, v146
    v_lshl_add_u32 v123, v147, 4, v146
    v_subrev_u32 v123, 3072, v123
    s_mov_b32 s8, s58
    s_mov_b32 s9, s59
    s_mov_b32 s10, 0x00800000
    s_mov_b32 s11, 0x00020000
    s_lshl_b32 s22, s6, 2
    s_add_u32 s22, s22, s20
    s_lshl_b32 s22, s22, 17
    s_mov_b32 s12, s60
    s_mov_b32 s13, s61
    s_mov_b32 s14, 0x00001000
    s_mov_b32 s15, 0x00020000
    v_lshlrev_b32 v146, 1, v136
    v_lshlrev_b32 v124, 4, v1
    v_lshlrev_b32 v125, 4, v1
    buffer_load_ushort v132, v146, s[12:15], 0 offen
    s_lshl_b32 s32, s20, 13
    s_add_u32 s32, s32, 65536
    v_and_b32 v158, 15, v1
    v_min_u32_e64 v158, 13, v158
    v_and_or_b32 v158, v1, 48, v158
    v_lshlrev_b32_e64 v158, 7, v158
    buffer_load_dwordx2 v[152:153], v158, s[72:75], s32 offen sc1
    s_waitcnt lgkmcnt(0)
    v_mfma_f32_16x16x32_bf16 v[8:11], v[48:51], v[40:43], v[8:11]
    v_mfma_f32_16x16x32_bf16 v[16:19], v[48:51], v[44:47], v[16:19]
    ds_read_b128 v[64:67], v127 offset:0
    ds_read_b128 v[68:71], v127 offset:2048
    ds_read_b64_tr_b16 v[72:73], v128 offset:28672
    ds_read_b64_tr_b16 v[74:75], v128 offset:29184
    ds_read_b64_tr_b16 v[76:77], v129 offset:28672
    ds_read_b64_tr_b16 v[78:79], v129 offset:29184
    v_mfma_f32_16x16x32_bf16 v[12:15], v[52:55], v[40:43], v[12:15]
    v_mfma_f32_16x16x32_bf16 v[20:23], v[52:55], v[44:47], v[20:23]
    ds_read_b64_tr_b16 v[80:81], v130 offset:28672
    ds_read_b64_tr_b16 v[82:83], v130 offset:29184
    ds_read_b64_tr_b16 v[84:85], v131 offset:28672
    ds_read_b64_tr_b16 v[86:87], v131 offset:29184
    ds_read_b32 v4, v3
    s_setprio 0
    v_mfma_f32_16x16x32_bf16 v[24:27], v[56:59], v[40:43], v[24:27]
    v_mfma_f32_16x16x32_bf16 v[32:35], v[56:59], v[44:47], v[32:35]
    s_setprio 3
    v_mfma_f32_16x16x32_bf16 v[28:31], v[60:63], v[40:43], v[28:31]
    v_mfma_f32_16x16x32_bf16 v[36:39], v[60:63], v[44:47], v[36:39]
    s_waitcnt vmcnt(7) lgkmcnt(0)
    v_cmp_gt_u32 vcc, 25, v4
    s_cbranch_vccnz L_parallel_sum__grouped_kv_mqa__mixer_gmlp__prompt_gslow_144
L_parallel_sum__grouped_kv_mqa__mixer_gmlp__prompt_gok_143:
    v_mfma_f32_16x16x32_bf16 v[8:11], v[72:75], v[64:67], v[8:11]
    v_mfma_f32_16x16x32_bf16 v[16:19], v[72:75], v[68:71], v[16:19]
    ds_read_b128 v[40:43], v126 offset:16384
    ds_read_b128 v[44:47], v126 offset:18432
    ds_read_b64_tr_b16 v[48:49], v128 offset:32768
    ds_read_b64_tr_b16 v[50:51], v128 offset:33280
    ds_read_b64_tr_b16 v[52:53], v129 offset:32768
    v_mfma_f32_16x16x32_bf16 v[12:15], v[76:79], v[64:67], v[12:15]
    v_mfma_f32_16x16x32_bf16 v[20:23], v[76:79], v[68:71], v[20:23]
    ds_read_b64_tr_b16 v[54:55], v129 offset:33280
    ds_read_b64_tr_b16 v[56:57], v130 offset:32768
    ds_read_b64_tr_b16 v[58:59], v130 offset:33280
    ds_read_b64_tr_b16 v[60:61], v131 offset:32768
    ds_read_b64_tr_b16 v[62:63], v131 offset:33280
    s_setprio 0
    s_add_u32 m0, s26, 0
    v_mfma_f32_16x16x32_bf16 v[24:27], v[80:83], v[64:67], v[24:27]
    v_mfma_f32_16x16x32_bf16 v[32:35], v[80:83], v[68:71], v[32:35]
    buffer_load_dwordx4 v120, s[8:11], s22 offen offset:0  lds
    buffer_load_dwordx4 v121, s[8:11], s22 offen offset:1024  lds
    s_setprio 3
    v_mfma_f32_16x16x32_bf16 v[28:31], v[84:87], v[64:67], v[28:31]
    v_mfma_f32_16x16x32_bf16 v[36:39], v[84:87], v[68:71], v[36:39]
    s_setprio 0
    buffer_load_dwordx4 v122, s[8:11], s22 offen offset:2048  lds
    buffer_load_dwordx4 v123, s[8:11], s22 offen offset:3072  lds
    s_setprio 3
    s_add_u32 s22, s22, 128
    s_waitcnt vmcnt(4)
    v_cmp_ne_u64 vcc, s[96:97], v[152:153]
    s_cbranch_vccz L_parallel_sum__grouped_kv_mqa__mixer_gmlp__prompt_zpd_145
    s_lshl_b32 s32, s20, 13
    s_add_u32 s32, s32, 65536
L_parallel_sum__grouped_kv_mqa__mixer_gmlp__prompt_pl_146:
    buffer_load_dwordx2 v[152:153], v158, s[72:75], s32 offen sc1
    s_waitcnt vmcnt(0)
    v_cmp_ne_u64 vcc, s[96:97], v[152:153]
    s_cbranch_vccz L_parallel_sum__grouped_kv_mqa__mixer_gmlp__prompt_pd_147
    s_sleep 4
    s_sub_u32 s70, s70, 1
    s_cbranch_scc0 L_parallel_sum__grouped_kv_mqa__mixer_gmlp__prompt_pl_146
L_parallel_sum__grouped_kv_mqa__mixer_gmlp__prompt_pd_147:
L_parallel_sum__grouped_kv_mqa__mixer_gmlp__prompt_zpd_145:
    s_add_u32 s21, s21, 1
    v_mov_b32_e64 v4, s21
    ds_write_b32 v5, v4
L_parallel_sum__grouped_kv_mqa__mixer_gmlp__prompt_gspin_148:
    ds_read_b32 v4, v6
    s_waitcnt lgkmcnt(0)
    v_cmp_gt_u32 vcc, s21, v4
    s_cbranch_vccz L_parallel_sum__grouped_kv_mqa__mixer_gmlp__prompt_gspun_149
    s_sleep 1
    s_sub_u32 s70, s70, 1
    s_cbranch_scc0 L_parallel_sum__grouped_kv_mqa__mixer_gmlp__prompt_gspin_148
L_parallel_sum__grouped_kv_mqa__mixer_gmlp__prompt_gspun_149:
    s_add_u32 s12, s68, 0x00970000
    s_addc_u32 s13, s69, 0
    s_mov_b32 s14, 0x00360000
    s_mov_b32 s15, 0x00020000
    s_lshl_b32 s32, s7, 2
    s_add_u32 s32, s32, s20
    s_lshl_b32 s24, s32, 16
    s_mov_b32 s25, 2048
    v_add_u32 v138, 112128, v124
    s_setprio 0
    s_add_u32 m0, s27, 0
    s_nop 0
    buffer_load_dwordx4 v124, s[12:15], s24 offen offset:0 sc1 lds
    buffer_load_dwordx4 v125, s[12:15], s24 offen offset:1024 sc1 lds
    s_add_u32 s24, s24, s25
    s_add_u32 m0, s27, 8192
    s_nop 0
    buffer_load_dwordx4 v124, s[12:15], s24 offen offset:0 sc1 lds
    buffer_load_dwordx4 v125, s[12:15], s24 offen offset:1024 sc1 lds
    s_add_u32 s24, s24, s25
    s_mov_b32 m0, s31
    s_add_u32 s71, s71, 4
    buffer_load_dword v137, s[40:43], s71 offen lds
    s_setprio 3
    s_waitcnt lgkmcnt(0)
    v_mfma_f32_16x16x32_bf16 v[8:11], v[48:51], v[40:43], v[8:11]
    v_mfma_f32_16x16x32_bf16 v[16:19], v[48:51], v[44:47], v[16:19]
    ds_read_b128 v[64:67], v127 offset:16384
    ds_read_b128 v[68:71], v127 offset:18432
    ds_read_b64_tr_b16 v[72:73], v128 offset:36864
    ds_read_b64_tr_b16 v[74:75], v128 offset:37376
    ds_read_b64_tr_b16 v[76:77], v129 offset:36864
    ds_read_b64_tr_b16 v[78:79], v129 offset:37376
    v_mfma_f32_16x16x32_bf16 v[12:15], v[52:55], v[40:43], v[12:15]
    v_mfma_f32_16x16x32_bf16 v[20:23], v[52:55], v[44:47], v[20:23]
    ds_read_b64_tr_b16 v[80:81], v130 offset:36864
    ds_read_b64_tr_b16 v[82:83], v130 offset:37376
    ds_read_b64_tr_b16 v[84:85], v131 offset:36864
    ds_read_b64_tr_b16 v[86:87], v131 offset:37376
    ds_read_b32 v4, v3
    s_setprio 0
    v_mfma_f32_16x16x32_bf16 v[24:27], v[56:59], v[40:43], v[24:27]
    v_mfma_f32_16x16x32_bf16 v[32:35], v[56:59], v[44:47], v[32:35]
    s_setprio 3
    v_mfma_f32_16x16x32_bf16 v[28:31], v[60:63], v[40:43], v[28:31]
    v_mfma_f32_16x16x32_bf16 v[36:39], v[60:63], v[44:47], v[36:39]
    s_add_u32 m0, s27, 16384
    s_waitcnt vmcnt(11) lgkmcnt(0)
    v_cmp_gt_u32 vcc, 26, v4
    s_cbranch_vccnz L_parallel_sum__grouped_kv_mqa__mixer_gmlp__prompt_gslow_151
L_parallel_sum__grouped_kv_mqa__mixer_gmlp__prompt_gok_150:
    v_mfma_f32_16x16x32_bf16 v[8:11], v[72:75], v[64:67], v[8:11]
    v_mfma_f32_16x16x32_bf16 v[16:19], v[72:75], v[68:71], v[16:19]
    ds_read_b128 v[40:43], v126 offset:32768
    ds_read_b128 v[44:47], v126 offset:34816
    ds_read_b64_tr_b16 v[48:49], v128 offset:40960
    ds_read_b64_tr_b16 v[50:51], v128 offset:41472
    ds_read_b64_tr_b16 v[52:53], v129 offset:40960
    s_setprio 0
    buffer_load_dwordx4 v124, s[12:15], s24 offen offset:0 sc1 lds
    s_setprio 3
    v_mfma_f32_16x16x32_bf16 v[12:15], v[76:79], v[64:67], v[12:15]
    v_mfma_f32_16x16x32_bf16 v[20:23], v[76:79], v[68:71], v[20:23]
    ds_read_b64_tr_b16 v[54:55], v129 offset:41472
    ds_read_b64_tr_b16 v[56:57], v130 offset:40960
    ds_read_b64_tr_b16 v[58:59], v130 offset:41472
    ds_read_b64_tr_b16 v[60:61], v131 offset:40960
    ds_read_b64_tr_b16 v[62:63], v131 offset:41472
    s_setprio 0
    buffer_load_dwordx4 v125, s[12:15], s24 offen offset:1024 sc1 lds
    s_add_u32 s24, s24, s25
    s_mov_b32 m0, s31
    s_add_u32 s71, s71, 4
    buffer_load_dword v137, s[40:43], s71 offen lds
    s_add_u32 m0, s26, 16384
    v_mfma_f32_16x16x32_bf16 v[24:27], v[80:83], v[64:67], v[24:27]
    v_mfma_f32_16x16x32_bf16 v[32:35], v[80:83], v[68:71], v[32:35]
    buffer_load_dwordx4 v120, s[8:11], s22 offen offset:0  lds
    s_setprio 3
    v_mfma_f32_16x16x32_bf16 v[28:31], v[84:87], v[64:67], v[28:31]
    v_mfma_f32_16x16x32_bf16 v[36:39], v[84:87], v[68:71], v[36:39]
    s_setprio 0
    buffer_load_dwordx4 v121, s[8:11], s22 offen offset:1024  lds
    s_setprio 3
    s_waitcnt lgkmcnt(0)
    v_mfma_f32_16x16x32_bf16 v[8:11], v[48:51], v[40:43], v[8:11]
    v_mfma_f32_16x16x32_bf16 v[16:19], v[48:51], v[44:47], v[16:19]
    ds_read_b128 v[64:67], v127 offset:32768
    ds_read_b128 v[68:71], v127 offset:34816
    ds_read_b64_tr_b16 v[72:73], v128 offset:45056
    ds_read_b64_tr_b16 v[74:75], v128 offset:45568
    ds_read_b64_tr_b16 v[76:77], v129 offset:45056
    ds_read_b64_tr_b16 v[78:79], v129 offset:45568
    s_setprio 0
    buffer_load_dwordx4 v122, s[8:11], s22 offen offset:2048  lds
    s_setprio 3
    v_mfma_f32_16x16x32_bf16 v[12:15], v[52:55], v[40:43], v[12:15]
    v_mfma_f32_16x16x32_bf16 v[20:23], v[52:55], v[44:47], v[20:23]
    ds_read_b64_tr_b16 v[80:81], v130 offset:45056
    ds_read_b64_tr_b16 v[82:83], v130 offset:45568
    ds_read_b64_tr_b16 v[84:85], v131 offset:45056
    ds_read_b64_tr_b16 v[86:87], v131 offset:45568
    ds_read_b32 v4, v3
    s_setprio 0
    buffer_load_dwordx4 v123, s[8:11], s22 offen offset:3072  lds
    s_add_u32 s22, s22, 128
    s_nop 0
    v_mfma_f32_16x16x32_bf16 v[24:27], v[56:59], v[40:43], v[24:27]
    v_mfma_f32_16x16x32_bf16 v[32:35], v[56:59], v[44:47], v[32:35]
    s_setprio 3
    v_mfma_f32_16x16x32_bf16 v[28:31], v[60:63], v[40:43], v[28:31]
    v_mfma_f32_16x16x32_bf16 v[36:39], v[60:63], v[44:47], v[36:39]
    s_add_u32 m0, s27, 24576
    s_waitcnt vmcnt(12) lgkmcnt(0)
    v_cmp_gt_u32 vcc, 27, v4
    s_cbranch_vccnz L_parallel_sum__grouped_kv_mqa__mixer_gmlp__prompt_gslow_153
L_parallel_sum__grouped_kv_mqa__mixer_gmlp__prompt_gok_152:
    v_mfma_f32_16x16x32_bf16 v[8:11], v[72:75], v[64:67], v[8:11]
    v_mfma_f32_16x16x32_bf16 v[16:19], v[72:75], v[68:71], v[16:19]
    ds_read_b128 v[40:43], v126 offset:0
    ds_read_b128 v[44:47], v126 offset:2048
    ds_read_b128 v[48:51], v138 offset:0
    s_setprio 0
    buffer_load_dwordx4 v124, s[12:15], s24 offen offset:0 sc1 lds
    s_setprio 3
    v_mfma_f32_16x16x32_bf16 v[12:15], v[76:79], v[64:67], v[12:15]
    v_mfma_f32_16x16x32_bf16 v[20:23], v[76:79], v[68:71], v[20:23]
    ds_read_b128 v[52:55], v138 offset:2048
    ds_read_b128 v[56:59], v138 offset:4096
    ds_read_b128 v[60:63], v138 offset:6144
    s_setprio 0
    buffer_load_dwordx4 v125, s[12:15], s24 offen offset:1024 sc1 lds
    s_add_u32 s24, s24, s25
    s_mov_b32 m0, s31
    s_add_u32 s71, s71, 4
    buffer_load_dword v137, s[40:43], s71 offen lds
    s_add_u32 m0, s26, 32768
    v_mfma_f32_16x16x32_bf16 v[24:27], v[80:83], v[64:67], v[24:27]
    v_mfma_f32_16x16x32_bf16 v[32:35], v[80:83], v[68:71], v[32:35]
    buffer_load_dwordx4 v120, s[8:11], s22 offen offset:0  lds
    s_setprio 3
    v_mfma_f32_16x16x32_bf16 v[28:31], v[84:87], v[64:67], v[28:31]
    v_mfma_f32_16x16x32_bf16 v[36:39], v[84:87], v[68:71], v[36:39]
    s_setprio 0
    buffer_load_dwordx4 v121, s[8:11], s22 offen offset:1024  lds
    s_setprio 3
L_parallel_sum__grouped_kv_mqa__mixer_gmlp__prompt_skipG_5:
    s_waitcnt lgkmcnt(0)
    v_mfma_f32_16x16x32_bf16 v[88:91], v[48:51], v[40:43], 0
    v_mfma_f32_16x16x32_bf16 v[96:99], v[48:51], v[44:47], 0
    ds_read_b128 v[64:67], v127 offset:0
    ds_read_b128 v[68:71], v127 offset:2048
    ds_read_b128 v[72:75], v138 offset:1024
    ds_read_b128 v[76:79], v138 offset:3072
    s_setprio 0
    buffer_load_dwordx4 v122, s[8:11], s22 offen offset:2048  lds
    s_setprio 3
    v_mfma_f32_16x16x32_bf16 v[92:95], v[52:55], v[40:43], 0
    v_mfma_f32_16x16x32_bf16 v[100:103], v[52:55], v[44:47], 0
    ds_read_b128 v[80:83], v138 offset:5120
    ds_read_b128 v[84:87], v138 offset:7168
    ds_read_b32 v4, v3
    s_setprio 0
    buffer_load_dwordx4 v123, s[8:11], s22 offen offset:3072  lds
    s_add_u32 s22, s22, 128
    s_nop 0
    s_setprio 3
    v_mfma_f32_16x16x32_bf16 v[104:107], v[56:59], v[40:43], 0
    v_mfma_f32_16x16x32_bf16 v[112:115], v[56:59], v[44:47], 0
    v_mfma_f32_16x16x32_bf16 v[108:111], v[60:63], v[40:43], 0
    v_mfma_f32_16x16x32_bf16 v[116:119], v[60:63], v[44:47], 0
    s_add_u32 m0, s27, 32768
    s_waitcnt vmcnt(7) lgkmcnt(0)
    v_cmp_gt_u32 vcc, 28, v4
    s_cbranch_vccnz L_parallel_sum__grouped_kv_mqa__mixer_gmlp__prompt_gslow_155
L_parallel_sum__grouped_kv_mqa__mixer_gmlp__prompt_gok_154:
    v_mfma_f32_16x16x32_bf16 v[88:91], v[72:75], v[64:67], v[88:91]
    v_mfma_f32_16x16x32_bf16 v[96:99], v[72:75], v[68:71], v[96:99]
    ds_read_b128 v[40:43], v126 offset:16384
    ds_read_b128 v[44:47], v126 offset:18432
    ds_read_b128 v[48:51], v138 offset:8192
    s_setprio 0
    buffer_load_dwordx4 v124, s[12:15], s24 offen offset:0 sc1 lds
    s_setprio 3
    v_mfma_f32_16x16x32_bf16 v[92:95], v[76:79], v[64:67], v[92:95]
    v_mfma_f32_16x16x32_bf16 v[100:103], v[76:79], v[68:71], v[100:103]
    ds_read_b128 v[52:55], v138 offset:10240
    ds_read_b128 v[56:59], v138 offset:12288
    ds_read_b128 v[60:63], v138 offset:14336
    s_setprio 0
    buffer_load_dwordx4 v125, s[12:15], s24 offen offset:1024 sc1 lds
    s_add_u32 s24, s24, s25
    s_mov_b32 m0, s31
    s_add_u32 s71, s71, 4
    buffer_load_dword v137, s[40:43], s71 offen lds
    s_add_u32 m0, s26, 0
    s_setprio 3
    v_mfma_f32_16x16x32_bf16 v[104:107], v[80:83], v[64:67], v[104:107]
    v_mfma_f32_16x16x32_bf16 v[112:115], v[80:83], v[68:71], v[112:115]
    s_setprio 0
    buffer_load_dwordx4 v120, s[8:11], s22 offen offset:0  lds
    s_setprio 3
    v_mfma_f32_16x16x32_bf16 v[108:111], v[84:87], v[64:67], v[108:111]
    v_mfma_f32_16x16x32_bf16 v[116:119], v[84:87], v[68:71], v[116:119]
    s_setprio 0
    buffer_load_dwordx4 v121, s[8:11], s22 offen offset:1024  lds
    s_setprio 3
    s_waitcnt lgkmcnt(0)
    v_mfma_f32_16x16x32_bf16 v[88:91], v[48:51], v[40:43], v[88:91]
    v_mfma_f32_16x16x32_bf16 v[96:99], v[48:51], v[44:47], v[96:99]
    ds_read_b128 v[64:67], v127 offset:16384
    ds_read_b128 v[68:71], v127 offset:18432
    ds_read_b128 v[72:75], v138 offset:9216
    ds_read_b128 v[76:79], v138 offset:11264
    s_setprio 0
    buffer_load_dwordx4 v122, s[8:11], s22 offen offset:2048  lds
    s_setprio 3
    v_mfma_f32_16x16x32_bf16 v[92:95], v[52:55], v[40:43], v[92:95]
    v_mfma_f32_16x16x32_bf16 v[100:103], v[52:55], v[44:47], v[100:103]
    ds_read_b128 v[80:83], v138 offset:13312
    ds_read_b128 v[84:87], v138 offset:15360
    ds_read_b32 v4, v3
    s_setprio 0
    buffer_load_dwordx4 v123, s[8:11], s22 offen offset:3072  lds
    s_add_u32 s22, s22, 128
    s_nop 0
    s_setprio 3
    v_mfma_f32_16x16x32_bf16 v[104:107], v[56:59], v[40:43], v[104:107]
    v_mfma_f32_16x16x32_bf16 v[112:115], v[56:59], v[44:47], v[112:115]
    v_mfma_f32_16x16x32_bf16 v[108:111], v[60:63], v[40:43], v[108:111]
    v_mfma_f32_16x16x32_bf16 v[116:119], v[60:63], v[44:47], v[116:119]
    s_add_u32 m0, s27, 40960
    s_waitcnt vmcnt(7) lgkmcnt(0)
    v_cmp_gt_u32 vcc, 29, v4
    s_cbranch_vccnz L_parallel_sum__grouped_kv_mqa__mixer_gmlp__prompt_gslow_157
L_parallel_sum__grouped_kv_mqa__mixer_gmlp__prompt_gok_156:
    v_mfma_f32_16x16x32_bf16 v[88:91], v[72:75], v[64:67], v[88:91]
    v_mfma_f32_16x16x32_bf16 v[96:99], v[72:75], v[68:71], v[96:99]
    ds_read_b128 v[40:43], v126 offset:32768
    ds_read_b128 v[44:47], v126 offset:34816
    ds_read_b128 v[48:51], v138 offset:16384
    s_setprio 0
    buffer_load_dwordx4 v124, s[12:15], s24 offen offset:0 sc1 lds
    s_setprio 3
    v_mfma_f32_16x16x32_bf16 v[92:95], v[76:79], v[64:67], v[92:95]
    v_mfma_f32_16x16x32_bf16 v[100:103], v[76:79], v[68:71], v[100:103]
    ds_read_b128 v[52:55], v138 offset:18432
    ds_read_b128 v[56:59], v138 offset:20480
    ds_read_b128 v[60:63], v138 offset:22528
    s_setprio 0
    buffer_load_dwordx4 v125, s[12:15], s24 offen offset:1024 sc1 lds
    s_add_u32 s24, s24, s25
    s_mov_b32 m0, s31
    s_add_u32 s71, s71, 4
    buffer_load_dword v137, s[40:43], s71 offen lds
    s_add_u32 m0, s26, 16384
    s_setprio 3
    v_mfma_f32_16x16x32_bf16 v[104:107], v[80:83], v[64:67], v[104:107]
    v_mfma_f32_16x16x32_bf16 v[112:115], v[80:83], v[68:71], v[112:115]
    s_setprio 0
    buffer_load_dwordx4 v120, s[8:11], s22 offen offset:0  lds
    s_setprio 3
    v_mfma_f32_16x16x32_bf16 v[108:111], v[84:87], v[64:67], v[108:111]
    v_mfma_f32_16x16x32_bf16 v[116:119], v[84:87], v[68:71], v[116:119]
    s_setprio 0
    buffer_load_dwordx4 v121, s[8:11], s22 offen offset:1024  lds
    s_setprio 3
    s_mov_b32 s29, 30
    s_mov_b32 s30, 0
    .p2align 3
L_parallel_sum__grouped_kv_mqa__mixer_gmlp__prompt_gloop_158:
    s_waitcnt lgkmcnt(0)
    v_mfma_f32_16x16x32_bf16 v[88:91], v[48:51], v[40:43], v[88:91]
    v_mfma_f32_16x16x32_bf16 v[96:99], v[48:51], v[44:47], v[96:99]
    ds_read_b128 v[64:67], v127 offset:32768
    ds_read_b128 v[68:71], v127 offset:34816
    ds_read_b128 v[72:75], v138 offset:17408
    ds_read_b128 v[76:79], v138 offset:19456
    s_setprio 0
    buffer_load_dwordx4 v122, s[8:11], s22 offen offset:2048  lds
    s_setprio 3
    v_mfma_f32_16x16x32_bf16 v[92:95], v[52:55], v[40:43], v[92:95]
    v_mfma_f32_16x16x32_bf16 v[100:103], v[52:55], v[44:47], v[100:103]
    ds_read_b128 v[80:83], v138 offset:21504
    ds_read_b128 v[84:87], v138 offset:23552
    ds_read_b32 v4, v3
    s_setprio 0
    buffer_load_dwordx4 v123, s[8:11], s22 offen offset:3072  lds
    s_add_u32 s22, s22, 128
    s_nop 0
    s_setprio 3
    v_mfma_f32_16x16x32_bf16 v[104:107], v[56:59], v[40:43], v[104:107]
    v_mfma_f32_16x16x32_bf16 v[112:115], v[56:59], v[44:47], v[112:115]
    v_mfma_f32_16x16x32_bf16 v[108:111], v[60:63], v[40:43], v[108:111]
    v_mfma_f32_16x16x32_bf16 v[116:119], v[60:63], v[44:47], v[116:119]
    s_add_u32 m0, s27, 0
    s_waitcnt vmcnt(7) lgkmcnt(0)
    v_cmp_gt_u32 vcc, s29, v4
    s_cbranch_vccnz L_parallel_sum__grouped_kv_mqa__mixer_gmlp__prompt_gslow_160
L_parallel_sum__grouped_kv_mqa__mixer_gmlp__prompt_gok_159:
    v_mfma_f32_16x16x32_bf16 v[88:91], v[72:75], v[64:67], v[88:91]
    v_mfma_f32_16x16x32_bf16 v[96:99], v[72:75], v[68:71], v[96:99]
    ds_read_b128 v[40:43], v126 offset:0
    ds_read_b128 v[44:47], v126 offset:2048
    ds_read_b128 v[48:51], v138 offset:24576
    s_setprio 0
    buffer_load_dwordx4 v124, s[12:15], s24 offen offset:0 sc1 lds
    s_setprio 3
    v_mfma_f32_16x16x32_bf16 v[92:95], v[76:79], v[64:67], v[92:95]
    v_mfma_f32_16x16x32_bf16 v[100:103], v[76:79], v[68:71], v[100:103]
    ds_read_b128 v[52:55], v138 offset:26624
    ds_read_b128 v[56:59], v138 offset:28672
    ds_read_b128 v[60:63], v138 offset:30720
    s_setprio 0
    buffer_load_dwordx4 v125, s[12:15], s24 offen offset:1024 sc1 lds
    s_add_u32 s24, s24, s25
    s_mov_b32 m0, s31
    s_add_u32 s71, s71, 4
    buffer_load_dword v137, s[40:43], s71 offen lds
    s_add_u32 m0, s26, 32768
    s_setprio 3
    v_mfma_f32_16x16x32_bf16 v[104:107], v[80:83], v[64:67], v[104:107]
    v_mfma_f32_16x16x32_bf16 v[112:115], v[80:83], v[68:71], v[112:115]
    s_setprio 0
    buffer_load_dwordx4 v120, s[8:11], s22 offen offset:0  lds
    s_setprio 3
    v_mfma_f32_16x16x32_bf16 v[108:111], v[84:87], v[64:67], v[108:111]
    v_mfma_f32_16x16x32_bf16 v[116:119], v[84:87], v[68:71], v[116:119]
    s_setprio 0
    buffer_load_dwordx4 v121, s[8:11], s22 offen offset:1024  lds
    s_setprio 3
    s_add_u32 s29, s29, 1
    s_waitcnt lgkmcnt(0)
    v_mfma_f32_16x16x32_bf16 v[88:91], v[48:51], v[40:43], v[88:91]
    v_mfma_f32_16x16x32_bf16 v[96:99], v[48:51], v[44:47], v[96:99]
    ds_read_b128 v[64:67], v127 offset:0
    ds_read_b128 v[68:71], v127 offset:2048
    ds_read_b128 v[72:75], v138 offset:25600
    ds_read_b128 v[76:79], v138 offset:27648
    s_setprio 0
    buffer_load_dwordx4 v122, s[8:11], s22 offen offset:2048  lds
    s_setprio 3
    v_mfma_f32_16x16x32_bf16 v[92:95], v[52:55], v[40:43], v[92:95]
    v_mfma_f32_16x16x32_bf16 v[100:103], v[52:55], v[44:47], v[100:103]
    ds_read_b128 v[80:83], v138 offset:29696
    ds_read_b128 v[84:87], v138 offset:31744
    ds_read_b32 v4, v3
    s_setprio 0
    buffer_load_dwordx4 v123, s[8:11], s22 offen offset:3072  lds
    s_add_u32 s22, s22, 128
    s_nop 0
    s_setprio 3
    v_mfma_f32_16x16x32_bf16 v[104:107], v[56:59], v[40:43], v[104:107]
    v_mfma_f32_16x16x32_bf16 v[112:115], v[56:59], v[44:47], v[112:115]
    v_mfma_f32_16x16x32_bf16 v[108:111], v[60:63], v[40:43], v[108:111]
    v_mfma_f32_16x16x32_bf16 v[116:119], v[60:63], v[44:47], v[116:119]
    s_add_u32 m0, s27, 8192
    s_waitcnt vmcnt(7) lgkmcnt(0)
    v_cmp_gt_u32 vcc, s29, v4
    s_cbranch_vccnz L_parallel_sum__grouped_kv_mqa__mixer_gmlp__prompt_gslow_162
L_parallel_sum__grouped_kv_mqa__mixer_gmlp__prompt_gok_161:
    v_mfma_f32_16x16x32_bf16 v[88:91], v[72:75], v[64:67], v[88:91]
    v_mfma_f32_16x16x32_bf16 v[96:99], v[72:75], v[68:71], v[96:99]
    ds_read_b128 v[40:43], v126 offset:16384
    ds_read_b128 v[44:47], v126 offset:18432
    ds_read_b128 v[48:51], v138 offset:32768
    s_setprio 0
    buffer_load_dwordx4 v124, s[12:15], s24 offen offset:0 sc1 lds
    s_setprio 3
    v_mfma_f32_16x16x32_bf16 v[92:95], v[76:79], v[64:67], v[92:95]
    v_mfma_f32_16x16x32_bf16 v[100:103], v[76:79], v[68:71], v[100:103]
    ds_read_b128 v[52:55], v138 offset:34816
    ds_read_b128 v[56:59], v138 offset:36864
    ds_read_b128 v[60:63], v138 offset:38912
    s_setprio 0
    buffer_load_dwordx4 v125, s[12:15], s24 offen offset:1024 sc1 lds
    s_add_u32 s24, s24, s25
    s_mov_b32 m0, s31
    s_add_u32 s71, s71, 4
    buffer_load_dword v137, s[40:43], s71 offen lds
    s_add_u32 m0, s26, 0
    s_setprio 3
    v_mfma_f32_16x16x32_bf16 v[104:107], v[80:83], v[64:67], v[104:107]
    v_mfma_f32_16x16x32_bf16 v[112:115], v[80:83], v[68:71], v[112:115]
    s_setprio 0
    buffer_load_dwordx4 v120, s[8:11], s22 offen offset:0  lds
    s_setprio 3
    v_mfma_f32_16x16x32_bf16 v[108:111], v[84:87], v[64:67], v[108:111]
    v_mfma_f32_16x16x32_bf16 v[116:119], v[84:87], v[68:71], v[116:119]
    s_setprio 0
    buffer_load_dwordx4 v121, s[8:11], s22 offen offset:1024  lds
    s_setprio 3
    s_add_u32 s29, s29, 1
    s_waitcnt lgkmcnt(0)
    v_mfma_f32_16x16x32_bf16 v[88:91], v[48:51], v[40:43], v[88:91]
    v_mfma_f32_16x16x32_bf16 v[96:99], v[48:51], v[44:47], v[96:99]
    ds_read_b128 v[64:67], v127 offset:16384
    ds_read_b128 v[68:71], v127 offset:18432
    ds_read_b128 v[72:75], v138 offset:33792
    ds_read_b128 v[76:79], v138 offset:35840
    s_setprio 0
    buffer_load_dwordx4 v122, s[8:11], s22 offen offset:2048  lds
    s_setprio 3
    v_mfma_f32_16x16x32_bf16 v[92:95], v[52:55], v[40:43], v[92:95]
    v_mfma_f32_16x16x32_bf16 v[100:103], v[52:55], v[44:47], v[100:103]
    ds_read_b128 v[80:83], v138 offset:37888
    ds_read_b128 v[84:87], v138 offset:39936
    ds_read_b32 v4, v3
    s_setprio 0
    buffer_load_dwordx4 v123, s[8:11], s22 offen offset:3072  lds
    s_add_u32 s22, s22, 128
    s_nop 0
    s_setprio 3
    v_mfma_f32_16x16x32_bf16 v[104:107], v[56:59], v[40:43], v[104:107]
    v_mfma_f32_16x16x32_bf16 v[112:115], v[56:59], v[44:47], v[112:115]
    v_mfma_f32_16x16x32_bf16 v[108:111], v[60:63], v[40:43], v[108:111]
    v_mfma_f32_16x16x32_bf16 v[116:119], v[60:63], v[44:47], v[116:119]
    s_add_u32 m0, s27, 16384
    s_waitcnt vmcnt(7) lgkmcnt(0)
    v_cmp_gt_u32 vcc, s29, v4
    s_cbranch_vccnz L_parallel_sum__grouped_kv_mqa__mixer_gmlp__prompt_gslow_164
L_parallel_sum__grouped_kv_mqa__mixer_gmlp__prompt_gok_163:
    v_mfma_f32_16x16x32_bf16 v[88:91], v[72:75], v[64:67], v[88:91]
    v_mfma_f32_16x16x32_bf16 v[96:99], v[72:75], v[68:71], v[96:99]
    ds_read_b128 v[40:43], v126 offset:32768
    ds_read_b128 v[44:47], v126 offset:34816
    ds_read_b128 v[48:51], v138 offset:40960
    s_setprio 0
    buffer_load_dwordx4 v124, s[12:15], s24 offen offset:0 sc1 lds
    s_setprio 3
    v_mfma_f32_16x16x32_bf16 v[92:95], v[76:79], v[64:67], v[92:95]
    v_mfma_f32_16x16x32_bf16 v[100:103], v[76:79], v[68:71], v[100:103]
    ds_read_b128 v[52:55], v138 offset:43008
    ds_read_b128 v[56:59], v138 offset:45056
    ds_read_b128 v[60:63], v138 offset:47104
    s_setprio 0
    buffer_load_dwordx4 v125, s[12:15], s24 offen offset:1024 sc1 lds
    s_add_u32 s24, s24, s25
    s_mov_b32 m0, s31
    s_add_u32 s71, s71, 4
    buffer_load_dword v137, s[40:43], s71 offen lds
    s_add_u32 m0, s26, 16384
    s_setprio 3
    v_mfma_f32_16x16x32_bf16 v[104:107], v[80:83], v[64:67], v[104:107]
    v_mfma_f32_16x16x32_bf16 v[112:115], v[80:83], v[68:71], v[112:115]
    s_setprio 0
    buffer_load_dwordx4 v120, s[8:11], s22 offen offset:0  lds
    s_setprio 3
    v_mfma_f32_16x16x32_bf16 v[108:111], v[84:87], v[64:67], v[108:111]
    v_mfma_f32_16x16x32_bf16 v[116:119], v[84:87], v[68:71], v[116:119]
    s_setprio 0
    buffer_load_dwordx4 v121, s[8:11], s22 offen offset:1024  lds
    s_setprio 3
    s_add_u32 s29, s29, 1
    s_waitcnt lgkmcnt(0)
    v_mfma_f32_16x16x32_bf16 v[88:91], v[48:51], v[40:43], v[88:91]
    v_mfma_f32_16x16x32_bf16 v[96:99], v[48:51], v[44:47], v[96:99]
    ds_read_b128 v[64:67], v127 offset:32768
    ds_read_b128 v[68:71], v127 offset:34816
    ds_read_b128 v[72:75], v138 offset:41984
    ds_read_b128 v[76:79], v138 offset:44032
    s_setprio 0
    buffer_load_dwordx4 v122, s[8:11], s22 offen offset:2048  lds
    s_setprio 3
    v_mfma_f32_16x16x32_bf16 v[92:95], v[52:55], v[40:43], v[92:95]
    v_mfma_f32_16x16x32_bf16 v[100:103], v[52:55], v[44:47], v[100:103]
    ds_read_b128 v[80:83], v138 offset:46080
    ds_read_b128 v[84:87], v138 offset:48128
    ds_read_b32 v4, v3
    s_setprio 0
    buffer_load_dwordx4 v123, s[8:11], s22 offen offset:3072  lds
    s_add_u32 s22, s22, 128
    s_nop 0
    s_setprio 3
    v_mfma_f32_16x16x32_bf16 v[104:107], v[56:59], v[40:43], v[104:107]
    v_mfma_f32_16x16x32_bf16 v[112:115], v[56:59], v[44:47], v[112:115]
    v_mfma_f32_16x16x32_bf16 v[108:111], v[60:63], v[40:43], v[108:111]
    v_mfma_f32_16x16x32_bf16 v[116:119], v[60:63], v[44:47], v[116:119]
    s_add_u32 m0, s27, 24576
    s_waitcnt vmcnt(7) lgkmcnt(0)
    v_cmp_gt_u32 vcc, s29, v4
    s_cbranch_vccnz L_parallel_sum__grouped_kv_mqa__mixer_gmlp__prompt_gslow_166
L_parallel_sum__grouped_kv_mqa__mixer_gmlp__prompt_gok_165:
    v_mfma_f32_16x16x32_bf16 v[88:91], v[72:75], v[64:67], v[88:91]
    v_mfma_f32_16x16x32_bf16 v[96:99], v[72:75], v[68:71], v[96:99]
    ds_read_b128 v[40:43], v126 offset:0
    ds_read_b128 v[44:47], v126 offset:2048
    ds_read_b128 v[48:51], v138 offset:0
    s_setprio 0
    buffer_load_dwordx4 v124, s[12:15], s24 offen offset:0 sc1 lds
    s_setprio 3
    v_mfma_f32_16x16x32_bf16 v[92:95], v[76:79], v[64:67], v[92:95]
    v_mfma_f32_16x16x32_bf16 v[100:103], v[76:79], v[68:71], v[100:103]
    ds_read_b128 v[52:55], v138 offset:2048
    ds_read_b128 v[56:59], v138 offset:4096
    ds_read_b128 v[60:63], v138 offset:6144
    s_setprio 0
    buffer_load_dwordx4 v125, s[12:15], s24 offen offset:1024 sc1 lds
    s_add_u32 s24, s24, s25
    s_mov_b32 m0, s31
    s_add_u32 s71, s71, 4
    buffer_load_dword v137, s[40:43], s71 offen lds
    s_add_u32 m0, s26, 32768
    s_setprio 3
    v_mfma_f32_16x16x32_bf16 v[104:107], v[80:83], v[64:67], v[104:107]
    v_mfma_f32_16x16x32_bf16 v[112:115], v[80:83], v[68:71], v[112:115]
    s_setprio 0
    buffer_load_dwordx4 v120, s[8:11], s22 offen offset:0  lds
    s_setprio 3
    v_mfma_f32_16x16x32_bf16 v[108:111], v[84:87], v[64:67], v[108:111]
    v_mfma_f32_16x16x32_bf16 v[116:119], v[84:87], v[68:71], v[116:119]
    s_setprio 0
    buffer_load_dwordx4 v121, s[8:11], s22 offen offset:1024  lds
    s_setprio 3
    s_add_u32 s29, s29, 1
    s_waitcnt lgkmcnt(0)
    v_mfma_f32_16x16x32_bf16 v[88:91], v[48:51], v[40:43], v[88:91]
    v_mfma_f32_16x16x32_bf16 v[96:99], v[48:51], v[44:47], v[96:99]
    ds_read_b128 v[64:67], v127 offset:0
    ds_read_b128 v[68:71], v127 offset:2048
    ds_read_b128 v[72:75], v138 offset:1024
    ds_read_b128 v[76:79], v138 offset:3072
    s_setprio 0
    buffer_load_dwordx4 v122, s[8:11], s22 offen offset:2048  lds
    s_setprio 3
    v_mfma_f32_16x16x32_bf16 v[92:95], v[52:55], v[40:43], v[92:95]
    v_mfma_f32_16x16x32_bf16 v[100:103], v[52:55], v[44:47], v[100:103]
    ds_read_b128 v[80:83], v138 offset:5120
    ds_read_b128 v[84:87], v138 offset:7168
    ds_read_b32 v4, v3
    s_setprio 0
    buffer_load_dwordx4 v123, s[8:11], s22 offen offset:3072  lds
    s_add_u32 s22, s22, 128
    s_nop 0
    s_setprio 3
    v_mfma_f32_16x16x32_bf16 v[104:107], v[56:59], v[40:43], v[104:107]
    v_mfma_f32_16x16x32_bf16 v[112:115], v[56:59], v[44:47], v[112:115]
    v_mfma_f32_16x16x32_bf16 v[108:111], v[60:63], v[40:43], v[108:111]
    v_mfma_f32_16x16x32_bf16 v[116:119], v[60:63], v[44:47], v[116:119]
    s_add_u32 m0, s27, 32768
    s_waitcnt vmcnt(7) lgkmcnt(0)
    v_cmp_gt_u32 vcc, s29, v4
    s_cbranch_vccnz L_parallel_sum__grouped_kv_mqa__mixer_gmlp__prompt_gslow_168
L_parallel_sum__grouped_kv_mqa__mixer_gmlp__prompt_gok_167:
    v_mfma_f32_16x16x32_bf16 v[88:91], v[72:75], v[64:67], v[88:91]
    v_mfma_f32_16x16x32_bf16 v[96:99], v[72:75], v[68:71], v[96:99]
    ds_read_b128 v[40:43], v126 offset:16384
    ds_read_b128 v[44:47], v126 offset:18432
    ds_read_b128 v[48:51], v138 offset:8192
    s_setprio 0
    buffer_load_dwordx4 v124, s[12:15], s24 offen offset:0 sc1 lds
    s_setprio 3
    v_mfma_f32_16x16x32_bf16 v[92:95], v[76:79], v[64:67], v[92:95]
    v_mfma_f32_16x16x32_bf16 v[100:103], v[76:79], v[68:71], v[100:103]
    ds_read_b128 v[52:55], v138 offset:10240
    ds_read_b128 v[56:59], v138 offset:12288
    ds_read_b128 v[60:63], v138 offset:14336
    s_setprio 0
    buffer_load_dwordx4 v125, s[12:15], s24 offen offset:1024 sc1 lds
    s_add_u32 s24, s24, s25
    s_mov_b32 m0, s31
    s_add_u32 s71, s71, 4
    buffer_load_dword v137, s[40:43], s71 offen lds
    s_add_u32 m0, s26, 0
    s_setprio 3
    v_mfma_f32_16x16x32_bf16 v[104:107], v[80:83], v[64:67], v[104:107]
    v_mfma_f32_16x16x32_bf16 v[112:115], v[80:83], v[68:71], v[112:115]
    s_setprio 0
    buffer_load_dwordx4 v120, s[8:11], s22 offen offset:0  lds
    s_setprio 3
    v_mfma_f32_16x16x32_bf16 v[108:111], v[84:87], v[64:67], v[108:111]
    v_mfma_f32_16x16x32_bf16 v[116:119], v[84:87], v[68:71], v[116:119]
    s_setprio 0
    buffer_load_dwordx4 v121, s[8:11], s22 offen offset:1024  lds
    s_setprio 3
    s_add_u32 s29, s29, 1
    s_waitcnt lgkmcnt(0)
    v_mfma_f32_16x16x32_bf16 v[88:91], v[48:51], v[40:43], v[88:91]
    v_mfma_f32_16x16x32_bf16 v[96:99], v[48:51], v[44:47], v[96:99]
    ds_read_b128 v[64:67], v127 offset:16384
    ds_read_b128 v[68:71], v127 offset:18432
    ds_read_b128 v[72:75], v138 offset:9216
    ds_read_b128 v[76:79], v138 offset:11264
    s_setprio 0
    buffer_load_dwordx4 v122, s[8:11], s22 offen offset:2048  lds
    s_setprio 3
    v_mfma_f32_16x16x32_bf16 v[92:95], v[52:55], v[40:43], v[92:95]
    v_mfma_f32_16x16x32_bf16 v[100:103], v[52:55], v[44:47], v[100:103]
    ds_read_b128 v[80:83], v138 offset:13312
    ds_read_b128 v[84:87], v138 offset:15360
    ds_read_b32 v4, v3
    s_setprio 0
    buffer_load_dwordx4 v123, s[8:11], s22 offen offset:3072  lds
    s_add_u32 s22, s22, 128
    s_nop 0
    s_setprio 3
    v_mfma_f32_16x16x32_bf16 v[104:107], v[56:59], v[40:43], v[104:107]
    v_mfma_f32_16x16x32_bf16 v[112:115], v[56:59], v[44:47], v[112:115]
    v_mfma_f32_16x16x32_bf16 v[108:111], v[60:63], v[40:43], v[108:111]
    v_mfma_f32_16x16x32_bf16 v[116:119], v[60:63], v[44:47], v[116:119]
    s_add_u32 m0, s27, 40960
    s_waitcnt vmcnt(7) lgkmcnt(0)
    v_cmp_gt_u32 vcc, s29, v4
    s_cbranch_vccnz L_parallel_sum__grouped_kv_mqa__mixer_gmlp__prompt_gslow_170
L_parallel_sum__grouped_kv_mqa__mixer_gmlp__prompt_gok_169:
    v_mfma_f32_16x16x32_bf16 v[88:91], v[72:75], v[64:67], v[88:91]
    v_mfma_f32_16x16x32_bf16 v[96:99], v[72:75], v[68:71], v[96:99]
    ds_read_b128 v[40:43], v126 offset:32768
    ds_read_b128 v[44:47], v126 offset:34816
    ds_read_b128 v[48:51], v138 offset:16384
    s_setprio 0
    buffer_load_dwordx4 v124, s[12:15], s24 offen offset:0 sc1 lds
    s_setprio 3
    v_mfma_f32_16x16x32_bf16 v[92:95], v[76:79], v[64:67], v[92:95]
    v_mfma_f32_16x16x32_bf16 v[100:103], v[76:79], v[68:71], v[100:103]
    ds_read_b128 v[52:55], v138 offset:18432
    ds_read_b128 v[56:59], v138 offset:20480
    ds_read_b128 v[60:63], v138 offset:22528
    s_setprio 0
    buffer_load_dwordx4 v125, s[12:15], s24 offen offset:1024 sc1 lds
    s_add_u32 s24, s24, s25
    s_mov_b32 m0, s31
    s_add_u32 s71, s71, 4
    buffer_load_dword v137, s[40:43], s71 offen lds
    s_add_u32 m0, s26, 16384
    s_setprio 3
    v_mfma_f32_16x16x32_bf16 v[104:107], v[80:83], v[64:67], v[104:107]
    v_mfma_f32_16x16x32_bf16 v[112:115], v[80:83], v[68:71], v[112:115]
    s_setprio 0
    buffer_load_dwordx4 v120, s[8:11], s22 offen offset:0  lds
    s_setprio 3
    v_mfma_f32_16x16x32_bf16 v[108:111], v[84:87], v[64:67], v[108:111]
    v_mfma_f32_16x16x32_bf16 v[116:119], v[84:87], v[68:71], v[116:119]
    s_setprio 0
    buffer_load_dwordx4 v121, s[8:11], s22 offen offset:1024  lds
    s_setprio 3
    s_add_u32 s29, s29, 1
    s_add_u32 s30, s30, 1
    s_cmp_lt_u32 s30, 3
    s_cbranch_scc1 L_parallel_sum__grouped_kv_mqa__mixer_gmlp__prompt_gloop_158
    s_waitcnt lgkmcnt(0)
    v_mfma_f32_16x16x32_bf16 v[88:91], v[48:51], v[40:43], v[88:91]
    v_mfma_f32_16x16x32_bf16 v[96:99], v[48:51], v[44:47], v[96:99]
    ds_read_b128 v[64:67], v127 offset:32768
    ds_read_b128 v[68:71], v127 offset:34816
    ds_read_b128 v[72:75], v138 offset:17408
    ds_read_b128 v[76:79], v138 offset:19456
    v_mul_f32 v144, v8, v8
    v_mul_f32_e64 v145, v9, v9
    v_mul_f32 v146, v10, v10
    s_setprio 0
    buffer_load_dwordx4 v122, s[8:11], s22 offen offset:2048  lds
    s_setprio 3
    v_mfma_f32_16x16x32_bf16 v[92:95], v[52:55], v[40:43], v[92:95]
    v_mfma_f32_16x16x32_bf16 v[100:103], v[52:55], v[44:47], v[100:103]
    ds_read_b128 v[80:83], v138 offset:21504
    ds_read_b128 v[84:87], v138 offset:23552
    ds_read_b32 v4, v3
    v_mul_f32 v147, v11, v11
    v_fmaak_f32 v144, v156, v144, 0xc0135761
    v_fmaak_f32 v145, v156, v145, 0xc0135761
    v_fmaak_f32 v146, v156, v146, 0xc0135761
    s_setprio 0
    buffer_load_dwordx4 v123, s[8:11], s22 offen offset:3072  lds
    s_add_u32 s22, s22, 128
    s_nop 0
    s_setprio 3
    v_mfma_f32_16x16x32_bf16 v[104:107], v[56:59], v[40:43], v[104:107]
    v_mfma_f32_16x16x32_bf16 v[112:115], v[56:59], v[44:47], v[112:115]
    v_fmaak_f32 v147, v156, v147, 0xc0135761
    v_mul_f32 v144, v144, v8
    v_mul_f32_e64 v145, v145, v9
    v_mfma_f32_16x16x32_bf16 v[108:111], v[60:63], v[40:43], v[108:111]
    v_mfma_f32_16x16x32_bf16 v[116:119], v[60:63], v[44:47], v[116:119]
    v_mul_f32 v146, v146, v10
    v_mul_f32 v147, v147, v11
    v_exp_f32 v144, v144
    v_exp_f32 v145, v145
    s_add_u32 m0, s27, 0
    s_waitcnt vmcnt(7) lgkmcnt(0)
    v_cmp_gt_u32 vcc, s29, v4
    s_cbranch_vccnz L_parallel_sum__grouped_kv_mqa__mixer_gmlp__prompt_gslow_172
L_parallel_sum__grouped_kv_mqa__mixer_gmlp__prompt_gok_171:
    v_mfma_f32_16x16x32_bf16 v[88:91], v[72:75], v[64:67], v[88:91]
    v_mfma_f32_16x16x32_bf16 v[96:99], v[72:75], v[68:71], v[96:99]
    ds_read_b128 v[40:43], v126 offset:0
    ds_read_b128 v[44:47], v126 offset:2048
    ds_read_b128 v[48:51], v138 offset:24576
    v_exp_f32 v146, v146
    v_exp_f32 v147, v147
    v_add_f32 v144, 1.0, v144
    s_setprio 0
    buffer_load_dwordx4 v124, s[12:15], s24 offen offset:0 sc1 lds
    s_setprio 3
    v_mfma_f32_16x16x32_bf16 v[92:95], v[76:79], v[64:67], v[92:95]
    v_mfma_f32_16x16x32_bf16 v[100:103], v[76:79], v[68:71], v[100:103]
    ds_read_b128 v[52:55], v138 offset:26624
    ds_read_b128 v[56:59], v138 offset:28672
    ds_read_b128 v[60:63], v138 offset:30720
    v_add_f32 v145, 1.0, v145
    v_add_f32 v146, 1.0, v146
    v_add_f32 v147, 1.0, v147
    v_rcp_f32 v144, v144
    s_setprio 0
    buffer_load_dwordx4 v125, s[12:15], s24 offen offset:1024 sc1 lds
    s_add_u32 s24, s24, s25
    s_mov_b32 m0, s31
    s_add_u32 s71, s71, 4
    buffer_load_dword v137, s[40:43], s71 offen lds
    s_add_u32 m0, s26, 32768
    s_setprio 3
    v_mfma_f32_16x16x32_bf16 v[104:107], v[80:83], v[64:67], v[104:107]
    v_mfma_f32_16x16x32_bf16 v[112:115], v[80:83], v[68:71], v[112:115]
    v_rcp_f32 v145, v145
    v_rcp_f32 v146, v146
    v_rcp_f32 v147, v147
    s_setprio 0
    buffer_load_dwordx4 v120, s[8:11], s22 offen offset:0  lds
    s_setprio 3
    v_mfma_f32_16x16x32_bf16 v[108:111], v[84:87], v[64:67], v[108:111]
    v_mfma_f32_16x16x32_bf16 v[116:119], v[84:87], v[68:71], v[116:119]
    v_mul_f32 v8, v144, v8
    v_mul_f32 v9, v145, v9
    v_mul_f32 v10, v146, v10
    v_mul_f32 v11, v147, v11
    s_setprio 0
    buffer_load_dwordx4 v121, s[8:11], s22 offen offset:1024  lds
    s_setprio 3
    s_add_u32 s29, s29, 1
    s_waitcnt lgkmcnt(0)
    v_mfma_f32_16x16x32_bf16 v[88:91], v[48:51], v[40:43], v[88:91]
    v_mfma_f32_16x16x32_bf16 v[96:99], v[48:51], v[44:47], v[96:99]
    ds_read_b128 v[64:67], v127 offset:0
    ds_read_b128 v[68:71], v127 offset:2048
    ds_read_b128 v[72:75], v138 offset:25600
    ds_read_b128 v[76:79], v138 offset:27648
    v_mul_f32 v144, v12, v12
    v_mul_f32_e64 v145, v13, v13
    v_mul_f32 v146, v14, v14
    s_setprio 0
    buffer_load_dwordx4 v122, s[8:11], s22 offen offset:2048  lds
    s_setprio 3
    v_mfma_f32_16x16x32_bf16 v[92:95], v[52:55], v[40:43], v[92:95]
    v_mfma_f32_16x16x32_bf16 v[100:103], v[52:55], v[44:47], v[100:103]
    ds_read_b128 v[80:83], v138 offset:29696
    ds_read_b128 v[84:87], v138 offset:31744
    ds_read_b32 v4, v3
    v_mul_f32 v147, v15, v15
    v_fmaak_f32 v144, v156, v144, 0xc0135761
    v_fmaak_f32 v145, v156, v145, 0xc0135761
    v_fmaak_f32 v146, v156, v146, 0xc0135761
    s_setprio 0
    buffer_load_dwordx4 v123, s[8:11], s22 offen offset:3072  lds
    s_add_u32 s22, s22, 128
    s_nop 0
    s_setprio 3
    v_mfma_f32_16x16x32_bf16 v[104:107], v[56:59], v[40:43], v[104:107]
    v_mfma_f32_16x16x32_bf16 v[112:115], v[56:59], v[44:47], v[112:115]
    v_fmaak_f32 v147, v156, v147, 0xc0135761
    v_mul_f32 v144, v144, v12
    v_mul_f32_e64 v145, v145, v13
    v_mfma_f32_16x16x32_bf16 v[108:111], v[60:63], v[40:43], v[108:111]
    v_mfma_f32_16x16x32_bf16 v[116:119], v[60:63], v[44:47], v[116:119]
    v_mul_f32 v146, v146, v14
    v_mul_f32 v147, v147, v15
    v_exp_f32 v144, v144
    v_exp_f32 v145, v145
    s_add_u32 m0, s27, 8192
    s_waitcnt vmcnt(7) lgkmcnt(0)
    v_cmp_gt_u32 vcc, s29, v4
    s_cbranch_vccnz L_parallel_sum__grouped_kv_mqa__mixer_gmlp__prompt_gslow_174
L_parallel_sum__grouped_kv_mqa__mixer_gmlp__prompt_gok_173:
    v_mfma_f32_16x16x32_bf16 v[88:91], v[72:75], v[64:67], v[88:91]
    v_mfma_f32_16x16x32_bf16 v[96:99], v[72:75], v[68:71], v[96:99]
    ds_read_b128 v[40:43], v126 offset:16384
    ds_read_b128 v[44:47], v126 offset:18432
    ds_read_b128 v[48:51], v138 offset:32768
    v_exp_f32 v146, v146
    v_exp_f32_e64 v147, v147
    v_add_f32 v144, 1.0, v144
    s_setprio 0
    buffer_load_dwordx4 v124, s[12:15], s24 offen offset:0 sc1 lds
    s_setprio 3
    v_mfma_f32_16x16x32_bf16 v[92:95], v[76:79], v[64:67], v[92:95]
    v_mfma_f32_16x16x32_bf16 v[100:103], v[76:79], v[68:71], v[100:103]
    ds_read_b128 v[52:55], v138 offset:34816
    ds_read_b128 v[56:59], v138 offset:36864
    ds_read_b128 v[60:63], v138 offset:38912
    v_add_f32 v145, 1.0, v145
    v_add_f32 v146, 1.0, v146
    v_add_f32 v147, 1.0, v147
    v_rcp_f32 v144, v144
    s_setprio 0
    buffer_load_dwordx4 v125, s[12:15], s24 offen offset:1024 sc1 lds
    s_add_u32 s24, s24, s25
    s_mov_b32 m0, s31
    s_add_u32 s71, s71, 4
    buffer_load_dword v137, s[40:43], s71 offen lds
    s_add_u32 m0, s26, 0
    s_setprio 3
    v_mfma_f32_16x16x32_bf16 v[104:107], v[80:83], v[64:67], v[104:107]
    v_mfma_f32_16x16x32_bf16 v[112:115], v[80:83], v[68:71], v[112:115]
    v_rcp_f32 v145, v145
    v_rcp_f32_e64 v146, v146
    v_rcp_f32 v147, v147
    s_setprio 0
    buffer_load_dwordx4 v120, s[8:11], s22 offen offset:0  lds
    s_setprio 3
    v_mfma_f32_16x16x32_bf16 v[108:111], v[84:87], v[64:67], v[108:111]
    v_mfma_f32_16x16x32_bf16 v[116:119], v[84:87], v[68:71], v[116:119]
    v_mul_f32 v12, v144, v12
    v_mul_f32 v13, v145, v13
    v_mul_f32 v14, v146, v14
    v_mul_f32 v15, v147, v15
    s_setprio 0
    buffer_load_dwordx4 v121, s[8:11], s22 offen offset:1024  lds
    s_setprio 3
    s_add_u32 s29, s29, 1
    s_waitcnt lgkmcnt(0)
    v_mfma_f32_16x16x32_bf16 v[88:91], v[48:51], v[40:43], v[88:91]
    v_mfma_f32_16x16x32_bf16 v[96:99], v[48:51], v[44:47], v[96:99]
    ds_read_b128 v[64:67], v127 offset:16384
    ds_read_b128 v[68:71], v127 offset:18432
    ds_read_b128 v[72:75], v138 offset:33792
    ds_read_b128 v[76:79], v138 offset:35840
    v_mul_f32 v144, v16, v16
    v_mul_f32_e64 v145, v17, v17
    v_mul_f32 v146, v18, v18
    s_setprio 0
    buffer_load_dwordx4 v122, s[8:11], s22 offen offset:2048  lds
    s_setprio 3
    v_mfma_f32_16x16x32_bf16 v[92:95], v[52:55], v[40:43], v[92:95]
    v_mfma_f32_16x16x32_bf16 v[100:103], v[52:55], v[44:47], v[100:103]
    ds_read_b128 v[80:83], v138 offset:37888
    ds_read_b128 v[84:87], v138 offset:39936
    ds_read_b32 v4, v3
    v_mul_f32 v147, v19, v19
    v_fmaak_f32 v144, v156, v144, 0xc0135761
    v_fmaak_f32 v145, v156, v145, 0xc0135761
    v_fmaak_f32 v146, v156, v146, 0xc0135761
    s_setprio 0
    buffer_load_dwordx4 v123, s[8:11], s22 offen offset:3072  lds
    s_add_u32 s22, s22, 128
    s_nop 0
    s_setprio 3
    v_mfma_f32_16x16x32_bf16 v[104:107], v[56:59], v[40:43], v[104:107]
    v_mfma_f32_16x16x32_bf16 v[112:115], v[56:59], v[44:47], v[112:115]
    v_fmaak_f32 v147, v156, v147, 0xc0135761
    v_mul_f32 v144, v144, v16
    v_mul_f32_e64 v145, v145, v17
    v_mfma_f32_16x16x32_bf16 v[108:111], v[60:63], v[40:43], v[108:111]
    v_mfma_f32_16x16x32_bf16 v[116:119], v[60:63], v[44:47], v[116:119]
    v_mul_f32 v146, v146, v18
    v_mul_f32 v147, v147, v19
    v_exp_f32 v144, v144
    v_exp_f32 v145, v145
    s_add_u32 m0, s27, 16384
    s_waitcnt vmcnt(7) lgkmcnt(0)
    v_cmp_gt_u32 vcc, s29, v4
    s_cbranch_vccnz L_parallel_sum__grouped_kv_mqa__mixer_gmlp__prompt_gslow_176
L_parallel_sum__grouped_kv_mqa__mixer_gmlp__prompt_gok_175:
    v_mfma_f32_16x16x32_bf16 v[88:91], v[72:75], v[64:67], v[88:91]
    v_mfma_f32_16x16x32_bf16 v[96:99], v[72:75], v[68:71], v[96:99]
    ds_read_b128 v[40:43], v126 offset:32768
    ds_read_b128 v[44:47], v126 offset:34816
    ds_read_b128 v[48:51], v138 offset:40960
    v_exp_f32 v146, v146
    v_exp_f32_e64 v147, v147
    v_add_f32 v144, 1.0, v144
    s_setprio 0
    buffer_load_dwordx4 v124, s[12:15], s24 offen offset:0 sc1 lds
    s_setprio 3
    v_mfma_f32_16x16x32_bf16 v[92:95], v[76:79], v[64:67], v[92:95]
    v_mfma_f32_16x16x32_bf16 v[100:103], v[76:79], v[68:71], v[100:103]
    ds_read_b128 v[52:55], v138 offset:43008
    ds_read_b128 v[56:59], v138 offset:45056
    ds_read_b128 v[60:63], v138 offset:47104
    v_add_f32 v145, 1.0, v145
    v_add_f32 v146, 1.0, v146
    v_add_f32 v147, 1.0, v147
    v_rcp_f32 v144, v144
    s_setprio 0
    buffer_load_dwordx4 v125, s[12:15], s24 offen offset:1024 sc1 lds
    s_add_u32 s24, s24, s25
    s_mov_b32 m0, s31
    s_add_u32 s71, s71, 4
    buffer_load_dword v137, s[40:43], s71 offen lds
    s_add_u32 m0, s26, 16384
    s_setprio 3
    v_mfma_f32_16x16x32_bf16 v[104:107], v[80:83], v[64:67], v[104:107]
    v_mfma_f32_16x16x32_bf16 v[112:115], v[80:83], v[68:71], v[112:115]
    v_rcp_f32 v145, v145
    v_rcp_f32 v146, v146
    v_rcp_f32 v147, v147
    s_setprio 0
    buffer_load_dwordx4 v120, s[8:11], s22 offen offset:0  lds
    s_setprio 3
    v_mfma_f32_16x16x32_bf16 v[108:111], v[84:87], v[64:67], v[108:111]
    v_mfma_f32_16x16x32_bf16 v[116:119], v[84:87], v[68:71], v[116:119]
    v_mul_f32 v16, v144, v16
    v_mul_f32 v17, v145, v17
    v_mul_f32 v18, v146, v18
    v_mul_f32 v19, v147, v19
    s_setprio 0
    buffer_load_dwordx4 v121, s[8:11], s22 offen offset:1024  lds
    s_setprio 3
    s_add_u32 s29, s29, 1
    s_waitcnt lgkmcnt(0)
    v_mfma_f32_16x16x32_bf16 v[88:91], v[48:51], v[40:43], v[88:91]
    v_mfma_f32_16x16x32_bf16 v[96:99], v[48:51], v[44:47], v[96:99]
    ds_read_b128 v[64:67], v127 offset:32768
    ds_read_b128 v[68:71], v127 offset:34816
    ds_read_b128 v[72:75], v138 offset:41984
    ds_read_b128 v[76:79], v138 offset:44032
    v_mul_f32 v144, v20, v20
    v_mul_f32_e64 v145, v21, v21
    v_mul_f32 v146, v22, v22
    s_setprio 0
    buffer_load_dwordx4 v122, s[8:11], s22 offen offset:2048  lds
    s_setprio 3
    v_mfma_f32_16x16x32_bf16 v[92:95], v[52:55], v[40:43], v[92:95]
    v_mfma_f32_16x16x32_bf16 v[100:103], v[52:55], v[44:47], v[100:103]
    ds_read_b128 v[80:83], v138 offset:46080
    ds_read_b128 v[84:87], v138 offset:48128
    ds_read_b32 v4, v3
    v_mul_f32 v147, v23, v23
    v_fmaak_f32 v144, v156, v144, 0xc0135761
    v_fmaak_f32 v145, v156, v145, 0xc0135761
    v_fmaak_f32 v146, v156, v146, 0xc0135761
    s_setprio 0
    buffer_load_dwordx4 v123, s[8:11], s22 offen offset:3072  lds
    s_add_u32 s22, s22, 128
    s_nop 0
    s_setprio 3
    v_mfma_f32_16x16x32_bf16 v[104:107], v[56:59], v[40:43], v[104:107]
    v_mfma_f32_16x16x32_bf16 v[112:115], v[56:59], v[44:47], v[112:115]
    v_fmaak_f32 v147, v156, v147, 0xc0135761
    v_mul_f32 v144, v144, v20
    v_mul_f32_e64 v145, v145, v21
    v_mfma_f32_16x16x32_bf16 v[108:111], v[60:63], v[40:43], v[108:111]
    v_mfma_f32_16x16x32_bf16 v[116:119], v[60:63], v[44:47], v[116:119]
    v_mul_f32 v146, v146, v22
    v_mul_f32 v147, v147, v23
    v_exp_f32 v144, v144
    v_exp_f32 v145, v145
    s_add_u32 m0, s27, 24576
    s_waitcnt vmcnt(7) lgkmcnt(0)
    v_cmp_gt_u32 vcc, s29, v4
    s_cbranch_vccnz L_parallel_sum__grouped_kv_mqa__mixer_gmlp__prompt_gslow_178
L_parallel_sum__grouped_kv_mqa__mixer_gmlp__prompt_gok_177:
    v_mfma_f32_16x16x32_bf16 v[88:91], v[72:75], v[64:67], v[88:91]
    v_mfma_f32_16x16x32_bf16 v[96:99], v[72:75], v[68:71], v[96:99]
    ds_read_b128 v[40:43], v126 offset:0
    ds_read_b128 v[44:47], v126 offset:2048
    ds_read_b128 v[48:51], v138 offset:0
    v_exp_f32 v146, v146
    v_exp_f32_e64 v147, v147
    v_add_f32 v144, 1.0, v144
    s_setprio 0
    buffer_load_dwordx4 v124, s[12:15], s24 offen offset:0 sc1 lds
    s_setprio 3
    v_mfma_f32_16x16x32_bf16 v[92:95], v[76:79], v[64:67], v[92:95]
    v_mfma_f32_16x16x32_bf16 v[100:103], v[76:79], v[68:71], v[100:103]
    ds_read_b128 v[52:55], v138 offset:2048
    ds_read_b128 v[56:59], v138 offset:4096
    ds_read_b128 v[60:63], v138 offset:6144
    v_add_f32 v145, 1.0, v145
    v_add_f32 v146, 1.0, v146
    v_add_f32 v147, 1.0, v147
    v_rcp_f32 v144, v144
    s_setprio 0
    buffer_load_dwordx4 v125, s[12:15], s24 offen offset:1024 sc1 lds
    s_add_u32 s24, s24, s25
    s_mov_b32 m0, s31
    s_add_u32 s71, s71, 4
    buffer_load_dword v137, s[40:43], s71 offen lds
    s_add_u32 m0, s26, 32768
    s_setprio 3
    v_mfma_f32_16x16x32_bf16 v[104:107], v[80:83], v[64:67], v[104:107]
    v_mfma_f32_16x16x32_bf16 v[112:115], v[80:83], v[68:71], v[112:115]
    v_rcp_f32 v145, v145
    v_rcp_f32 v146, v146
    v_rcp_f32 v147, v147
    s_setprio 0
    buffer_load_dwordx4 v120, s[8:11], s22 offen offset:0  lds
    s_setprio 3
    v_mfma_f32_16x16x32_bf16 v[108:111], v[84:87], v[64:67], v[108:111]
    v_mfma_f32_16x16x32_bf16 v[116:119], v[84:87], v[68:71], v[116:119]
    v_mul_f32 v20, v144, v20
    v_mul_f32 v21, v145, v21
    v_mul_f32 v22, v146, v22
    v_mul_f32 v23, v147, v23
    s_setprio 0
    buffer_load_dwordx4 v121, s[8:11], s22 offen offset:1024  lds
    s_setprio 3
    s_add_u32 s29, s29, 1
    s_waitcnt lgkmcnt(0)
    v_mfma_f32_16x16x32_bf16 v[88:91], v[48:51], v[40:43], v[88:91]
    v_mfma_f32_16x16x32_bf16 v[96:99], v[48:51], v[44:47], v[96:99]
    ds_read_b128 v[64:67], v127 offset:0
    ds_read_b128 v[68:71], v127 offset:2048
    ds_read_b128 v[72:75], v138 offset:1024
    ds_read_b128 v[76:79], v138 offset:3072
    v_mul_f32 v144, v24, v24
    v_mul_f32_e64 v145, v25, v25
    v_mul_f32 v146, v26, v26
    s_setprio 0
    buffer_load_dwordx4 v122, s[8:11], s22 offen offset:2048  lds
    s_setprio 3
    v_mfma_f32_16x16x32_bf16 v[92:95], v[52:55], v[40:43], v[92:95]
    v_mfma_f32_16x16x32_bf16 v[100:103], v[52:55], v[44:47], v[100:103]
    ds_read_b128 v[80:83], v138 offset:5120
    ds_read_b128 v[84:87], v138 offset:7168
    ds_read_b32 v4, v3
    v_mul_f32 v147, v27, v27
    v_fmaak_f32 v144, v156, v144, 0xc0135761
    v_fmaak_f32 v145, v156, v145, 0xc0135761
    v_fmaak_f32 v146, v156, v146, 0xc0135761
    s_setprio 0
    buffer_load_dwordx4 v123, s[8:11], s22 offen offset:3072  lds
    s_add_u32 s22, s22, 128
    s_nop 0
    s_setprio 3
    v_mfma_f32_16x16x32_bf16 v[104:107], v[56:59], v[40:43], v[104:107]
    v_mfma_f32_16x16x32_bf16 v[112:115], v[56:59], v[44:47], v[112:115]
    v_fmaak_f32 v147, v156, v147, 0xc0135761
    v_mul_f32 v144, v144, v24
    v_mul_f32_e64 v145, v145, v25
    v_mfma_f32_16x16x32_bf16 v[108:111], v[60:63], v[40:43], v[108:111]
    v_mfma_f32_16x16x32_bf16 v[116:119], v[60:63], v[44:47], v[116:119]
    v_mul_f32 v146, v146, v26
    v_mul_f32 v147, v147, v27
    v_exp_f32 v144, v144
    v_exp_f32 v145, v145
    s_add_u32 m0, s27, 32768
    s_waitcnt vmcnt(7) lgkmcnt(0)
    v_cmp_gt_u32 vcc, s29, v4
    s_cbranch_vccnz L_parallel_sum__grouped_kv_mqa__mixer_gmlp__prompt_gslow_180
L_parallel_sum__grouped_kv_mqa__mixer_gmlp__prompt_gok_179:
    v_mfma_f32_16x16x32_bf16 v[88:91], v[72:75], v[64:67], v[88:91]
    v_mfma_f32_16x16x32_bf16 v[96:99], v[72:75], v[68:71], v[96:99]
    ds_read_b128 v[40:43], v126 offset:16384
    ds_read_b128 v[44:47], v126 offset:18432
    ds_read_b128 v[48:51], v138 offset:8192
    v_exp_f32 v146, v146
    v_exp_f32_e64 v147, v147
    v_add_f32 v144, 1.0, v144
    s_setprio 0
    buffer_load_dwordx4 v124, s[12:15], s24 offen offset:0 sc1 lds
    s_setprio 3
    v_mfma_f32_16x16x32_bf16 v[92:95], v[76:79], v[64:67], v[92:95]
    v_mfma_f32_16x16x32_bf16 v[100:103], v[76:79], v[68:71], v[100:103]
    ds_read_b128 v[52:55], v138 offset:10240
    ds_read_b128 v[56:59], v138 offset:12288
    ds_read_b128 v[60:63], v138 offset:14336
    v_add_f32 v145, 1.0, v145
    v_add_f32 v146, 1.0, v146
    v_add_f32 v147, 1.0, v147
    v_rcp_f32 v144, v144
    s_setprio 0
    buffer_load_dwordx4 v125, s[12:15], s24 offen offset:1024 sc1 lds
    s_add_u32 s24, s24, s25
    s_mov_b32 m0, s31
    s_add_u32 s71, s71, 4
    buffer_load_dword v137, s[40:43], s71 offen lds
    s_add_u32 m0, s26, 0
    s_setprio 3
    v_mfma_f32_16x16x32_bf16 v[104:107], v[80:83], v[64:67], v[104:107]
    v_mfma_f32_16x16x32_bf16 v[112:115], v[80:83], v[68:71], v[112:115]
    v_rcp_f32 v145, v145
    v_rcp_f32_e64 v146, v146
    v_rcp_f32 v147, v147
    s_setprio 0
    buffer_load_dwordx4 v120, s[8:11], s22 offen offset:0  lds
    s_setprio 3
    v_mfma_f32_16x16x32_bf16 v[108:111], v[84:87], v[64:67], v[108:111]
    v_mfma_f32_16x16x32_bf16 v[116:119], v[84:87], v[68:71], v[116:119]
    v_mul_f32 v24, v144, v24
    v_mul_f32 v25, v145, v25
    v_mul_f32 v26, v146, v26
    v_mul_f32 v27, v147, v27
    s_setprio 0
    buffer_load_dwordx4 v121, s[8:11], s22 offen offset:1024  lds
    s_setprio 3
    s_add_u32 s29, s29, 1
    v_and_b32 v158, 31, v1
    v_lshlrev_b32 v158, 7, v158
    s_mov_b32 s32, 163840
    buffer_load_dwordx2 v[152:153], v158, s[72:75], s32 offen sc1
    s_waitcnt lgkmcnt(0)
    v_mfma_f32_16x16x32_bf16 v[88:91], v[48:51], v[40:43], v[88:91]
    v_mfma_f32_16x16x32_bf16 v[96:99], v[48:51], v[44:47], v[96:99]
    ds_read_b128 v[64:67], v127 offset:16384
    ds_read_b128 v[68:71], v127 offset:18432
    ds_read_b128 v[72:75], v138 offset:9216
    ds_read_b128 v[76:79], v138 offset:11264
    v_mul_f32 v144, v28, v28
    v_mul_f32_e64 v145, v29, v29
    v_mul_f32 v146, v30, v30
    s_setprio 0
    buffer_load_dwordx4 v122, s[8:11], s22 offen offset:2048  lds
    s_setprio 3
    v_mfma_f32_16x16x32_bf16 v[92:95], v[52:55], v[40:43], v[92:95]
    v_mfma_f32_16x16x32_bf16 v[100:103], v[52:55], v[44:47], v[100:103]
    ds_read_b128 v[80:83], v138 offset:13312
    ds_read_b128 v[84:87], v138 offset:15360
    ds_read_b32 v4, v3
    v_mul_f32 v147, v31, v31
    v_fmaak_f32 v144, v156, v144, 0xc0135761
    v_fmaak_f32 v145, v156, v145, 0xc0135761
    v_fmaak_f32 v146, v156, v146, 0xc0135761
    s_setprio 0
    buffer_load_dwordx4 v123, s[8:11], s22 offen offset:3072  lds
    s_add_u32 s22, s22, 128
    s_nop 0
    s_setprio 3
    v_mfma_f32_16x16x32_bf16 v[104:107], v[56:59], v[40:43], v[104:107]
    v_mfma_f32_16x16x32_bf16 v[112:115], v[56:59], v[44:47], v[112:115]
    v_fmaak_f32 v147, v156, v147, 0xc0135761
    v_mul_f32 v144, v144, v28
    v_mul_f32_e64 v145, v145, v29
    v_mfma_f32_16x16x32_bf16 v[108:111], v[60:63], v[40:43], v[108:111]
    v_mfma_f32_16x16x32_bf16 v[116:119], v[60:63], v[44:47], v[116:119]
    v_mul_f32 v146, v146, v30
    v_mul_f32 v147, v147, v31
    v_exp_f32 v144, v144
    v_exp_f32 v145, v145
    s_add_u32 m0, s27, 40960
    s_waitcnt vmcnt(7) lgkmcnt(0)
    v_cmp_gt_u32 vcc, s29, v4
    s_cbranch_vccnz L_parallel_sum__grouped_kv_mqa__mixer_gmlp__prompt_gslow_182
L_parallel_sum__grouped_kv_mqa__mixer_gmlp__prompt_gok_181:
    v_mfma_f32_16x16x32_bf16 v[88:91], v[72:75], v[64:67], v[88:91]
    v_mfma_f32_16x16x32_bf16 v[96:99], v[72:75], v[68:71], v[96:99]
    ds_read_b128 v[40:43], v126 offset:32768
    ds_read_b128 v[44:47], v126 offset:34816
    ds_read_b128 v[48:51], v138 offset:16384
    v_exp_f32 v146, v146
    v_exp_f32_e64 v147, v147
    v_add_f32 v144, 1.0, v144
    s_setprio 0
    buffer_load_dwordx4 v124, s[12:15], s24 offen offset:0 sc1 lds
    s_setprio 3
    v_mfma_f32_16x16x32_bf16 v[92:95], v[76:79], v[64:67], v[92:95]
    v_mfma_f32_16x16x32_bf16 v[100:103], v[76:79], v[68:71], v[100:103]
    ds_read_b128 v[52:55], v138 offset:18432
    ds_read_b128 v[56:59], v138 offset:20480
    ds_read_b128 v[60:63], v138 offset:22528
    v_add_f32 v145, 1.0, v145
    v_add_f32 v146, 1.0, v146
    v_add_f32 v147, 1.0, v147
    v_rcp_f32 v144, v144
    s_setprio 0
    buffer_load_dwordx4 v125, s[12:15], s24 offen offset:1024 sc1 lds
    s_add_u32 s24, s24, s25
    s_mov_b32 m0, s31
    s_add_u32 s71, s71, 4
    buffer_load_dword v137, s[40:43], s71 offen lds
    s_add_u32 m0, s26, 16384
    s_setprio 3
    v_mfma_f32_16x16x32_bf16 v[104:107], v[80:83], v[64:67], v[104:107]
    v_mfma_f32_16x16x32_bf16 v[112:115], v[80:83], v[68:71], v[112:115]
    v_rcp_f32 v145, v145
    v_rcp_f32 v146, v146
    v_rcp_f32 v147, v147
    s_setprio 0
    buffer_load_dwordx4 v120, s[8:11], s22 offen offset:0  lds
    s_setprio 3
    v_mfma_f32_16x16x32_bf16 v[108:111], v[84:87], v[64:67], v[108:111]
    v_mfma_f32_16x16x32_bf16 v[116:119], v[84:87], v[68:71], v[116:119]
    v_mul_f32 v28, v144, v28
    v_mul_f32 v29, v145, v29
    v_mul_f32 v30, v146, v30
    v_mul_f32 v31, v147, v31
    s_setprio 0
    buffer_load_dwordx4 v121, s[8:11], s22 offen offset:1024  lds
    s_setprio 3
    s_add_u32 s29, s29, 1
    s_waitcnt lgkmcnt(0)
    v_mfma_f32_16x16x32_bf16 v[88:91], v[48:51], v[40:43], v[88:91]
    v_mfma_f32_16x16x32_bf16 v[96:99], v[48:51], v[44:47], v[96:99]
    ds_read_b128 v[64:67], v127 offset:32768
    ds_read_b128 v[68:71], v127 offset:34816
    ds_read_b128 v[72:75], v138 offset:17408
    ds_read_b128 v[76:79], v138 offset:19456
    v_mul_f32 v144, v32, v32
    v_mul_f32_e64 v145, v33, v33
    v_mul_f32 v146, v34, v34
    s_setprio 0
    buffer_load_dwordx4 v122, s[8:11], s22 offen offset:2048  lds
    s_setprio 3
    v_mfma_f32_16x16x32_bf16 v[92:95], v[52:55], v[40:43], v[92:95]
    v_mfma_f32_16x16x32_bf16 v[100:103], v[52:55], v[44:47], v[100:103]
    ds_read_b128 v[80:83], v138 offset:21504
    ds_read_b128 v[84:87], v138 offset:23552
    ds_read_b32 v4, v3
    v_mul_f32 v147, v35, v35
    v_fmaak_f32 v144, v156, v144, 0xc0135761
    v_fmaak_f32 v145, v156, v145, 0xc0135761
    v_fmaak_f32 v146, v156, v146, 0xc0135761
    s_setprio 0
    buffer_load_dwordx4 v123, s[8:11], s22 offen offset:3072  lds
    s_add_u32 s22, s22, 128
    s_nop 0
    s_setprio 3
    v_mfma_f32_16x16x32_bf16 v[104:107], v[56:59], v[40:43], v[104:107]
    v_mfma_f32_16x16x32_bf16 v[112:115], v[56:59], v[44:47], v[112:115]
    v_fmaak_f32 v147, v156, v147, 0xc0135761
    v_mul_f32 v144, v144, v32
    v_mul_f32_e64 v145, v145, v33
    v_mfma_f32_16x16x32_bf16 v[108:111], v[60:63], v[40:43], v[108:111]
    v_mfma_f32_16x16x32_bf16 v[116:119], v[60:63], v[44:47], v[116:119]
    v_mul_f32 v146, v146, v34
    v_mul_f32 v147, v147, v35
    v_exp_f32 v144, v144
    v_exp_f32 v145, v145
    s_add_u32 m0, s27, 0
    s_waitcnt vmcnt(7) lgkmcnt(0)
    v_cmp_gt_u32 vcc, s29, v4
    s_cbranch_vccnz L_parallel_sum__grouped_kv_mqa__mixer_gmlp__prompt_gslow_184
L_parallel_sum__grouped_kv_mqa__mixer_gmlp__prompt_gok_183:
    v_mfma_f32_16x16x32_bf16 v[88:91], v[72:75], v[64:67], v[88:91]
    v_mfma_f32_16x16x32_bf16 v[96:99], v[72:75], v[68:71], v[96:99]
    ds_read_b128 v[40:43], v126 offset:0
    ds_read_b128 v[44:47], v126 offset:2048
    ds_read_b128 v[48:51], v138 offset:24576
    v_exp_f32 v146, v146
    v_exp_f32 v147, v147
    v_add_f32 v144, 1.0, v144
    s_setprio 0
    buffer_load_dwordx4 v124, s[12:15], s24 offen offset:0 sc1 lds
    s_setprio 3
    v_mfma_f32_16x16x32_bf16 v[92:95], v[76:79], v[64:67], v[92:95]
    v_mfma_f32_16x16x32_bf16 v[100:103], v[76:79], v[68:71], v[100:103]
    ds_read_b128 v[52:55], v138 offset:26624
    ds_read_b128 v[56:59], v138 offset:28672
    ds_read_b128 v[60:63], v138 offset:30720
    v_add_f32 v145, 1.0, v145
    v_add_f32 v146, 1.0, v146
    v_add_f32 v147, 1.0, v147
    v_rcp_f32 v144, v144
    s_setprio 0
    buffer_load_dwordx4 v125, s[12:15], s24 offen offset:1024 sc1 lds
    s_add_u32 s24, s24, s25
    s_mov_b32 m0, s31
    s_add_u32 s71, s71, 4
    buffer_load_dword v137, s[40:43], s71 offen lds
    s_add_u32 m0, s26, 32768
    s_setprio 3
    v_mfma_f32_16x16x32_bf16 v[104:107], v[80:83], v[64:67], v[104:107]
    v_mfma_f32_16x16x32_bf16 v[112:115], v[80:83], v[68:71], v[112:115]
    v_rcp_f32 v145, v145
    v_rcp_f32 v146, v146
    v_rcp_f32 v147, v147
    s_setprio 0
    buffer_load_dwordx4 v120, s[8:11], s22 offen offset:0  lds
    s_setprio 3
    v_mfma_f32_16x16x32_bf16 v[108:111], v[84:87], v[64:67], v[108:111]
    v_mfma_f32_16x16x32_bf16 v[116:119], v[84:87], v[68:71], v[116:119]
    v_mul_f32 v32, v144, v32
    v_mul_f32 v33, v145, v33
    v_mul_f32 v34, v146, v34
    v_mul_f32 v35, v147, v35
    s_setprio 0
    buffer_load_dwordx4 v121, s[8:11], s22 offen offset:1024  lds
    s_setprio 3
    s_add_u32 s29, s29, 1
    s_waitcnt lgkmcnt(0)
    v_mfma_f32_16x16x32_bf16 v[88:91], v[48:51], v[40:43], v[88:91]
    v_mfma_f32_16x16x32_bf16 v[96:99], v[48:51], v[44:47], v[96:99]
    ds_read_b128 v[64:67], v127 offset:0
    ds_read_b128 v[68:71], v127 offset:2048
    ds_read_b128 v[72:75], v138 offset:25600
    ds_read_b128 v[76:79], v138 offset:27648
    v_mul_f32 v144, v36, v36
    v_mul_f32_e64 v145, v37, v37
    v_mul_f32 v146, v38, v38
    s_setprio 0
    buffer_load_dwordx4 v122, s[8:11], s22 offen offset:2048  lds
    s_setprio 3
    v_mfma_f32_16x16x32_bf16 v[92:95], v[52:55], v[40:43], v[92:95]
    v_mfma_f32_16x16x32_bf16 v[100:103], v[52:55], v[44:47], v[100:103]
    ds_read_b128 v[80:83], v138 offset:29696
    ds_read_b128 v[84:87], v138 offset:31744
    ds_read_b32 v4, v3
    v_mul_f32 v147, v39, v39
    v_fmaak_f32 v144, v156, v144, 0xc0135761
    v_fmaak_f32 v145, v156, v145, 0xc0135761
    v_fmaak_f32 v146, v156, v146, 0xc0135761
    s_setprio 0
    buffer_load_dwordx4 v123, s[8:11], s22 offen offset:3072  lds
    s_add_u32 s22, s22, 128
    s_nop 0
    s_setprio 3
    v_mfma_f32_16x16x32_bf16 v[104:107], v[56:59], v[40:43], v[104:107]
    v_mfma_f32_16x16x32_bf16 v[112:115], v[56:59], v[44:47], v[112:115]
    v_fmaak_f32 v147, v156, v147, 0xc0135761
    v_mul_f32 v144, v144, v36
    v_mul_f32_e64 v145, v145, v37
    v_mfma_f32_16x16x32_bf16 v[108:111], v[60:63], v[40:43], v[108:111]
    v_mfma_f32_16x16x32_bf16 v[116:119], v[60:63], v[44:47], v[116:119]
    v_mul_f32 v146, v146, v38
    v_mul_f32 v147, v147, v39
    v_exp_f32 v144, v144
    v_exp_f32 v145, v145
    s_add_u32 m0, s27, 8192
    s_waitcnt vmcnt(7) lgkmcnt(0)
    v_cmp_gt_u32 vcc, s29, v4
    s_cbranch_vccnz L_parallel_sum__grouped_kv_mqa__mixer_gmlp__prompt_gslow_186
L_parallel_sum__grouped_kv_mqa__mixer_gmlp__prompt_gok_185:
    v_mfma_f32_16x16x32_bf16 v[88:91], v[72:75], v[64:67], v[88:91]
    v_mfma_f32_16x16x32_bf16 v[96:99], v[72:75], v[68:71], v[96:99]
    ds_read_b128 v[40:43], v126 offset:16384
    ds_read_b128 v[44:47], v126 offset:18432
    ds_read_b128 v[48:51], v138 offset:32768
    v_exp_f32 v146, v146
    v_exp_f32_e64 v147, v147
    v_add_f32 v144, 1.0, v144
    s_setprio 0
    buffer_load_dwordx4 v124, s[12:15], s24 offen offset:0 sc1 lds
    s_setprio 3
    v_mfma_f32_16x16x32_bf16 v[92:95], v[76:79], v[64:67], v[92:95]
    v_mfma_f32_16x16x32_bf16 v[100:103], v[76:79], v[68:71], v[100:103]
    ds_read_b128 v[52:55], v138 offset:34816
    ds_read_b128 v[56:59], v138 offset:36864
    ds_read_b128 v[60:63], v138 offset:38912
    v_add_f32 v145, 1.0, v145
    v_add_f32 v146, 1.0, v146
    v_add_f32 v147, 1.0, v147
    v_rcp_f32 v144, v144
    s_setprio 0
    buffer_load_dwordx4 v125, s[12:15], s24 offen offset:1024 sc1 lds
    s_add_u32 s24, s24, s25
    s_mov_b32 m0, s31
    s_add_u32 s71, s71, 4
    buffer_load_dword v137, s[40:43], s71 offen lds
    s_add_u32 m0, s26, 0
    s_setprio 3
    v_mfma_f32_16x16x32_bf16 v[104:107], v[80:83], v[64:67], v[104:107]
    v_mfma_f32_16x16x32_bf16 v[112:115], v[80:83], v[68:71], v[112:115]
    v_rcp_f32 v145, v145
    v_rcp_f32_e64 v146, v146
    v_rcp_f32 v147, v147
    s_setprio 0
    buffer_load_dwordx4 v120, s[8:11], s22 offen offset:0  lds
    s_setprio 3
    v_mfma_f32_16x16x32_bf16 v[108:111], v[84:87], v[64:67], v[108:111]
    v_mfma_f32_16x16x32_bf16 v[116:119], v[84:87], v[68:71], v[116:119]
    v_mul_f32 v36, v144, v36
    v_mul_f32 v37, v145, v37
    v_mul_f32 v38, v146, v38
    v_mul_f32 v39, v147, v39
    s_setprio 0
    buffer_load_dwordx4 v121, s[8:11], s22 offen offset:1024  lds
    s_setprio 3
    s_add_u32 s29, s29, 1
    v_cmp_ne_u64 vcc, s[96:97], v[152:153]
    s_cbranch_vccz L_parallel_sum__grouped_kv_mqa__mixer_gmlp__prompt_wok_187
    s_mov_b32 s32, 163840
L_parallel_sum__grouped_kv_mqa__mixer_gmlp__prompt_pl_188:
    buffer_load_dwordx2 v[152:153], v158, s[72:75], s32 offen sc1
    s_waitcnt vmcnt(0)
    v_cmp_ne_u64 vcc, s[96:97], v[152:153]
    s_cbranch_vccz L_parallel_sum__grouped_kv_mqa__mixer_gmlp__prompt_pd_189
    s_sleep 4
    s_sub_u32 s70, s70, 1
    s_cbranch_scc0 L_parallel_sum__grouped_kv_mqa__mixer_gmlp__prompt_pl_188
L_parallel_sum__grouped_kv_mqa__mixer_gmlp__prompt_pd_189:
L_parallel_sum__grouped_kv_mqa__mixer_gmlp__prompt_wok_187:
    s_lshr_b32 s30, s2, 5
    s_mul_i32 s23, s30, 240640
    s_add_u32 s23, s23, 38400
    s_add_u32 s12, s68, 0x012d0000
    s_addc_u32 s13, s69, 0
    s_mov_b32 s14, 0x001d6000
    s_mov_b32 s15, 0x00020000
    s_waitcnt lgkmcnt(0)
    v_mfma_f32_16x16x32_bf16 v[88:91], v[48:51], v[40:43], v[88:91]
    v_mfma_f32_16x16x32_bf16 v[96:99], v[48:51], v[44:47], v[96:99]
    ds_read_b128 v[64:67], v127 offset:16384
    ds_read_b128 v[68:71], v127 offset:18432
    ds_read_b128 v[72:75], v138 offset:33792
    ds_read_b128 v[76:79], v138 offset:35840
    s_setprio 0
    buffer_load_dwordx4 v122, s[8:11], s22 offen offset:2048  lds
    s_setprio 3
    v_mfma_f32_16x16x32_bf16 v[92:95], v[52:55], v[40:43], v[92:95]
    v_mfma_f32_16x16x32_bf16 v[100:103], v[52:55], v[44:47], v[100:103]
    ds_read_b128 v[80:83], v138 offset:37888
    ds_read_b128 v[84:87], v138 offset:39936
    ds_read_b32 v4, v3
    s_setprio 0
    buffer_load_dwordx4 v123, s[8:11], s22 offen offset:3072  lds
    s_add_u32 s22, s22, 128
    s_nop 0
    s_setprio 3
    v_mfma_f32_16x16x32_bf16 v[104:107], v[56:59], v[40:43], v[104:107]
    v_mfma_f32_16x16x32_bf16 v[112:115], v[56:59], v[44:47], v[112:115]
    v_mfma_f32_16x16x32_bf16 v[108:111], v[60:63], v[40:43], v[108:111]
    v_mfma_f32_16x16x32_bf16 v[116:119], v[60:63], v[44:47], v[116:119]
    s_add_u32 m0, s27, 16384
    s_add_u32 s24, m0, s23
    s_waitcnt vmcnt(7) lgkmcnt(0)
    v_cmp_gt_u32 vcc, s29, v4
    s_cbranch_vccnz L_parallel_sum__grouped_kv_mqa__mixer_gmlp__prompt_gslow_191
L_parallel_sum__grouped_kv_mqa__mixer_gmlp__prompt_gok_190:
    v_mfma_f32_16x16x32_bf16 v[88:91], v[72:75], v[64:67], v[88:91]
    v_mfma_f32_16x16x32_bf16 v[96:99], v[72:75], v[68:71], v[96:99]
    ds_read_b128 v[40:43], v126 offset:32768
    ds_read_b128 v[44:47], v126 offset:34816
    ds_read_b128 v[48:51], v138 offset:40960
    s_setprio 0
    buffer_load_dwordx4 v124, s[12:15], s24 offen offset:0 sc1 lds
    s_setprio 3
    v_mfma_f32_16x16x32_bf16 v[92:95], v[76:79], v[64:67], v[92:95]
    v_mfma_f32_16x16x32_bf16 v[100:103], v[76:79], v[68:71], v[100:103]
    ds_read_b128 v[52:55], v138 offset:43008
    ds_read_b128 v[56:59], v138 offset:45056
    ds_read_b128 v[60:63], v138 offset:47104
    s_setprio 0
    buffer_load_dwordx4 v125, s[12:15], s24 offen offset:1024 sc1 lds
    s_mov_b32 m0, s31
    s_add_u32 s71, s71, 4
    buffer_load_dword v137, s[40:43], s71 offen lds
    s_add_u32 m0, s26, 16384
    s_setprio 3
    v_mfma_f32_16x16x32_bf16 v[104:107], v[80:83], v[64:67], v[104:107]
    v_mfma_f32_16x16x32_bf16 v[112:115], v[80:83], v[68:71], v[112:115]
    s_setprio 0
    buffer_load_dwordx4 v120, s[8:11], s22 offen offset:0  lds
    buffer_load_dwordx4 v121, s[8:11], s22 offen offset:1024  lds
    s_setprio 3
    v_mfma_f32_16x16x32_bf16 v[108:111], v[84:87], v[64:67], v[108:111]
    v_mfma_f32_16x16x32_bf16 v[116:119], v[84:87], v[68:71], v[116:119]
    s_setprio 0
    buffer_load_dwordx4 v122, s[8:11], s22 offen offset:2048  lds
    buffer_load_dwordx4 v123, s[8:11], s22 offen offset:3072  lds
    s_setprio 3
    s_add_u32 s22, s22, 128
    s_add_u32 s29, s29, 1
    s_add_u32 s8, s68, 0x012d0000
    s_addc_u32 s9, s69, 0
    s_mov_b32 s10, 0x001d6000
    s_mov_b32 s11, 0x00020000
    v_mov_b32 v120, v124
    v_mov_b32 v121, v124
    v_mov_b32_e64 v122, v124
    v_mov_b32 v123, v124
    s_waitcnt lgkmcnt(0)
    v_mfma_f32_16x16x32_bf16 v[88:91], v[48:51], v[40:43], v[88:91]
    v_mfma_f32_16x16x32_bf16 v[96:99], v[48:51], v[44:47], v[96:99]
    ds_read_b128 v[64:67], v127 offset:32768
    ds_read_b128 v[68:71], v127 offset:34816
    ds_read_b128 v[72:75], v138 offset:41984
    ds_read_b128 v[76:79], v138 offset:44032
    v_mfma_f32_16x16x32_bf16 v[92:95], v[52:55], v[40:43], v[92:95]
    v_mfma_f32_16x16x32_bf16 v[100:103], v[52:55], v[44:47], v[100:103]
    ds_read_b128 v[80:83], v138 offset:46080
    ds_read_b128 v[84:87], v138 offset:48128
    ds_read_b32 v4, v3
    v_mfma_f32_16x16x32_bf16 v[104:107], v[56:59], v[40:43], v[104:107]
    v_mfma_f32_16x16x32_bf16 v[112:115], v[56:59], v[44:47], v[112:115]
    v_mfma_f32_16x16x32_bf16 v[108:111], v[60:63], v[40:43], v[108:111]
    v_mfma_f32_16x16x32_bf16 v[116:119], v[60:63], v[44:47], v[116:119]
    s_add_u32 m0, s27, 24576
    s_add_u32 s24, m0, s23
    s_waitcnt vmcnt(7) lgkmcnt(0)
    v_cmp_gt_u32 vcc, s29, v4
    s_cbranch_vccnz L_parallel_sum__grouped_kv_mqa__mixer_gmlp__prompt_gslow_193
L_parallel_sum__grouped_kv_mqa__mixer_gmlp__prompt_gok_192:
    v_mfma_f32_16x16x32_bf16 v[88:91], v[72:75], v[64:67], v[88:91]
    v_mfma_f32_16x16x32_bf16 v[96:99], v[72:75], v[68:71], v[96:99]
    ds_read_b128 v[40:43], v126 offset:0
    ds_read_b128 v[44:47], v126 offset:2048
    ds_read_b128 v[48:51], v138 offset:0
    s_setprio 0
    buffer_load_dwordx4 v124, s[12:15], s24 offen offset:0 sc1 lds
    s_setprio 3
    v_mfma_f32_16x16x32_bf16 v[92:95], v[76:79], v[64:67], v[92:95]
    v_mfma_f32_16x16x32_bf16 v[100:103], v[76:79], v[68:71], v[100:103]
    ds_read_b128 v[52:55], v138 offset:2048
    ds_read_b128 v[56:59], v138 offset:4096
    ds_read_b128 v[60:63], v138 offset:6144
    s_setprio 0
    buffer_load_dwordx4 v125, s[12:15], s24 offen offset:1024 sc1 lds
    s_mov_b32 m0, s31
    s_add_u32 s71, s71, 4
    buffer_load_dword v137, s[40:43], s71 offen lds
    s_add_u32 m0, s26, 32768
    s_add_u32 s22, m0, s23
    s_setprio 3
    v_mfma_f32_16x16x32_bf16 v[104:107], v[80:83], v[64:67], v[104:107]
    v_mfma_f32_16x16x32_bf16 v[112:115], v[80:83], v[68:71], v[112:115]
    s_setprio 0
    buffer_load_dwordx4 v120, s[8:11], s22 offen offset:0 sc1 lds
    buffer_load_dwordx4 v121, s[8:11], s22 offen offset:1024 sc1 lds
    s_setprio 3
    v_mfma_f32_16x16x32_bf16 v[108:111], v[84:87], v[64:67], v[108:111]
    v_mfma_f32_16x16x32_bf16 v[116:119], v[84:87], v[68:71], v[116:119]
    s_setprio 0
    buffer_load_dwordx4 v122, s[8:11], s22 offen offset:2048 sc1 lds
    buffer_load_dwordx4 v123, s[8:11], s22 offen offset:3072 sc1 lds
    s_setprio 3
    s_add_u32 s29, s29, 1
    s_waitcnt lgkmcnt(0)
    v_mfma_f32_16x16x32_bf16 v[88:91], v[48:51], v[40:43], v[88:91]
    v_mfma_f32_16x16x32_bf16 v[96:99], v[48:51], v[44:47], v[96:99]
    ds_read_b128 v[64:67], v127 offset:0
    ds_read_b128 v[68:71], v127 offset:2048
    ds_read_b128 v[72:75], v138 offset:1024
    ds_read_b128 v[76:79], v138 offset:3072
    v_mfma_f32_16x16x32_bf16 v[92:95], v[52:55], v[40:43], v[92:95]
    v_mfma_f32_16x16x32_bf16 v[100:103], v[52:55], v[44:47], v[100:103]
    ds_read_b128 v[80:83], v138 offset:5120
    ds_read_b128 v[84:87], v138 offset:7168
    ds_read_b32 v4, v3
    v_mfma_f32_16x16x32_bf16 v[104:107], v[56:59], v[40:43], v[104:107]
    v_mfma_f32_16x16x32_bf16 v[112:115], v[56:59], v[44:47], v[112:115]
    v_mfma_f32_16x16x32_bf16 v[108:111], v[60:63], v[40:43], v[108:111]
    v_mfma_f32_16x16x32_bf16 v[116:119], v[60:63], v[44:47], v[116:119]
    s_add_u32 m0, s27, 32768
    s_add_u32 s24, m0, s23
    s_waitcnt vmcnt(7) lgkmcnt(0)
    v_cmp_gt_u32 vcc, s29, v4
    s_cbranch_vccnz L_parallel_sum__grouped_kv_mqa__mixer_gmlp__prompt_gslow_195
L_parallel_sum__grouped_kv_mqa__mixer_gmlp__prompt_gok_194:
    v_mfma_f32_16x16x32_bf16 v[88:91], v[72:75], v[64:67], v[88:91]
    v_mfma_f32_16x16x32_bf16 v[96:99], v[72:75], v[68:71], v[96:99]
    ds_read_b128 v[40:43], v126 offset:16384
    ds_read_b128 v[44:47], v126 offset:18432
    ds_read_b128 v[48:51], v138 offset:8192
    s_setprio 0
    buffer_load_dwordx4 v124, s[12:15], s24 offen offset:0 sc1 lds
    s_setprio 3
    v_mfma_f32_16x16x32_bf16 v[92:95], v[76:79], v[64:67], v[92:95]
    v_mfma_f32_16x16x32_bf16 v[100:103], v[76:79], v[68:71], v[100:103]
    ds_read_b128 v[52:55], v138 offset:10240
    ds_read_b128 v[56:59], v138 offset:12288
    ds_read_b128 v[60:63], v138 offset:14336
    s_setprio 0
    buffer_load_dwordx4 v125, s[12:15], s24 offen offset:1024 sc1 lds
    s_mov_b32 m0, s31
    s_add_u32 s71, s71, 4
    buffer_load_dword v137, s[40:43], s71 offen lds
    s_add_u32 m0, s26, 0
    s_add_u32 s22, m0, s23
    s_setprio 3
    v_mfma_f32_16x16x32_bf16 v[104:107], v[80:83], v[64:67], v[104:107]
    v_mfma_f32_16x16x32_bf16 v[112:115], v[80:83], v[68:71], v[112:115]
    s_setprio 0
    buffer_load_dwordx4 v120, s[8:11], s22 offen offset:0 sc1 lds
    buffer_load_dwordx4 v121, s[8:11], s22 offen offset:1024 sc1 lds
    s_setprio 3
    v_mfma_f32_16x16x32_bf16 v[108:111], v[84:87], v[64:67], v[108:111]
    v_mfma_f32_16x16x32_bf16 v[116:119], v[84:87], v[68:71], v[116:119]
    s_setprio 0
    buffer_load_dwordx4 v122, s[8:11], s22 offen offset:2048 sc1 lds
    buffer_load_dwordx4 v123, s[8:11], s22 offen offset:3072 sc1 lds
    s_setprio 3
    s_add_u32 s29, s29, 1
    s_waitcnt lgkmcnt(0)
    v_mfma_f32_16x16x32_bf16 v[88:91], v[48:51], v[40:43], v[88:91]
    v_mfma_f32_16x16x32_bf16 v[96:99], v[48:51], v[44:47], v[96:99]
    ds_read_b128 v[64:67], v127 offset:16384
    ds_read_b128 v[68:71], v127 offset:18432
    ds_read_b128 v[72:75], v138 offset:9216
    ds_read_b128 v[76:79], v138 offset:11264
    v_mfma_f32_16x16x32_bf16 v[92:95], v[52:55], v[40:43], v[92:95]
    v_mfma_f32_16x16x32_bf16 v[100:103], v[52:55], v[44:47], v[100:103]
    ds_read_b128 v[80:83], v138 offset:13312
    ds_read_b128 v[84:87], v138 offset:15360
    ds_read_b32 v4, v3
    v_mfma_f32_16x16x32_bf16 v[104:107], v[56:59], v[40:43], v[104:107]
    v_mfma_f32_16x16x32_bf16 v[112:115], v[56:59], v[44:47], v[112:115]
    v_mfma_f32_16x16x32_bf16 v[108:111], v[60:63], v[40:43], v[108:111]
    v_mfma_f32_16x16x32_bf16 v[116:119], v[60:63], v[44:47], v[116:119]
    s_add_u32 m0, s27, 40960
    s_add_u32 s24, m0, s23
    s_waitcnt vmcnt(7) lgkmcnt(0)
    v_cmp_gt_u32 vcc, s29, v4
    s_cbranch_vccnz L_parallel_sum__grouped_kv_mqa__mixer_gmlp__prompt_gslow_197
L_parallel_sum__grouped_kv_mqa__mixer_gmlp__prompt_gok_196:
    v_mfma_f32_16x16x32_bf16 v[88:91], v[72:75], v[64:67], v[88:91]
    v_mfma_f32_16x16x32_bf16 v[96:99], v[72:75], v[68:71], v[96:99]
    s_setprio 0
    buffer_load_dwordx4 v124, s[12:15], s24 offen offset:0 sc1 lds
    s_setprio 3
    v_mfma_f32_16x16x32_bf16 v[92:95], v[76:79], v[64:67], v[92:95]
    v_mfma_f32_16x16x32_bf16 v[100:103], v[76:79], v[68:71], v[100:103]
    s_setprio 0
    buffer_load_dwordx4 v125, s[12:15], s24 offen offset:1024 sc1 lds
    s_mov_b32 m0, s31
    s_add_u32 s71, s71, 4
    buffer_load_dword v137, s[40:43], s71 offen lds
    s_add_u32 m0, s26, 16384
    s_add_u32 s22, m0, s23
    s_setprio 3
    v_mfma_f32_16x16x32_bf16 v[104:107], v[80:83], v[64:67], v[104:107]
    v_mfma_f32_16x16x32_bf16 v[112:115], v[80:83], v[68:71], v[112:115]
    s_setprio 0
    buffer_load_dwordx4 v120, s[8:11], s22 offen offset:0 sc1 lds
    buffer_load_dwordx4 v121, s[8:11], s22 offen offset:1024 sc1 lds
    s_setprio 3
    v_mfma_f32_16x16x32_bf16 v[108:111], v[84:87], v[64:67], v[108:111]
    v_mfma_f32_16x16x32_bf16 v[116:119], v[84:87], v[68:71], v[116:119]
    s_setprio 0
    buffer_load_dwordx4 v122, s[8:11], s22 offen offset:2048 sc1 lds
    buffer_load_dwordx4 v123, s[8:11], s22 offen offset:3072 sc1 lds
    s_setprio 3
    s_add_u32 s29, s29, 1
    s_add_u32 s16, s68, 0x00cf0000
    s_addc_u32 s17, s69, 0
    s_mov_b32 s18, 0x005e0000
    s_mov_b32 s19, 0x00020000
    v_lshlrev_b32 v132, 16, v132
    s_lshl_b32 s32, s6, 2
    s_add_u32 s32, s32, s20
    v_mov_b32 v133, v132
    s_mul_i32 s32, s32, 96256
    s_lshl_b32 s33, s7, 11
    s_add_u32 s32, s32, s33
    v_permlane16_swap_b32 v132, v133
    s_add_u32 s32, s32, 20480
    s_add_u32 s33, s32, 48128
    v_add_f32 v88, v88, v132
    v_add_f32 v89, v89, v132
    v_add_f32 v90, v90, v132
    v_add_f32 v91, v91, v132
    v_add_f32 v92, v92, v132
    v_add_f32 v93, v93, v132
    v_add_f32 v94, v94, v132
    v_add_f32 v95, v95, v132
    v_add_f32 v96, v96, v133
    v_add_f32 v97, v97, v133
    v_add_f32 v98, v98, v133
    v_add_f32 v99, v99, v133
    v_add_f32 v100, v100, v133
    v_add_f32 v101, v101, v133
    v_add_f32 v102, v102, v133
    v_add_f32 v103, v103, v133
    v_mul_f32 v88, v88, v8
    v_mul_f32 v89, v89, v9
    v_mul_f32 v90, v90, v10
    v_mul_f32 v91, v91, v11
    v_mul_f32 v92, v92, v12
    v_mul_f32 v93, v93, v13
    v_mul_f32 v94, v94, v14
    v_mul_f32 v95, v95, v15
    v_mul_f32 v96, v96, v16
    v_mul_f32 v97, v97, v17
    v_mul_f32 v98, v98, v18
    v_mul_f32 v99, v99, v19
    v_mul_f32 v100, v100, v20
    v_mul_f32 v101, v101, v21
    v_mul_f32 v102, v102, v22
    v_mul_f32_e64 v103, v103, v23
    v_cvt_pk_bf16_f32 v64, v88, v89
    v_cvt_pk_bf16_f32 v65, v90, v91
    v_cvt_pk_bf16_f32 v66, v92, v93
    v_cvt_pk_bf16_f32 v67, v94, v95
    v_cvt_pk_bf16_f32 v68, v96, v97
    v_cvt_pk_bf16_f32 v69, v98, v99
    v_cvt_pk_bf16_f32 v70, v100, v101
    v_cvt_pk_bf16_f32 v71, v102, v103
    s_nop 0
    v_permlane32_swap_b32 v64, v66
    v_permlane32_swap_b32 v65, v67
    v_permlane32_swap_b32 v68, v70
    v_permlane32_swap_b32 v69, v71
    v_permlane16_swap_b32 v64, v66
    v_permlane16_swap_b32 v65, v67
    v_permlane16_swap_b32 v68, v70
    v_permlane16_swap_b32 v69, v71
    buffer_store_dwordx4 v[64:67], v124, s[16:19], s32 offen offset:0 sc1
    buffer_store_dwordx4 v[68:71], v124, s[16:19], s33 offen offset:0 sc1
    s_cmp_eq_u32 s7, 13
    s_cbranch_scc1 L_parallel_sum__grouped_kv_mqa__mixer_gmlp__prompt_gfin_198
    v_add_f32 v104, v104, v132
    v_add_f32 v105, v105, v132
    v_add_f32 v106, v106, v132
    v_add_f32 v107, v107, v132
    v_add_f32 v108, v108, v132
    v_add_f32 v109, v109, v132
    v_add_f32 v110, v110, v132
    v_add_f32 v111, v111, v132
    v_add_f32 v112, v112, v133
    v_add_f32 v113, v113, v133
    v_add_f32 v114, v114, v133
    v_add_f32 v115, v115, v133
    v_add_f32 v116, v116, v133
    v_add_f32 v117, v117, v133
    v_add_f32 v118, v118, v133
    v_add_f32 v119, v119, v133
    v_mul_f32 v104, v104, v24
    v_mul_f32 v105, v105, v25
    v_mul_f32 v106, v106, v26
    v_mul_f32 v107, v107, v27
    v_mul_f32 v108, v108, v28
    v_mul_f32 v109, v109, v29
    v_mul_f32 v110, v110, v30
    v_mul_f32 v111, v111, v31
    v_mul_f32 v112, v112, v32
    v_mul_f32 v113, v113, v33
    v_mul_f32 v114, v114, v34
    v_mul_f32 v115, v115, v35
    v_mul_f32 v116, v116, v36
    v_mul_f32 v117, v117, v37
    v_mul_f32 v118, v118, v38
    v_mul_f32_e64 v119, v119, v39
    v_cvt_pk_bf16_f32 v72, v104, v105
    v_cvt_pk_bf16_f32 v73, v106, v107
    v_cvt_pk_bf16_f32 v74, v108, v109
    v_cvt_pk_bf16_f32 v75, v110, v111
    v_cvt_pk_bf16_f32 v76, v112, v113
    v_cvt_pk_bf16_f32 v77, v114, v115
    v_cvt_pk_bf16_f32 v78, v116, v117
    v_cvt_pk_bf16_f32 v79, v118, v119
    s_nop 0
    v_permlane32_swap_b32 v72, v74
    v_permlane32_swap_b32 v73, v75
    v_permlane32_swap_b32 v76, v78
    v_permlane32_swap_b32 v77, v79
    v_permlane16_swap_b32 v72, v74
    v_permlane16_swap_b32 v73, v75
    v_permlane16_swap_b32 v76, v78
    v_permlane16_swap_b32 v77, v79
    buffer_store_dwordx4 v[72:75], v124, s[16:19], s32 offen offset:1024 sc1
    buffer_store_dwordx4 v[76:79], v124, s[16:19], s33 offen offset:1024 sc1
L_parallel_sum__grouped_kv_mqa__mixer_gmlp__prompt_gfin_198:
    s_add_u32 s21, s21, 1
    v_mov_b32_e64 v4, s21
    ds_write_b32 v5, v4
L_parallel_sum__grouped_kv_mqa__mixer_gmlp__prompt_gspin_199:
    ds_read_b32 v4, v6
    s_waitcnt lgkmcnt(0)
    v_cmp_gt_u32 vcc, s21, v4
    s_cbranch_vccz L_parallel_sum__grouped_kv_mqa__mixer_gmlp__prompt_gspun_200
    s_sleep 1
    s_sub_u32 s70, s70, 1
    s_cbranch_scc0 L_parallel_sum__grouped_kv_mqa__mixer_gmlp__prompt_gspin_199
L_parallel_sum__grouped_kv_mqa__mixer_gmlp__prompt_gspun_200:
    s_lshl_b32 s33, s20, 12
    s_add_u32 m0, s33, 112128
    s_add_u32 s24, m0, s23
    buffer_load_dwordx4 v124, s[12:15], s24 offen offset:0 sc1 lds
    buffer_load_dwordx4 v124, s[12:15], s24 offen offset:1024 sc1 lds
    buffer_load_dwordx4 v124, s[12:15], s24 offen offset:2048 sc1 lds
    buffer_load_dwordx4 v124, s[12:15], s24 offen offset:3072 sc1 lds
    s_lshl_b32 s32, s6, 2
    s_add_u32 s32, s32, s20
    s_lshl_b32 s32, s32, 11
    s_lshl_b32 s33, s7, 7
    s_add_u32 s32, s32, s33
    s_add_u32 s32, s32, 262144
    s_waitcnt vmcnt(4)
    v_mov_b32 v146, s96
    v_mov_b32 v147, s97
    v_lshlrev_b32_e64 v144, 3, v1
    s_mov_b64 exec, 0xffff
    buffer_store_dwordx2 v[146:147], v144, s[72:75], s32 offen sc1
    s_mov_b64 exec, -1
    s_branch L_parallel_sum__grouped_kv_mqa__mixer_gmlp__prompt_outp_93
L_parallel_sum__grouped_kv_mqa__mixer_gmlp__prompt_rep_91:
    s_cmp_ge_u32 s20, 2
    s_cbranch_scc1 L_parallel_sum__grouped_kv_mqa__mixer_gmlp__prompt_kw_95
    s_mov_b32 s12, s48
    s_mov_b32 s13, s49
    s_mov_b32 s14, 0x00006400
    s_mov_b32 s15, 0x00020000
    s_branch L_parallel_sum__grouped_kv_mqa__mixer_gmlp__prompt_kwd_96
L_parallel_sum__grouped_kv_mqa__mixer_gmlp__prompt_kw_95:
    s_mov_b32 s12, s50
    s_mov_b32 s13, s51
    s_mov_b32 s14, 0x00006400
    s_mov_b32 s15, 0x00020000
L_parallel_sum__grouped_kv_mqa__mixer_gmlp__prompt_kwd_96:
    v_lshlrev_b32 v106, 4, v1
    v_lshlrev_b32_e64 v107, 4, v1
    s_and_b32 s24, s20, 1
    s_lshl_b32 s24, s24, 9
    s_mov_b32 s25, 2560
    s_lshr_b32 s30, s20, 1
    s_lshl_b32 s30, s30, 12
    s_add_u32 s30, s30, s24
    s_add_u32 s30, s30, 29184
    s_mul_i32 s22, s36, s25
    s_add_u32 m0, s30, 0
    s_add_u32 s22, s22, s24
    buffer_load_dwordx4 v106, s[12:15], s22 offen offset:0 lds
    buffer_load_dwordx4 v107, s[12:15], s22 offen offset:1024 lds
    s_add_u32 s36, s36, 1
    s_cmp_eq_u32 s36, 10
    s_cmov_b32 s36, 0
    s_lshl_b32 s22, s36, 7
    s_add_u32 m0, s29, 20480
    s_add_u32 s22, s23, s22
    buffer_load_dwordx4 v104, s[8:11], s22 offen offset:0 lds
    buffer_load_dwordx4 v105, s[8:11], s22 offen offset:1024 lds
    s_mul_i32 s22, s36, s25
    s_add_u32 m0, s30, 20480
    s_add_u32 s22, s22, s24
    buffer_load_dwordx4 v106, s[12:15], s22 offen offset:0 lds
    buffer_load_dwordx4 v107, s[12:15], s22 offen offset:1024 lds
    s_add_u32 s36, s36, 1
    s_cmp_eq_u32 s36, 10
    s_cmov_b32 s36, 0
    s_lshl_b32 s22, s36, 7
    s_add_u32 m0, s29, 40960
    s_add_u32 s22, s23, s22
    buffer_load_dwordx4 v104, s[8:11], s22 offen offset:0 lds
    buffer_load_dwordx4 v105, s[8:11], s22 offen offset:1024 lds
    s_mul_i32 s22, s36, s25
    s_add_u32 m0, s30, 40960
    s_add_u32 s22, s22, s24
    buffer_load_dwordx4 v106, s[12:15], s22 offen offset:0 lds
    buffer_load_dwordx4 v107, s[12:15], s22 offen offset:1024 lds
    s_add_u32 s36, s36, 1
    s_cmp_eq_u32 s36, 10
    s_cmov_b32 s36, 0
    s_lshl_b32 s22, s36, 7
    s_add_u32 m0, s29, 61440
    s_add_u32 s22, s23, s22
    buffer_load_dwordx4 v104, s[8:11], s22 offen offset:0 lds
    buffer_load_dwordx4 v105, s[8:11], s22 offen offset:1024 lds
    s_mul_i32 s22, s36, s25
    s_add_u32 m0, s30, 61440
    s_add_u32 s22, s22, s24
    buffer_load_dwordx4 v106, s[12:15], s22 offen offset:0 lds
    buffer_load_dwordx4 v107, s[12:15], s22 offen offset:1024 lds
    s_add_u32 s36, s36, 1
    s_cmp_eq_u32 s36, 10
    s_cmov_b32 s36, 0
    s_lshl_b32 s33, s20, 2
    s_add_u32 s34, s33, 163360
    v_mov_b32 v2, s34
    s_add_u32 s34, s33, 163392
    v_mov_b32 v5, s34
    v_and_b32 v3, 3, v1
    v_lshlrev_b32_e64 v3, 2, v3
    v_add_u32 v6, 163392, v3
    v_lshlrev_b32_e64 v3, 6, v3
    v_add_u32 v3, 161280, v3
    v_mov_b32 v137, 0
    s_lshl_b32 s31, s20, 8
    s_lshl_b32 s71, s2, 10
    s_add_u32 s71, s71, s31
    s_add_u32 s31, s31, 161280
    v_and_b32 v134, 31, v1
    v_lshrrev_b32 v135, 5, v1
    s_mov_b32 s28, 0xffff0000
    s_mov_b32 s21, 0
    v_mov_b32 v7, 1
    v_mov_b32 v140, 0x3f803f80
    v_mov_b32 v141, 0x3f803f80
    s_lshl_b32 s33, s6, 7
    s_lshl_b32 s34, s20, 5
    s_add_u32 s33, s33, s34
    v_add_u32 v136, s33, v134
    v_bfe_u32 v145, v1, 1, 3
    v_lshrrev_b32 v146, 4, v1
    v_xor_b32 v145, v145, v146
    v_and_b32 v146, 15, v1
    v_lshlrev_b32 v146, 7, v146
    v_add_u32_e64 v146, s26, v146
    v_lshl_add_u32 v126, v145, 4, v146
    v_xor_b32_e64 v145, 4, v145
    v_lshl_add_u32 v127, v145, 4, v146
    s_add_u32 s40, s68, 0x00600000
    s_addc_u32 s41, s69, 0
    s_mov_b32 s42, 0x00040000
    s_mov_b32 s43, 0x00020000
    v_lshlrev_b32 v145, 2, v1
    buffer_store_dword v1, v145, s[40:43], s71 offen sc1
    s_waitcnt lgkmcnt(0)
    s_add_u32 s96, s96, 1
    v_lshl_add_u32 v110, v1, 4, s29
    v_add_u32 v111, 61440, v110
    v_mov_b32 v64, 0
    v_mov_b32 v65, 0
    v_mov_b32 v66, 0
    v_mov_b32 v67, 0
    v_mov_b32 v68, 0
    v_mov_b32 v69, 0
    v_mov_b32 v70, 0
    v_mov_b32 v71, 0
    v_mov_b32 v72, 0
    v_mov_b32 v73, 0
    v_mov_b32 v74, 0
    v_mov_b32 v75, 0
    v_mov_b32 v76, 0
    v_mov_b32 v77, 0
    v_mov_b32 v78, 0
    v_mov_b32 v79, 0
    s_waitcnt vmcnt(8)
    s_barrier
    ds_read_b128 v[40:43], v110 offset:0
    ds_read_b128 v[44:47], v110 offset:1024
    s_lshl_b32 s22, s36, 7
    s_add_u32 m0, s29, 81920
    s_add_u32 s22, s23, s22
    buffer_load_dwordx4 v104, s[8:11], s22 offen offset:0 lds
    buffer_load_dwordx4 v105, s[8:11], s22 offen offset:1024 lds
    s_mul_i32 s22, s36, s25
    s_add_u32 m0, s30, 81920
    s_add_u32 s22, s22, s24
    buffer_load_dwordx4 v106, s[12:15], s22 offen offset:0 lds
    buffer_load_dwordx4 v107, s[12:15], s22 offen offset:1024 lds
    s_add_u32 s36, s36, 1
    s_cmp_eq_u32 s36, 10
    s_cmov_b32 s36, 0
    s_waitcnt lgkmcnt(0)
    v_mfma_f32_4x4x4_16b_bf16 v[64:67], v[140:141], v[40:41], v[64:67]
    v_mfma_f32_4x4x4_16b_bf16 v[68:71], v[40:41], v[40:41], v[68:71]
    v_mfma_f32_4x4x4_16b_bf16 v[72:75], v[140:141], v[44:45], v[72:75]
    v_mfma_f32_4x4x4_16b_bf16 v[76:79], v[44:45], v[44:45], v[76:79]
    v_mfma_f32_4x4x4_16b_bf16 v[64:67], v[140:141], v[42:43], v[64:67]
    v_mfma_f32_4x4x4_16b_bf16 v[68:71], v[42:43], v[42:43], v[68:71]
    v_mfma_f32_4x4x4_16b_bf16 v[72:75], v[140:141], v[46:47], v[72:75]
    v_mfma_f32_4x4x4_16b_bf16 v[76:79], v[46:47], v[46:47], v[76:79]
    ds_read_b128 v[40:43], v110 offset:20480
    ds_read_b128 v[44:47], v110 offset:21504
    s_lshl_b32 s22, s36, 7
    s_add_u32 m0, s29, 102400
    s_add_u32 s22, s23, s22
    buffer_load_dwordx4 v104, s[8:11], s22 offen offset:0 lds
    buffer_load_dwordx4 v105, s[8:11], s22 offen offset:1024 lds
    s_mul_i32 s22, s36, s25
    s_add_u32 m0, s30, 102400
    s_add_u32 s22, s22, s24
    buffer_load_dwordx4 v106, s[12:15], s22 offen offset:0 lds
    buffer_load_dwordx4 v107, s[12:15], s22 offen offset:1024 lds
    s_add_u32 s36, s36, 1
    s_cmp_eq_u32 s36, 10
    s_cmov_b32 s36, 0
    s_waitcnt lgkmcnt(0)
    v_mfma_f32_4x4x4_16b_bf16 v[64:67], v[140:141], v[40:41], v[64:67]
    v_mfma_f32_4x4x4_16b_bf16 v[68:71], v[40:41], v[40:41], v[68:71]
    v_mfma_f32_4x4x4_16b_bf16 v[72:75], v[140:141], v[44:45], v[72:75]
    v_mfma_f32_4x4x4_16b_bf16 v[76:79], v[44:45], v[44:45], v[76:79]
    v_mfma_f32_4x4x4_16b_bf16 v[64:67], v[140:141], v[42:43], v[64:67]
    v_mfma_f32_4x4x4_16b_bf16 v[68:71], v[42:43], v[42:43], v[68:71]
    v_mfma_f32_4x4x4_16b_bf16 v[72:75], v[140:141], v[46:47], v[72:75]
    v_mfma_f32_4x4x4_16b_bf16 v[76:79], v[46:47], v[46:47], v[76:79]
    s_waitcnt vmcnt(8)
    s_barrier
    ds_read_b128 v[40:43], v110 offset:40960
    ds_read_b128 v[44:47], v110 offset:41984
    s_lshl_b32 s22, s36, 7
    s_add_u32 m0, s29, 0
    s_add_u32 s22, s23, s22
    buffer_load_dwordx4 v104, s[8:11], s22 offen offset:0 lds
    buffer_load_dwordx4 v105, s[8:11], s22 offen offset:1024 lds
    s_mul_i32 s22, s36, s25
    s_add_u32 m0, s30, 0
    s_add_u32 s22, s22, s24
    buffer_load_dwordx4 v106, s[12:15], s22 offen offset:0 lds
    buffer_load_dwordx4 v107, s[12:15], s22 offen offset:1024 lds
    s_add_u32 s36, s36, 1
    s_cmp_eq_u32 s36, 10
    s_cmov_b32 s36, 0
    s_waitcnt lgkmcnt(0)
    v_mfma_f32_4x4x4_16b_bf16 v[64:67], v[140:141], v[40:41], v[64:67]
    v_mfma_f32_4x4x4_16b_bf16 v[68:71], v[40:41], v[40:41], v[68:71]
    v_mfma_f32_4x4x4_16b_bf16 v[72:75], v[140:141], v[44:45], v[72:75]
    v_mfma_f32_4x4x4_16b_bf16 v[76:79], v[44:45], v[44:45], v[76:79]
    v_mfma_f32_4x4x4_16b_bf16 v[64:67], v[140:141], v[42:43], v[64:67]
    v_mfma_f32_4x4x4_16b_bf16 v[68:71], v[42:43], v[42:43], v[68:71]
    v_mfma_f32_4x4x4_16b_bf16 v[72:75], v[140:141], v[46:47], v[72:75]
    v_mfma_f32_4x4x4_16b_bf16 v[76:79], v[46:47], v[46:47], v[76:79]
    ds_read_b128 v[40:43], v111 offset:0
    ds_read_b128 v[44:47], v111 offset:1024
    s_lshl_b32 s22, s36, 7
    s_add_u32 m0, s29, 20480
    s_add_u32 s22, s23, s22
    buffer_load_dwordx4 v104, s[8:11], s22 offen offset:0 lds
    buffer_load_dwordx4 v105, s[8:11], s22 offen offset:1024 lds
    s_mul_i32 s22, s36, s25
    s_add_u32 m0, s30, 20480
    s_add_u32 s22, s22, s24
    buffer_load_dwordx4 v106, s[12:15], s22 offen offset:0 lds
    buffer_load_dwordx4 v107, s[12:15], s22 offen offset:1024 lds
    s_add_u32 s36, s36, 1
    s_cmp_eq_u32 s36, 10
    s_cmov_b32 s36, 0
    s_waitcnt lgkmcnt(0)
    v_mfma_f32_4x4x4_16b_bf16 v[64:67], v[140:141], v[40:41], v[64:67]
    v_mfma_f32_4x4x4_16b_bf16 v[68:71], v[40:41], v[40:41], v[68:71]
    v_mfma_f32_4x4x4_16b_bf16 v[72:75], v[140:141], v[44:45], v[72:75]
    v_mfma_f32_4x4x4_16b_bf16 v[76:79], v[44:45], v[44:45], v[76:79]
    v_mfma_f32_4x4x4_16b_bf16 v[64:67], v[140:141], v[42:43], v[64:67]
    v_mfma_f32_4x4x4_16b_bf16 v[68:71], v[42:43], v[42:43], v[68:71]
    v_mfma_f32_4x4x4_16b_bf16 v[72:75], v[140:141], v[46:47], v[72:75]
    v_mfma_f32_4x4x4_16b_bf16 v[76:79], v[46:47], v[46:47], v[76:79]
    s_waitcnt vmcnt(8)
    s_barrier
    ds_read_b128 v[40:43], v111 offset:20480
    ds_read_b128 v[44:47], v111 offset:21504
    s_lshl_b32 s22, s36, 7
    s_add_u32 m0, s29, 40960
    s_add_u32 s22, s23, s22
    buffer_load_dwordx4 v104, s[8:11], s22 offen offset:0 lds
    buffer_load_dwordx4 v105, s[8:11], s22 offen offset:1024 lds
    s_mul_i32 s22, s36, s25
    s_add_u32 m0, s30, 40960
    s_add_u32 s22, s22, s24
    buffer_load_dwordx4 v106, s[12:15], s22 offen offset:0 lds
    buffer_load_dwordx4 v107, s[12:15], s22 offen offset:1024 lds
    s_add_u32 s36, s36, 1
    s_cmp_eq_u32 s36, 10
    s_cmov_b32 s36, 0
    s_waitcnt lgkmcnt(0)
    v_mfma_f32_4x4x4_16b_bf16 v[64:67], v[140:141], v[40:41], v[64:67]
    v_mfma_f32_4x4x4_16b_bf16 v[68:71], v[40:41], v[40:41], v[68:71]
    v_mfma_f32_4x4x4_16b_bf16 v[72:75], v[140:141], v[44:45], v[72:75]
    v_mfma_f32_4x4x4_16b_bf16 v[76:79], v[44:45], v[44:45], v[76:79]
    v_mfma_f32_4x4x4_16b_bf16 v[64:67], v[140:141], v[42:43], v[64:67]
    v_mfma_f32_4x4x4_16b_bf16 v[68:71], v[42:43], v[42:43], v[68:71]
    v_mfma_f32_4x4x4_16b_bf16 v[72:75], v[140:141], v[46:47], v[72:75]
    v_mfma_f32_4x4x4_16b_bf16 v[76:79], v[46:47], v[46:47], v[76:79]
    ds_read_b128 v[40:43], v111 offset:40960
    ds_read_b128 v[44:47], v111 offset:41984
    s_lshl_b32 s22, s36, 7
    s_add_u32 m0, s29, 61440
    s_add_u32 s22, s23, s22
    buffer_load_dwordx4 v104, s[8:11], s22 offen offset:0 lds
    buffer_load_dwordx4 v105, s[8:11], s22 offen offset:1024 lds
    s_mul_i32 s22, s36, s25
    s_add_u32 m0, s30, 61440
    s_add_u32 s22, s22, s24
    buffer_load_dwordx4 v106, s[12:15], s22 offen offset:0 lds
    buffer_load_dwordx4 v107, s[12:15], s22 offen offset:1024 lds
    s_add_u32 s36, s36, 1
    s_cmp_eq_u32 s36, 10
    s_cmov_b32 s36, 0
    s_waitcnt lgkmcnt(0)
    v_mfma_f32_4x4x4_16b_bf16 v[64:67], v[140:141], v[40:41], v[64:67]
    v_mfma_f32_4x4x4_16b_bf16 v[68:71], v[40:41], v[40:41], v[68:71]
    v_mfma_f32_4x4x4_16b_bf16 v[72:75], v[140:141], v[44:45], v[72:75]
    v_mfma_f32_4x4x4_16b_bf16 v[76:79], v[44:45], v[44:45], v[76:79]
    v_mfma_f32_4x4x4_16b_bf16 v[64:67], v[140:141], v[42:43], v[64:67]
    v_mfma_f32_4x4x4_16b_bf16 v[68:71], v[42:43], v[42:43], v[68:71]
    v_mfma_f32_4x4x4_16b_bf16 v[72:75], v[140:141], v[46:47], v[72:75]
    v_mfma_f32_4x4x4_16b_bf16 v[76:79], v[46:47], v[46:47], v[76:79]
    s_waitcnt vmcnt(8)
    s_barrier
    ds_read_b128 v[40:43], v110 offset:0
    ds_read_b128 v[44:47], v110 offset:1024
    s_waitcnt lgkmcnt(0)
    v_mfma_f32_4x4x4_16b_bf16 v[64:67], v[140:141], v[40:41], v[64:67]
    v_mfma_f32_4x4x4_16b_bf16 v[68:71], v[40:41], v[40:41], v[68:71]
    v_mfma_f32_4x4x4_16b_bf16 v[72:75], v[140:141], v[44:45], v[72:75]
    v_mfma_f32_4x4x4_16b_bf16 v[76:79], v[44:45], v[44:45], v[76:79]
    v_mfma_f32_4x4x4_16b_bf16 v[64:67], v[140:141], v[42:43], v[64:67]
    v_mfma_f32_4x4x4_16b_bf16 v[68:71], v[42:43], v[42:43], v[68:71]
    v_mfma_f32_4x4x4_16b_bf16 v[72:75], v[140:141], v[46:47], v[72:75]
    v_mfma_f32_4x4x4_16b_bf16 v[76:79], v[46:47], v[46:47], v[76:79]
    ds_read_b128 v[40:43], v110 offset:20480
    ds_read_b128 v[44:47], v110 offset:21504
    s_waitcnt lgkmcnt(0)
    v_mfma_f32_4x4x4_16b_bf16 v[64:67], v[140:141], v[40:41], v[64:67]
    v_mfma_f32_4x4x4_16b_bf16 v[68:71], v[40:41], v[40:41], v[68:71]
    v_mfma_f32_4x4x4_16b_bf16 v[72:75], v[140:141], v[44:45], v[72:75]
    v_mfma_f32_4x4x4_16b_bf16 v[76:79], v[44:45], v[44:45], v[76:79]
    v_mfma_f32_4x4x4_16b_bf16 v[64:67], v[140:141], v[42:43], v[64:67]
    v_mfma_f32_4x4x4_16b_bf16 v[68:71], v[42:43], v[42:43], v[68:71]
    v_mfma_f32_4x4x4_16b_bf16 v[72:75], v[140:141], v[46:47], v[72:75]
    v_mfma_f32_4x4x4_16b_bf16 v[76:79], v[46:47], v[46:47], v[76:79]
    s_waitcnt vmcnt(0)
    s_barrier
    ds_read_b128 v[40:43], v110 offset:40960
    ds_read_b128 v[44:47], v110 offset:41984
    s_waitcnt lgkmcnt(0)
    v_mfma_f32_4x4x4_16b_bf16 v[64:67], v[140:141], v[40:41], v[64:67]
    v_mfma_f32_4x4x4_16b_bf16 v[68:71], v[40:41], v[40:41], v[68:71]
    v_mfma_f32_4x4x4_16b_bf16 v[72:75], v[140:141], v[44:45], v[72:75]
    v_mfma_f32_4x4x4_16b_bf16 v[76:79], v[44:45], v[44:45], v[76:79]
    v_mfma_f32_4x4x4_16b_bf16 v[64:67], v[140:141], v[42:43], v[64:67]
    v_mfma_f32_4x4x4_16b_bf16 v[68:71], v[42:43], v[42:43], v[68:71]
    v_mfma_f32_4x4x4_16b_bf16 v[72:75], v[140:141], v[46:47], v[72:75]
    v_mfma_f32_4x4x4_16b_bf16 v[76:79], v[46:47], v[46:47], v[76:79]
    ds_read_b128 v[40:43], v111 offset:0
    ds_read_b128 v[44:47], v111 offset:1024
    s_waitcnt lgkmcnt(0)
    v_mfma_f32_4x4x4_16b_bf16 v[64:67], v[140:141], v[40:41], v[64:67]
    v_mfma_f32_4x4x4_16b_bf16 v[68:71], v[40:41], v[40:41], v[68:71]
    v_mfma_f32_4x4x4_16b_bf16 v[72:75], v[140:141], v[44:45], v[72:75]
    v_mfma_f32_4x4x4_16b_bf16 v[76:79], v[44:45], v[44:45], v[76:79]
    v_mfma_f32_4x4x4_16b_bf16 v[64:67], v[140:141], v[42:43], v[64:67]
    v_mfma_f32_4x4x4_16b_bf16 v[68:71], v[42:43], v[42:43], v[68:71]
    v_mfma_f32_4x4x4_16b_bf16 v[72:75], v[140:141], v[46:47], v[72:75]
    v_mfma_f32_4x4x4_16b_bf16 v[76:79], v[46:47], v[46:47], v[76:79]
    v_and_b32 v80, 3, v1
    s_nop 2
    v_cmp_eq_u32 vcc, 1, v80
    s_nop 1
    v_cndmask_b32 v68, v68, v69, vcc
    v_cndmask_b32 v76, v76, v77, vcc
    v_cmp_eq_u32 vcc, 2, v80
    s_nop 1
    v_cndmask_b32 v68, v68, v70, vcc
    v_cndmask_b32 v76, v76, v78, vcc
    v_cmp_eq_u32 vcc, 3, v80
    s_nop 1
    v_cndmask_b32 v68, v68, v71, vcc
    v_cndmask_b32 v76, v76, v79, vcc
    v_add_f32_dpp v64, v64, v64 quad_perm:[1,0,3,2] row_mask:0xf bank_mask:0xf
    v_add_f32_dpp v72, v72, v72 quad_perm:[1,0,3,2] row_mask:0xf bank_mask:0xf
    v_add_f32_dpp v68, v68, v68 quad_perm:[1,0,3,2] row_mask:0xf bank_mask:0xf
    v_add_f32_dpp v76, v76, v76 quad_perm:[1,0,3,2] row_mask:0xf bank_mask:0xf
    v_add_f32_dpp v64, v64, v64 quad_perm:[2,3,0,1] row_mask:0xf bank_mask:0xf
    v_add_f32_dpp v72, v72, v72 quad_perm:[2,3,0,1] row_mask:0xf bank_mask:0xf
    v_add_f32_dpp v68, v68, v68 quad_perm:[2,3,0,1] row_mask:0xf bank_mask:0xf
    v_add_f32_dpp v76, v76, v76 quad_perm:[2,3,0,1] row_mask:0xf bank_mask:0xf
    v_add_f32_dpp v64, v64, v64 row_half_mirror row_mask:0xf bank_mask:0xf
    v_add_f32_dpp v72, v72, v72 row_half_mirror row_mask:0xf bank_mask:0xf
    v_add_f32_dpp v68, v68, v68 row_half_mirror row_mask:0xf bank_mask:0xf
    v_add_f32_dpp v76, v76, v76 row_half_mirror row_mask:0xf bank_mask:0xf
    v_mul_f32 v64, 0x3acccccd, v64
    v_mul_f32 v72, 0x3acccccd, v72
    v_mul_f32 v68, 0x3acccccd, v68
    v_mul_f32 v76, 0x3acccccd, v76
    v_fma_f32 v68, -v64, v64, v68
    v_max_f32_e64 v68, 0, v68
    v_add_f32 v68, 0x3727c5ac, v68
    v_rsq_f32_e64 v68, v68
    v_fma_f32 v76, -v72, v72, v76
    v_max_f32_e64 v76, 0, v76
    v_add_f32 v76, 0x3727c5ac, v76
    v_rsq_f32 v76, v76
    s_lshl_b32 s32, s20, 6
    s_add_u32 s32, s32, 54272
    v_lshrrev_b32_e64 v80, 3, v1
    v_lshl_add_u32 v80, v80, 2, s32
    ds_write_b32 v80, v64
    ds_write_b32 v80, v68 offset:256
    ds_write_b32 v80, v72 offset:32
    ds_write_b32 v80, v76 offset:288
    s_waitcnt lgkmcnt(0)
    v_add_u32 v144, 0, v1
    v_mul_u32_u24 v145, 5462, v144
    v_lshrrev_b32 v145, 16, v145
    v_mul_u32_u24 v146, 12, v145
    v_sub_u32_e64 v146, v144, v146
    v_mul_u32_u24 v145, 1280, v145
    v_lshl_add_u32 v106, v146, 4, v145
    v_add_u32_e64 v144, 64, v1
    v_mul_u32_u24 v145, 5462, v144
    v_lshrrev_b32 v145, 16, v145
    v_mul_u32_u24 v146, 12, v145
    v_sub_u32_e64 v146, v144, v146
    v_mul_u32_u24 v145, 1280, v145
    v_lshl_add_u32 v107, v146, 4, v145
    v_subrev_u32 v107, 1024, v107
    v_add_u32 v144, 128, v1
    v_mul_u32_u24 v145, 5462, v144
    v_lshrrev_b32 v145, 16, v145
    v_mul_u32_u24 v146, 12, v145
    v_sub_u32_e64 v146, v144, v146
    v_mul_u32_u24 v145, 1280, v145
    v_lshl_add_u32 v108, v146, 4, v145
    v_subrev_u32 v108, 2048, v108
    s_mov_b32 s12, s46
    s_mov_b32 s13, s47
    s_mov_b32 s14, 0x000c8000
    s_mov_b32 s15, 0x00020000
    s_mul_i32 s24, s20, 20480
    s_mul_i32 s32, s99, 160
    s_and_b32 s32, s32, 0xffffffc0
    s_add_u32 s24, s24, s32
    s_mov_b32 s25, 81920
    s_mul_i32 s30, s20, 3072
    s_add_u32 s30, s30, 29184
    s_barrier
    s_barrier
    s_barrier
    s_lshl_b32 s22, s36, 7
    s_add_u32 m0, s29, 0
    s_add_u32 s22, s23, s22
    buffer_load_dwordx4 v104, s[8:11], s22 offen offset:0 lds
    buffer_load_dwordx4 v105, s[8:11], s22 offen offset:1024 lds
    s_mul_i32 s22, s36, s25
    s_add_u32 m0, s30, 0
    s_add_u32 s22, s22, s24
    buffer_load_dwordx4 v106, s[12:15], s22 offen offset:0 lds
    buffer_load_dwordx4 v107, s[12:15], s22 offen offset:1024 lds
    buffer_load_dwordx4 v108, s[12:15], s22 offen offset:2048 lds
    s_add_u32 s36, s36, 1
    s_cmp_eq_u32 s36, 10
    s_cmov_b32 s36, 0
    s_lshl_b32 s22, s36, 7
    s_add_u32 m0, s29, 20480
    s_add_u32 s22, s23, s22
    buffer_load_dwordx4 v104, s[8:11], s22 offen offset:0 lds
    buffer_load_dwordx4 v105, s[8:11], s22 offen offset:1024 lds
    s_mul_i32 s22, s36, s25
    s_add_u32 m0, s30, 20480
    s_add_u32 s22, s22, s24
    buffer_load_dwordx4 v106, s[12:15], s22 offen offset:0 lds
    buffer_load_dwordx4 v107, s[12:15], s22 offen offset:1024 lds
    buffer_load_dwordx4 v108, s[12:15], s22 offen offset:2048 lds
    s_add_u32 s36, s36, 1
    s_cmp_eq_u32 s36, 10
    s_cmov_b32 s36, 0
    s_lshl_b32 s22, s36, 7
    s_add_u32 m0, s29, 40960
    s_add_u32 s22, s23, s22
    buffer_load_dwordx4 v104, s[8:11], s22 offen offset:0 lds
    buffer_load_dwordx4 v105, s[8:11], s22 offen offset:1024 lds
    s_mul_i32 s22, s36, s25
    s_add_u32 m0, s30, 40960
    s_add_u32 s22, s22, s24
    buffer_load_dwordx4 v106, s[12:15], s22 offen offset:0 lds
    buffer_load_dwordx4 v107, s[12:15], s22 offen offset:1024 lds
    buffer_load_dwordx4 v108, s[12:15], s22 offen offset:2048 lds
    s_add_u32 s36, s36, 1
    s_cmp_eq_u32 s36, 10
    s_cmov_b32 s36, 0
    s_lshl_b32 s22, s36, 7
    s_add_u32 m0, s29, 61440
    s_add_u32 s22, s23, s22
    buffer_load_dwordx4 v104, s[8:11], s22 offen offset:0 lds
    buffer_load_dwordx4 v105, s[8:11], s22 offen offset:1024 lds
    s_mul_i32 s22, s36, s25
    s_add_u32 m0, s30, 61440
    s_add_u32 s22, s22, s24
    buffer_load_dwordx4 v106, s[12:15], s22 offen offset:0 lds
    buffer_load_dwordx4 v107, s[12:15], s22 offen offset:1024 lds
    buffer_load_dwordx4 v108, s[12:15], s22 offen offset:2048 lds
    s_add_u32 s36, s36, 1
    s_cmp_eq_u32 s36, 10
    s_cmov_b32 s36, 0
    v_lshl_add_u32 v110, v1, 4, s29
    v_add_u32 v111, 61440, v110
    v_mov_b32 v64, 0
    v_mov_b32 v65, 0
    v_mov_b32 v66, 0
    v_mov_b32 v67, 0
    v_mov_b32 v68, 0
    v_mov_b32 v69, 0
    v_mov_b32 v70, 0
    v_mov_b32 v71, 0
    v_mov_b32 v72, 0
    v_mov_b32 v73, 0
    v_mov_b32 v74, 0
    v_mov_b32 v75, 0
    v_mov_b32 v76, 0
    v_mov_b32 v77, 0
    v_mov_b32 v78, 0
    v_mov_b32 v79, 0
    s_waitcnt vmcnt(10)
    s_barrier
    ds_read_b128 v[40:43], v110 offset:0
    ds_read_b128 v[44:47], v110 offset:1024
    s_lshl_b32 s22, s36, 7
    s_add_u32 m0, s29, 81920
    s_add_u32 s22, s23, s22
    buffer_load_dwordx4 v104, s[8:11], s22 offen offset:0 lds
    buffer_load_dwordx4 v105, s[8:11], s22 offen offset:1024 lds
    s_mul_i32 s22, s36, s25
    s_add_u32 m0, s30, 81920
    s_add_u32 s22, s22, s24
    buffer_load_dwordx4 v106, s[12:15], s22 offen offset:0 lds
    buffer_load_dwordx4 v107, s[12:15], s22 offen offset:1024 lds
    buffer_load_dwordx4 v108, s[12:15], s22 offen offset:2048 lds
    s_add_u32 s36, s36, 1
    s_cmp_eq_u32 s36, 10
    s_cmov_b32 s36, 0
    s_waitcnt lgkmcnt(0)
    v_mfma_f32_4x4x4_16b_bf16 v[64:67], v[140:141], v[40:41], v[64:67]
    v_mfma_f32_4x4x4_16b_bf16 v[68:71], v[40:41], v[40:41], v[68:71]
    v_mfma_f32_4x4x4_16b_bf16 v[72:75], v[140:141], v[44:45], v[72:75]
    v_mfma_f32_4x4x4_16b_bf16 v[76:79], v[44:45], v[44:45], v[76:79]
    v_mfma_f32_4x4x4_16b_bf16 v[64:67], v[140:141], v[42:43], v[64:67]
    v_mfma_f32_4x4x4_16b_bf16 v[68:71], v[42:43], v[42:43], v[68:71]
    v_mfma_f32_4x4x4_16b_bf16 v[72:75], v[140:141], v[46:47], v[72:75]
    v_mfma_f32_4x4x4_16b_bf16 v[76:79], v[46:47], v[46:47], v[76:79]
    ds_read_b128 v[40:43], v110 offset:20480
    ds_read_b128 v[44:47], v110 offset:21504
    s_lshl_b32 s22, s36, 7
    s_add_u32 m0, s29, 102400
    s_add_u32 s22, s23, s22
    buffer_load_dwordx4 v104, s[8:11], s22 offen offset:0 lds
    buffer_load_dwordx4 v105, s[8:11], s22 offen offset:1024 lds
    s_mul_i32 s22, s36, s25
    s_add_u32 m0, s30, 102400
    s_add_u32 s22, s22, s24
    buffer_load_dwordx4 v106, s[12:15], s22 offen offset:0 lds
    buffer_load_dwordx4 v107, s[12:15], s22 offen offset:1024 lds
    buffer_load_dwordx4 v108, s[12:15], s22 offen offset:2048 lds
    s_add_u32 s36, s36, 1
    s_cmp_eq_u32 s36, 10
    s_cmov_b32 s36, 0
    s_waitcnt lgkmcnt(0)
    v_mfma_f32_4x4x4_16b_bf16 v[64:67], v[140:141], v[40:41], v[64:67]
    v_mfma_f32_4x4x4_16b_bf16 v[68:71], v[40:41], v[40:41], v[68:71]
    v_mfma_f32_4x4x4_16b_bf16 v[72:75], v[140:141], v[44:45], v[72:75]
    v_mfma_f32_4x4x4_16b_bf16 v[76:79], v[44:45], v[44:45], v[76:79]
    v_mfma_f32_4x4x4_16b_bf16 v[64:67], v[140:141], v[42:43], v[64:67]
    v_mfma_f32_4x4x4_16b_bf16 v[68:71], v[42:43], v[42:43], v[68:71]
    v_mfma_f32_4x4x4_16b_bf16 v[72:75], v[140:141], v[46:47], v[72:75]
    v_mfma_f32_4x4x4_16b_bf16 v[76:79], v[46:47], v[46:47], v[76:79]
    s_waitcnt vmcnt(10)
    s_barrier
    ds_read_b128 v[40:43], v110 offset:40960
    ds_read_b128 v[44:47], v110 offset:41984
    s_lshl_b32 s22, s36, 7
    s_add_u32 m0, s29, 0
    s_add_u32 s22, s23, s22
    buffer_load_dwordx4 v104, s[8:11], s22 offen offset:0 lds
    buffer_load_dwordx4 v105, s[8:11], s22 offen offset:1024 lds
    s_mul_i32 s22, s36, s25
    s_add_u32 m0, s30, 0
    s_add_u32 s22, s22, s24
    buffer_load_dwordx4 v106, s[12:15], s22 offen offset:0 lds
    buffer_load_dwordx4 v107, s[12:15], s22 offen offset:1024 lds
    buffer_load_dwordx4 v108, s[12:15], s22 offen offset:2048 lds
    s_add_u32 s36, s36, 1
    s_cmp_eq_u32 s36, 10
    s_cmov_b32 s36, 0
    s_waitcnt lgkmcnt(0)
    v_mfma_f32_4x4x4_16b_bf16 v[64:67], v[140:141], v[40:41], v[64:67]
    v_mfma_f32_4x4x4_16b_bf16 v[68:71], v[40:41], v[40:41], v[68:71]
    v_mfma_f32_4x4x4_16b_bf16 v[72:75], v[140:141], v[44:45], v[72:75]
    v_mfma_f32_4x4x4_16b_bf16 v[76:79], v[44:45], v[44:45], v[76:79]
    v_mfma_f32_4x4x4_16b_bf16 v[64:67], v[140:141], v[42:43], v[64:67]
    v_mfma_f32_4x4x4_16b_bf16 v[68:71], v[42:43], v[42:43], v[68:71]
    v_mfma_f32_4x4x4_16b_bf16 v[72:75], v[140:141], v[46:47], v[72:75]
    v_mfma_f32_4x4x4_16b_bf16 v[76:79], v[46:47], v[46:47], v[76:79]
    ds_read_b128 v[40:43], v111 offset:0
    ds_read_b128 v[44:47], v111 offset:1024
    s_lshl_b32 s22, s36, 7
    s_add_u32 m0, s29, 20480
    s_add_u32 s22, s23, s22
    buffer_load_dwordx4 v104, s[8:11], s22 offen offset:0 lds
    buffer_load_dwordx4 v105, s[8:11], s22 offen offset:1024 lds
    s_mul_i32 s22, s36, s25
    s_add_u32 m0, s30, 20480
    s_add_u32 s22, s22, s24
    buffer_load_dwordx4 v106, s[12:15], s22 offen offset:0 lds
    buffer_load_dwordx4 v107, s[12:15], s22 offen offset:1024 lds
    buffer_load_dwordx4 v108, s[12:15], s22 offen offset:2048 lds
    s_add_u32 s36, s36, 1
    s_cmp_eq_u32 s36, 10
    s_cmov_b32 s36, 0
    s_waitcnt lgkmcnt(0)
    v_mfma_f32_4x4x4_16b_bf16 v[64:67], v[140:141], v[40:41], v[64:67]
    v_mfma_f32_4x4x4_16b_bf16 v[68:71], v[40:41], v[40:41], v[68:71]
    v_mfma_f32_4x4x4_16b_bf16 v[72:75], v[140:141], v[44:45], v[72:75]
    v_mfma_f32_4x4x4_16b_bf16 v[76:79], v[44:45], v[44:45], v[76:79]
    v_mfma_f32_4x4x4_16b_bf16 v[64:67], v[140:141], v[42:43], v[64:67]
    v_mfma_f32_4x4x4_16b_bf16 v[68:71], v[42:43], v[42:43], v[68:71]
    v_mfma_f32_4x4x4_16b_bf16 v[72:75], v[140:141], v[46:47], v[72:75]
    v_mfma_f32_4x4x4_16b_bf16 v[76:79], v[46:47], v[46:47], v[76:79]
    s_waitcnt vmcnt(10)
    s_barrier
    ds_read_b128 v[40:43], v111 offset:20480
    ds_read_b128 v[44:47], v111 offset:21504
    s_lshl_b32 s22, s36, 7
    s_add_u32 m0, s29, 40960
    s_add_u32 s22, s23, s22
    buffer_load_dwordx4 v104, s[8:11], s22 offen offset:0 lds
    buffer_load_dwordx4 v105, s[8:11], s22 offen offset:1024 lds
    s_mul_i32 s22, s36, s25
    s_add_u32 m0, s30, 40960
    s_add_u32 s22, s22, s24
    buffer_load_dwordx4 v106, s[12:15], s22 offen offset:0 lds
    buffer_load_dwordx4 v107, s[12:15], s22 offen offset:1024 lds
    buffer_load_dwordx4 v108, s[12:15], s22 offen offset:2048 lds
    s_add_u32 s36, s36, 1
    s_cmp_eq_u32 s36, 10
    s_cmov_b32 s36, 0
    s_waitcnt lgkmcnt(0)
    v_mfma_f32_4x4x4_16b_bf16 v[64:67], v[140:141], v[40:41], v[64:67]
    v_mfma_f32_4x4x4_16b_bf16 v[68:71], v[40:41], v[40:41], v[68:71]
    v_mfma_f32_4x4x4_16b_bf16 v[72:75], v[140:141], v[44:45], v[72:75]
    v_mfma_f32_4x4x4_16b_bf16 v[76:79], v[44:45], v[44:45], v[76:79]
    v_mfma_f32_4x4x4_16b_bf16 v[64:67], v[140:141], v[42:43], v[64:67]
    v_mfma_f32_4x4x4_16b_bf16 v[68:71], v[42:43], v[42:43], v[68:71]
    v_mfma_f32_4x4x4_16b_bf16 v[72:75], v[140:141], v[46:47], v[72:75]
    v_mfma_f32_4x4x4_16b_bf16 v[76:79], v[46:47], v[46:47], v[76:79]
    ds_read_b128 v[40:43], v111 offset:40960
    ds_read_b128 v[44:47], v111 offset:41984
    s_lshl_b32 s22, s36, 7
    s_add_u32 m0, s29, 61440
    s_add_u32 s22, s23, s22
    buffer_load_dwordx4 v104, s[8:11], s22 offen offset:0 lds
    buffer_load_dwordx4 v105, s[8:11], s22 offen offset:1024 lds
    s_mul_i32 s22, s36, s25
    s_add_u32 m0, s30, 61440
    s_add_u32 s22, s22, s24
    buffer_load_dwordx4 v106, s[12:15], s22 offen offset:0 lds
    buffer_load_dwordx4 v107, s[12:15], s22 offen offset:1024 lds
    buffer_load_dwordx4 v108, s[12:15], s22 offen offset:2048 lds
    s_add_u32 s36, s36, 1
    s_cmp_eq_u32 s36, 10
    s_cmov_b32 s36, 0
    s_waitcnt lgkmcnt(0)
    v_mfma_f32_4x4x4_16b_bf16 v[64:67], v[140:141], v[40:41], v[64:67]
    v_mfma_f32_4x4x4_16b_bf16 v[68:71], v[40:41], v[40:41], v[68:71]
    v_mfma_f32_4x4x4_16b_bf16 v[72:75], v[140:141], v[44:45], v[72:75]
    v_mfma_f32_4x4x4_16b_bf16 v[76:79], v[44:45], v[44:45], v[76:79]
    v_mfma_f32_4x4x4_16b_bf16 v[64:67], v[140:141], v[42:43], v[64:67]
    v_mfma_f32_4x4x4_16b_bf16 v[68:71], v[42:43], v[42:43], v[68:71]
    v_mfma_f32_4x4x4_16b_bf16 v[72:75], v[140:141], v[46:47], v[72:75]
    v_mfma_f32_4x4x4_16b_bf16 v[76:79], v[46:47], v[46:47], v[76:79]
    s_waitcnt vmcnt(10)
    s_barrier
    ds_read_b128 v[40:43], v110 offset:0
    ds_read_b128 v[44:47], v110 offset:1024
    s_waitcnt lgkmcnt(0)
    v_mfma_f32_4x4x4_16b_bf16 v[64:67], v[140:141], v[40:41], v[64:67]
    v_mfma_f32_4x4x4_16b_bf16 v[68:71], v[40:41], v[40:41], v[68:71]
    v_mfma_f32_4x4x4_16b_bf16 v[72:75], v[140:141], v[44:45], v[72:75]
    v_mfma_f32_4x4x4_16b_bf16 v[76:79], v[44:45], v[44:45], v[76:79]
    v_mfma_f32_4x4x4_16b_bf16 v[64:67], v[140:141], v[42:43], v[64:67]
    v_mfma_f32_4x4x4_16b_bf16 v[68:71], v[42:43], v[42:43], v[68:71]
    v_mfma_f32_4x4x4_16b_bf16 v[72:75], v[140:141], v[46:47], v[72:75]
    v_mfma_f32_4x4x4_16b_bf16 v[76:79], v[46:47], v[46:47], v[76:79]
    ds_read_b128 v[40:43], v110 offset:20480
    ds_read_b128 v[44:47], v110 offset:21504
    s_waitcnt lgkmcnt(0)
    v_mfma_f32_4x4x4_16b_bf16 v[64:67], v[140:141], v[40:41], v[64:67]
    v_mfma_f32_4x4x4_16b_bf16 v[68:71], v[40:41], v[40:41], v[68:71]
    v_mfma_f32_4x4x4_16b_bf16 v[72:75], v[140:141], v[44:45], v[72:75]
    v_mfma_f32_4x4x4_16b_bf16 v[76:79], v[44:45], v[44:45], v[76:79]
    v_mfma_f32_4x4x4_16b_bf16 v[64:67], v[140:141], v[42:43], v[64:67]
    v_mfma_f32_4x4x4_16b_bf16 v[68:71], v[42:43], v[42:43], v[68:71]
    v_mfma_f32_4x4x4_16b_bf16 v[72:75], v[140:141], v[46:47], v[72:75]
    v_mfma_f32_4x4x4_16b_bf16 v[76:79], v[46:47], v[46:47], v[76:79]
    s_waitcnt vmcnt(0)
    s_barrier
    ds_read_b128 v[40:43], v110 offset:40960
    ds_read_b128 v[44:47], v110 offset:41984
    s_waitcnt lgkmcnt(0)
    v_mfma_f32_4x4x4_16b_bf16 v[64:67], v[140:141], v[40:41], v[64:67]
    v_mfma_f32_4x4x4_16b_bf16 v[68:71], v[40:41], v[40:41], v[68:71]
    v_mfma_f32_4x4x4_16b_bf16 v[72:75], v[140:141], v[44:45], v[72:75]
    v_mfma_f32_4x4x4_16b_bf16 v[76:79], v[44:45], v[44:45], v[76:79]
    v_mfma_f32_4x4x4_16b_bf16 v[64:67], v[140:141], v[42:43], v[64:67]
    v_mfma_f32_4x4x4_16b_bf16 v[68:71], v[42:43], v[42:43], v[68:71]
    v_mfma_f32_4x4x4_16b_bf16 v[72:75], v[140:141], v[46:47], v[72:75]
    v_mfma_f32_4x4x4_16b_bf16 v[76:79], v[46:47], v[46:47], v[76:79]
    ds_read_b128 v[40:43], v111 offset:0
    ds_read_b128 v[44:47], v111 offset:1024
    s_waitcnt lgkmcnt(0)
    v_mfma_f32_4x4x4_16b_bf16 v[64:67], v[140:141], v[40:41], v[64:67]
    v_mfma_f32_4x4x4_16b_bf16 v[68:71], v[40:41], v[40:41], v[68:71]
    v_mfma_f32_4x4x4_16b_bf16 v[72:75], v[140:141], v[44:45], v[72:75]
    v_mfma_f32_4x4x4_16b_bf16 v[76:79], v[44:45], v[44:45], v[76:79]
    v_mfma_f32_4x4x4_16b_bf16 v[64:67], v[140:141], v[42:43], v[64:67]
    v_mfma_f32_4x4x4_16b_bf16 v[68:71], v[42:43], v[42:43], v[68:71]
    v_mfma_f32_4x4x4_16b_bf16 v[72:75], v[140:141], v[46:47], v[72:75]
    v_mfma_f32_4x4x4_16b_bf16 v[76:79], v[46:47], v[46:47], v[76:79]
    v_and_b32 v80, 3, v1
    s_nop 2
    v_cmp_eq_u32 vcc, 1, v80
    s_nop 1
    v_cndmask_b32 v68, v68, v69, vcc
    v_cndmask_b32 v76, v76, v77, vcc
    v_cmp_eq_u32 vcc, 2, v80
    s_nop 1
    v_cndmask_b32 v68, v68, v70, vcc
    v_cndmask_b32 v76, v76, v78, vcc
    v_cmp_eq_u32 vcc, 3, v80
    s_nop 1
    v_cndmask_b32 v68, v68, v71, vcc
    v_cndmask_b32 v76, v76, v79, vcc
    v_add_f32_dpp v64, v64, v64 quad_perm:[1,0,3,2] row_mask:0xf bank_mask:0xf
    v_add_f32_dpp v72, v72, v72 quad_perm:[1,0,3,2] row_mask:0xf bank_mask:0xf
    v_add_f32_dpp v68, v68, v68 quad_perm:[1,0,3,2] row_mask:0xf bank_mask:0xf
    v_add_f32_dpp v76, v76, v76 quad_perm:[1,0,3,2] row_mask:0xf bank_mask:0xf
    v_add_f32_dpp v64, v64, v64 quad_perm:[2,3,0,1] row_mask:0xf bank_mask:0xf
    v_add_f32_dpp v72, v72, v72 quad_perm:[2,3,0,1] row_mask:0xf bank_mask:0xf
    v_add_f32_dpp v68, v68, v68 quad_perm:[2,3,0,1] row_mask:0xf bank_mask:0xf
    v_add_f32_dpp v76, v76, v76 quad_perm:[2,3,0,1] row_mask:0xf bank_mask:0xf
    v_add_f32_dpp v64, v64, v64 row_half_mirror row_mask:0xf bank_mask:0xf
    v_add_f32_dpp v72, v72, v72 row_half_mirror row_mask:0xf bank_mask:0xf
    v_add_f32_dpp v68, v68, v68 row_half_mirror row_mask:0xf bank_mask:0xf
    v_add_f32_dpp v76, v76, v76 row_half_mirror row_mask:0xf bank_mask:0xf
    v_mul_f32 v64, 0x3acccccd, v64
    v_mul_f32 v72, 0x3acccccd, v72
    v_mul_f32 v68, 0x3acccccd, v68
    v_mul_f32 v76, 0x3acccccd, v76
    v_fma_f32 v68, -v64, v64, v68
    v_max_f32_e64 v68, 0, v68
    v_add_f32 v68, 0x3727c5ac, v68
    v_rsq_f32_e64 v68, v68
    v_fma_f32 v76, -v72, v72, v76
    v_max_f32_e64 v76, 0, v76
    v_add_f32 v76, 0x3727c5ac, v76
    v_rsq_f32 v76, v76
    s_lshl_b32 s32, s20, 6
    s_add_u32 s32, s32, 54272
    v_lshrrev_b32_e64 v80, 3, v1
    v_lshl_add_u32 v80, v80, 2, s32
    ds_write_b32 v80, v64
    ds_write_b32 v80, v68 offset:256
    ds_write_b32 v80, v72 offset:32
    ds_write_b32 v80, v76 offset:288
    s_waitcnt lgkmcnt(0)
    s_barrier
    v_and_b32 v149, 7, v1
    v_lshlrev_b32 v149, 2, v149
    v_add_u32 v149, 163328, v149
L_parallel_sum__grouped_kv_mqa__mixer_gmlp__prompt_ac_202:
    ds_read_b32 v4, v149
    s_waitcnt lgkmcnt(0)
    v_cmp_gt_u32 vcc, 1, v4
    s_cbranch_vccz L_parallel_sum__grouped_kv_mqa__mixer_gmlp__prompt_acd_203
    s_sleep 8
    s_sub_u32 s70, s70, 1
    s_cbranch_scc0 L_parallel_sum__grouped_kv_mqa__mixer_gmlp__prompt_ac_202
L_parallel_sum__grouped_kv_mqa__mixer_gmlp__prompt_acd_203:
    v_and_b32 v149, 7, v1
    v_lshlrev_b32 v149, 2, v149
    v_add_u32 v149, 163328, v149
L_parallel_sum__grouped_kv_mqa__mixer_gmlp__prompt_ac_204:
    ds_read_b32 v4, v149
    s_waitcnt lgkmcnt(0)
    v_cmp_gt_u32 vcc, 1, v4
    s_cbranch_vccz L_parallel_sum__grouped_kv_mqa__mixer_gmlp__prompt_acd_205
    s_sleep 8
    s_sub_u32 s70, s70, 1
    s_cbranch_scc0 L_parallel_sum__grouped_kv_mqa__mixer_gmlp__prompt_ac_204
L_parallel_sum__grouped_kv_mqa__mixer_gmlp__prompt_acd_205:
    s_and_b32 s32, s2, 1
    s_lshl_b32 s32, s32, 2
    s_add_u32 s32, s32, s20
    s_lshl_b32 s32, s32, 16
    s_lshl_b32 s33, s6, 19
    s_add_u32 s32, s32, s33
    v_lshlrev_b32_e64 v152, 7, v1
    s_mov_b32 s16, s58
    s_mov_b32 s17, s59
    s_mov_b32 s18, 0x00800000
    s_mov_b32 s19, 0x00020000
    buffer_load_dword v153, v152, s[16:19], s32 offen
    s_add_u32 s32, s32, 8192
    buffer_load_dword v153, v152, s[16:19], s32 offen
    s_add_u32 s32, s32, 8192
    s_waitcnt vmcnt(0)
    buffer_load_dword v153, v152, s[16:19], s32 offen
    s_add_u32 s32, s32, 8192
    buffer_load_dword v153, v152, s[16:19], s32 offen
    s_add_u32 s32, s32, 8192
    s_waitcnt vmcnt(0)
    buffer_load_dword v153, v152, s[16:19], s32 offen
    s_add_u32 s32, s32, 8192
    buffer_load_dword v153, v152, s[16:19], s32 offen
    s_add_u32 s32, s32, 8192
    s_waitcnt vmcnt(0)
    buffer_load_dword v153, v152, s[16:19], s32 offen
    s_add_u32 s32, s32, 8192
    buffer_load_dword v153, v152, s[16:19], s32 offen
    s_add_u32 s32, s32, 8192
    s_waitcnt vmcnt(0)
    s_mov_b32 s29, s98
L_parallel_sum__grouped_kv_mqa__mixer_gmlp__prompt_rl_201:
    s_cmp_ge_u32 s29, 20
    s_cbranch_scc1 L_parallel_sum__grouped_kv_mqa__mixer_gmlp__prompt_rp1_206
    s_mov_b32 s8, s52
    s_mov_b32 s9, s53
    s_mov_b32 s10, 0x000c8000
    s_mov_b32 s11, 0x00020000
    s_mul_i32 s16, s29, 40960
    s_branch L_parallel_sum__grouped_kv_mqa__mixer_gmlp__prompt_rp2_207
L_parallel_sum__grouped_kv_mqa__mixer_gmlp__prompt_rp1_206:
    s_mov_b32 s8, s62
    s_mov_b32 s9, s63
    s_mov_b32 s10, 0x0010e000
    s_mov_b32 s11, 0x00020000
    s_sub_u32 s16, s29, 20
    s_mul_i32 s16, s16, 40960
L_parallel_sum__grouped_kv_mqa__mixer_gmlp__prompt_rp2_207:
    s_add_u32 s12, s68, 0x012d0000
    s_addc_u32 s13, s69, 0
    s_mov_b32 s14, 0x001d6000
    s_mov_b32 s15, 0x00020000
    s_mul_i32 s17, s20, 10240
    s_add_u32 s16, s16, s17
    s_add_u32 s17, s17, 62976
    v_lshlrev_b32 v48, 4, v1
    s_add_u32 m0, s17, 0
    s_add_u32 s18, s16, 0
    buffer_load_dwordx4 v48, s[8:11], s18 offen offset:0 lds
    buffer_load_dwordx4 v48, s[8:11], s18 offen offset:1024 lds
    buffer_load_dwordx4 v48, s[8:11], s18 offen offset:2048 lds
    buffer_load_dwordx4 v48, s[8:11], s18 offen offset:3072 lds
    s_add_u32 m0, s17, 4096
    s_add_u32 s18, s16, 4096
    buffer_load_dwordx4 v48, s[8:11], s18 offen offset:0 lds
    buffer_load_dwordx4 v48, s[8:11], s18 offen offset:1024 lds
    buffer_load_dwordx4 v48, s[8:11], s18 offen offset:2048 lds
    buffer_load_dwordx4 v48, s[8:11], s18 offen offset:3072 lds
    s_add_u32 m0, s17, 8192
    s_add_u32 s18, s16, 8192
    buffer_load_dwordx4 v48, s[8:11], s18 offen offset:0 lds
    buffer_load_dwordx4 v48, s[8:11], s18 offen offset:1024 lds
    v_lshrrev_b32_e64 v49, 4, v1
    v_bfe_u32 v50, v1, 2, 2
    v_lshl_add_u32 v49, v49, 3, v50
    v_mul_u32_u24 v49, 1280, v49
    v_and_b32_e64 v50, 3, v1
    v_lshl_add_u32 v49, v50, 3, v49
    s_mul_i32 s16, s20, 320
    s_add_u32 s16, s16, 62976
    v_add_u32 v49, s16, v49
    s_waitcnt vmcnt(0)
    s_add_u32 s21, s21, 1
    v_mov_b32 v4, s21
    ds_write_b32 v5, v4
L_parallel_sum__grouped_kv_mqa__mixer_gmlp__prompt_gspin_208:
    ds_read_b32 v4, v6
    s_waitcnt lgkmcnt(0)
    v_cmp_gt_u32 vcc, s21, v4
    s_cbranch_vccz L_parallel_sum__grouped_kv_mqa__mixer_gmlp__prompt_gspun_209
    s_sleep 1
    s_sub_u32 s70, s70, 1
    s_cbranch_scc0 L_parallel_sum__grouped_kv_mqa__mixer_gmlp__prompt_gspin_208
L_parallel_sum__grouped_kv_mqa__mixer_gmlp__prompt_gspun_209:
    s_lshl_b32 s18, s20, 1
    s_add_u32 s18, s18, 0
    s_mov_b32 s16, s29
    s_mul_i32 s18, s18, 47
    s_add_u32 s16, s16, s18
    s_mul_i32 s16, s16, 5120
    ds_read_b64_tr_b16 v[8:9], v49 offset:0
    ds_read_b64_tr_b16 v[10:11], v49 offset:5120
    ds_read_b64_tr_b16 v[12:13], v49 offset:32
    ds_read_b64_tr_b16 v[14:15], v49 offset:5152
    ds_read_b64_tr_b16 v[16:17], v49 offset:64
    ds_read_b64_tr_b16 v[18:19], v49 offset:5184
    ds_read_b64_tr_b16 v[20:21], v49 offset:96
    ds_read_b64_tr_b16 v[22:23], v49 offset:5216
    ds_read_b64_tr_b16 v[24:25], v49 offset:128
    ds_read_b64_tr_b16 v[26:27], v49 offset:5248
    s_waitcnt lgkmcnt(0)
    buffer_store_dwordx4 v[8:11], v48, s[12:15], s16 offen offset:0 sc1
    buffer_store_dwordx4 v[12:15], v48, s[12:15], s16 offen offset:1024 sc1
    buffer_store_dwordx4 v[16:19], v48, s[12:15], s16 offen offset:2048 sc1
    buffer_store_dwordx4 v[20:23], v48, s[12:15], s16 offen offset:3072 sc1
    s_add_u32 s17, s16, 4096
    buffer_store_dwordx4 v[24:27], v48, s[12:15], s17 offen sc1
    s_lshl_b32 s18, s20, 1
    s_add_u32 s18, s18, 1
    s_mov_b32 s16, s29
    s_mul_i32 s18, s18, 47
    s_add_u32 s16, s16, s18
    s_mul_i32 s16, s16, 5120
    ds_read_b64_tr_b16 v[28:29], v49 offset:160
    ds_read_b64_tr_b16 v[30:31], v49 offset:5280
    ds_read_b64_tr_b16 v[32:33], v49 offset:192
    ds_read_b64_tr_b16 v[34:35], v49 offset:5312
    ds_read_b64_tr_b16 v[36:37], v49 offset:224
    ds_read_b64_tr_b16 v[38:39], v49 offset:5344
    ds_read_b64_tr_b16 v[40:41], v49 offset:256
    ds_read_b64_tr_b16 v[42:43], v49 offset:5376
    ds_read_b64_tr_b16 v[44:45], v49 offset:288
    ds_read_b64_tr_b16 v[46:47], v49 offset:5408
    s_waitcnt lgkmcnt(0)
    buffer_store_dwordx4 v[28:31], v48, s[12:15], s16 offen offset:0 sc1
    buffer_store_dwordx4 v[32:35], v48, s[12:15], s16 offen offset:1024 sc1
    buffer_store_dwordx4 v[36:39], v48, s[12:15], s16 offen offset:2048 sc1
    buffer_store_dwordx4 v[40:43], v48, s[12:15], s16 offen offset:3072 sc1
    s_add_u32 s17, s16, 4096
    buffer_store_dwordx4 v[44:47], v48, s[12:15], s17 offen sc1
    s_add_u32 s29, s29, 32
    s_waitcnt vmcnt(0)
    s_add_u32 s21, s21, 1
    v_mov_b32 v4, s21
    ds_write_b32 v5, v4
L_parallel_sum__grouped_kv_mqa__mixer_gmlp__prompt_gspin_210:
    ds_read_b32 v4, v6
    s_waitcnt lgkmcnt(0)
    v_cmp_gt_u32 vcc, s21, v4
    s_cbranch_vccz L_parallel_sum__grouped_kv_mqa__mixer_gmlp__prompt_gspun_211
    s_sleep 1
    s_sub_u32 s70, s70, 1
    s_cbranch_scc0 L_parallel_sum__grouped_kv_mqa__mixer_gmlp__prompt_gspin_210
L_parallel_sum__grouped_kv_mqa__mixer_gmlp__prompt_gspun_211:
    s_cmp_lt_u32 s29, 47
    s_cbranch_scc1 L_parallel_sum__grouped_kv_mqa__mixer_gmlp__prompt_rl_201
    s_cmp_lg_u32 s20, 0
    s_cbranch_scc1 L_parallel_sum__grouped_kv_mqa__mixer_gmlp__prompt_nf_212
    s_lshl_b32 s32, s98, 7
    s_add_u32 s32, s32, 163840
    v_mov_b32 v146, s96
    v_mov_b32 v147, s97
    v_lshlrev_b32 v144, 3, v1
    s_mov_b64 exec, 0xffff
    buffer_store_dwordx2 v[146:147], v144, s[72:75], s32 offen sc1
    s_mov_b64 exec, -1
L_parallel_sum__grouped_kv_mqa__mixer_gmlp__prompt_nf_212:
L_parallel_sum__grouped_kv_mqa__mixer_gmlp__prompt_outq_94:
    s_setprio 0
    s_lshr_b32 s30, s2, 5
    s_mul_i32 s23, s30, 240640
    s_add_u32 s23, s23, 38400
    s_add_u32 s12, s68, 0x012d0000
    s_addc_u32 s13, s69, 0
    s_mov_b32 s14, 0x001d6000
    s_mov_b32 s15, 0x00020000
    v_and_b32 v144, 7, v1
    v_lshlrev_b32 v144, 2, v144
    v_add_u32 v144, 163328, v144
L_parallel_sum__grouped_kv_mqa__mixer_gmlp__prompt_ac_213:
    ds_read_b32 v4, v144
    s_waitcnt lgkmcnt(0)
    v_cmp_gt_u32 vcc, 6, v4
    s_cbranch_vccz L_parallel_sum__grouped_kv_mqa__mixer_gmlp__prompt_acd_214
    s_sleep 32
    s_sub_u32 s70, s70, 1
    s_cbranch_scc0 L_parallel_sum__grouped_kv_mqa__mixer_gmlp__prompt_ac_213
L_parallel_sum__grouped_kv_mqa__mixer_gmlp__prompt_acd_214:
    v_lshlrev_b32 v124, 4, v1
    v_lshlrev_b32 v144, 7, v1
    s_mov_b32 s32, 163840
    s_mov_b64 exec, 0xffffffff
L_parallel_sum__grouped_kv_mqa__mixer_gmlp__prompt_pl_215:
    buffer_load_dwordx2 v[146:147], v144, s[72:75], s32 offen sc1
    s_waitcnt vmcnt(0)
    v_cmp_ne_u64 vcc, s[96:97], v[146:147]
    s_cbranch_vccz L_parallel_sum__grouped_kv_mqa__mixer_gmlp__prompt_pd_216
    s_sleep 16
    s_sub_u32 s70, s70, 1
    s_cbranch_scc0 L_parallel_sum__grouped_kv_mqa__mixer_gmlp__prompt_pl_215
L_parallel_sum__grouped_kv_mqa__mixer_gmlp__prompt_pd_216:
    s_mov_b64 exec, -1
    s_mul_i32 s32, s20, 24576
    s_add_u32 s32, s32, 62976
    s_add_u32 m0, s32, 0
    s_add_u32 s24, m0, s23
    buffer_load_dwordx4 v124, s[12:15], s24 offen offset:0 sc1 lds
    buffer_load_dwordx4 v124, s[12:15], s24 offen offset:1024 sc1 lds
    buffer_load_dwordx4 v124, s[12:15], s24 offen offset:2048 sc1 lds
    buffer_load_dwordx4 v124, s[12:15], s24 offen offset:3072 sc1 lds
    s_add_u32 m0, s32, 4096
    s_add_u32 s24, m0, s23
    buffer_load_dwordx4 v124, s[12:15], s24 offen offset:0 sc1 lds
    buffer_load_dwordx4 v124, s[12:15], s24 offen offset:1024 sc1 lds
    buffer_load_dwordx4 v124, s[12:15], s24 offen offset:2048 sc1 lds
    buffer_load_dwordx4 v124, s[12:15], s24 offen offset:3072 sc1 lds
    s_add_u32 m0, s32, 8192
    s_add_u32 s24, m0, s23
    buffer_load_dwordx4 v124, s[12:15], s24 offen offset:0 sc1 lds
    buffer_load_dwordx4 v124, s[12:15], s24 offen offset:1024 sc1 lds
    buffer_load_dwordx4 v124, s[12:15], s24 offen offset:2048 sc1 lds
    buffer_load_dwordx4 v124, s[12:15], s24 offen offset:3072 sc1 lds
    s_add_u32 m0, s32, 12288
    s_add_u32 s24, m0, s23
    buffer_load_dwordx4 v124, s[12:15], s24 offen offset:0 sc1 lds
    buffer_load_dwordx4 v124, s[12:15], s24 offen offset:1024 sc1 lds
    buffer_load_dwordx4 v124, s[12:15], s24 offen offset:2048 sc1 lds
    buffer_load_dwordx4 v124, s[12:15], s24 offen offset:3072 sc1 lds
    s_add_u32 m0, s32, 16384
    s_add_u32 s24, m0, s23
    buffer_load_dwordx4 v124, s[12:15], s24 offen offset:0 sc1 lds
    buffer_load_dwordx4 v124, s[12:15], s24 offen offset:1024 sc1 lds
    buffer_load_dwordx4 v124, s[12:15], s24 offen offset:2048 sc1 lds
    buffer_load_dwordx4 v124, s[12:15], s24 offen offset:3072 sc1 lds
    s_add_u32 m0, s32, 20480
    s_add_u32 s24, m0, s23
    buffer_load_dwordx4 v124, s[12:15], s24 offen offset:0 sc1 lds
    buffer_load_dwordx4 v124, s[12:15], s24 offen offset:1024 sc1 lds
    buffer_load_dwordx4 v124, s[12:15], s24 offen offset:2048 sc1 lds
    buffer_load_dwordx4 v124, s[12:15], s24 offen offset:3072 sc1 lds
L_parallel_sum__grouped_kv_mqa__mixer_gmlp__prompt_outp_93:
    s_add_u32 s8, s68, 0x00cf0000
    s_addc_u32 s9, s69, 0
    s_mov_b32 s10, 0x005e0000
    s_mov_b32 s11, 0x00020000
    s_mov_b32 s16, s44
    s_mov_b32 s17, s45
    s_mov_b32 s18, 0x00280000
    s_mov_b32 s19, 0x00020000
    s_lshl_b32 s22, s98, 2
    s_add_u32 s22, s22, s20
    s_mul_i32 s25, s22, 48128
    s_mul_i32 s26, s22, 20480
    s_mul_i32 s32, s30, 160
    s_add_u32 s26, s26, s32
    v_lshlrev_b32_e64 v162, 4, v1
    v_add_u32 v163, 58880, v162
    v_add_u32 v164, 110080, v162
    v_lshlrev_b32 v166, 7, v1
    v_and_b32 v165, 15, v1
    v_mul_u32_u24 v165, 1280, v165
    v_lshrrev_b32_e64 v158, 4, v1
    v_lshl_add_u32 v165, v158, 3, v165
    s_setprio 0
    s_mul_i32 s37, s30, 5
    s_lshr_b32 s37, s37, 1
    s_mul_i32 s38, s30, 27
    s_lshr_b32 s38, s38, 3
    buffer_load_dwordx2 v[148:149], v165, s[16:19], s26 offen offset:0
    buffer_load_dwordx2 v[150:151], v165, s[16:19], s26 offen offset:32
    buffer_load_dwordx2 v[152:153], v165, s[16:19], s26 offen offset:64
    buffer_load_dwordx2 v[154:155], v165, s[16:19], s26 offen offset:96
    buffer_load_dwordx2 v[156:157], v165, s[16:19], s26 offen offset:128
    s_mul_i32 s33, s30, 240640
    s_mul_i32 s34, s20, 10240
    s_add_u32 s33, s33, s34
    s_add_u32 s33, s33, 199680
    s_add_u32 s34, s34, 64000
    v_add_u32_e64 v2, s34, v162
    buffer_load_dwordx4 v[68:71], v162, s[12:15], s33 offen offset:0 sc1
    buffer_load_dwordx4 v[72:75], v162, s[12:15], s33 offen offset:1024 sc1
    buffer_load_dwordx4 v[76:79], v162, s[12:15], s33 offen offset:2048 sc1
    buffer_load_dwordx4 v[80:83], v162, s[12:15], s33 offen offset:3072 sc1
    s_add_u32 s33, s33, 4096
    buffer_load_dwordx4 v[84:87], v162, s[12:15], s33 offen offset:0 sc1
    buffer_load_dwordx4 v[88:91], v162, s[12:15], s33 offen offset:1024 sc1
    buffer_load_dwordx4 v[92:95], v162, s[12:15], s33 offen offset:2048 sc1
    buffer_load_dwordx4 v[96:99], v162, s[12:15], s33 offen offset:3072 sc1
    s_add_u32 s33, s33, 4096
    buffer_load_dwordx4 v[100:103], v162, s[12:15], s33 offen offset:0 sc1
    buffer_load_dwordx4 v[104:107], v162, s[12:15], s33 offen offset:1024 sc1
    s_setprio 3
    s_lshr_b32 s29, s22, 1
    s_lshl_b32 s29, s29, 11
    s_add_u32 s29, s29, 262144
    s_waitcnt vmcnt(0)
    s_add_u32 s21, s21, 1
    v_mov_b32 v4, s21
    ds_write_b32 v5, v4
L_parallel_sum__grouped_kv_mqa__mixer_gmlp__prompt_gspin_217:
    ds_read_b32 v4, v6
    s_waitcnt lgkmcnt(0)
    v_cmp_gt_u32 vcc, s21, v4
    s_cbranch_vccz L_parallel_sum__grouped_kv_mqa__mixer_gmlp__prompt_gspun_218
    s_sleep 1
    s_sub_u32 s70, s70, 1
    s_cbranch_scc0 L_parallel_sum__grouped_kv_mqa__mixer_gmlp__prompt_gspin_217
L_parallel_sum__grouped_kv_mqa__mixer_gmlp__prompt_gspun_218:
L_parallel_sum__grouped_kv_mqa__mixer_gmlp__prompt_pb_219:
    s_mov_b64 exec, 0x00003fff
    buffer_load_dwordx2 v[158:159], v166, s[72:75], s29 offen sc1
    s_mov_b64 exec, -1
    s_waitcnt vmcnt(0)
    s_mov_b64 exec, 0x00003fff
    v_cmp_ne_u64 vcc, s[96:97], v[158:159]
    s_mov_b64 exec, -1
    s_cbranch_vccz L_parallel_sum__grouped_kv_mqa__mixer_gmlp__prompt_pbd_220
    s_sleep 2
    s_sub_u32 s70, s70, 1
    s_cbranch_scc0 L_parallel_sum__grouped_kv_mqa__mixer_gmlp__prompt_pb_219
L_parallel_sum__grouped_kv_mqa__mixer_gmlp__prompt_pbd_220:
    s_lshl_b32 s29, s98, 10
    s_add_u32 s29, s29, 98304
    s_setprio 0
    s_add_u32 s32, s25, 20480
    buffer_load_dwordx4 v[28:31], v162, s[8:11], s32 offen sc1
    s_add_u32 s32, s25, 21504
    buffer_load_dwordx4 v[32:35], v162, s[8:11], s32 offen sc1
    s_add_u32 s32, s25, 22528
    buffer_load_dwordx4 v[36:39], v162, s[8:11], s32 offen sc1
    s_add_u32 s32, s25, 23552
    buffer_load_dwordx4 v[40:43], v162, s[8:11], s32 offen sc1
    s_add_u32 s32, s25, 24576
    buffer_load_dwordx4 v[44:47], v162, s[8:11], s32 offen sc1
    s_add_u32 s32, s25, 25600
    buffer_load_dwordx4 v[48:51], v162, s[8:11], s32 offen sc1
    s_add_u32 s32, s25, 26624
    buffer_load_dwordx4 v[52:55], v162, s[8:11], s32 offen sc1
    s_add_u32 s32, s25, 27648
    buffer_load_dwordx4 v[56:59], v162, s[8:11], s32 offen sc1
    s_add_u32 s32, s25, 28672
    buffer_load_dwordx4 v[60:63], v162, s[8:11], s32 offen sc1
    s_add_u32 s32, s25, 29696
    buffer_load_dwordx4 v[64:67], v162, s[8:11], s32 offen sc1
    ds_read_b128 v[108:111], v163 offset:5120
    ds_read_b128 v[112:115], v163 offset:6144
    ds_read_b128 v[116:119], v163 offset:7168
    ds_read_b128 v[120:123], v163 offset:8192
    ds_read_b128 v[124:127], v163 offset:9216
    ds_read_b128 v[128:131], v163 offset:10240
    ds_read_b128 v[132:135], v163 offset:11264
    ds_read_b128 v[136:139], v163 offset:12288
    ds_read_b128 v[140:143], v163 offset:13312
    ds_read_b128 v[144:147], v163 offset:14336
    s_waitcnt vmcnt(9) lgkmcnt(5)
    v_mfma_f32_16x16x32_bf16 v[8:11], v[108:111], v[28:31], 0
    ds_read_b128 v[108:111], v163 offset:15360
    v_mfma_f32_16x16x32_bf16 v[12:15], v[112:115], v[28:31], 0
    ds_read_b128 v[112:115], v163 offset:16384
    v_mfma_f32_16x16x32_bf16 v[16:19], v[116:119], v[28:31], 0
    ds_read_b128 v[116:119], v163 offset:17408
    v_mfma_f32_16x16x32_bf16 v[20:23], v[120:123], v[28:31], 0
    ds_read_b128 v[120:123], v163 offset:18432
    v_mfma_f32_16x16x32_bf16 v[24:27], v[124:127], v[28:31], 0
    ds_read_b128 v[124:127], v163 offset:19456
    s_waitcnt vmcnt(8) lgkmcnt(5)
    v_mfma_f32_16x16x32_bf16 v[8:11], v[128:131], v[32:35], v[8:11]
    ds_read_b128 v[128:131], v163 offset:20480
    v_mfma_f32_16x16x32_bf16 v[12:15], v[132:135], v[32:35], v[12:15]
    ds_read_b128 v[132:135], v163 offset:21504
    s_add_u32 s32, s25, 30720
    buffer_load_dwordx4 v[28:31], v162, s[8:11], s32 offen sc1
    v_mfma_f32_16x16x32_bf16 v[16:19], v[136:139], v[32:35], v[16:19]
    ds_read_b128 v[136:139], v163 offset:22528
    v_mfma_f32_16x16x32_bf16 v[20:23], v[140:143], v[32:35], v[20:23]
    ds_read_b128 v[140:143], v163 offset:23552
    v_mfma_f32_16x16x32_bf16 v[24:27], v[144:147], v[32:35], v[24:27]
    ds_read_b128 v[144:147], v163 offset:24576
    s_waitcnt vmcnt(8) lgkmcnt(5)
    v_mfma_f32_16x16x32_bf16 v[8:11], v[108:111], v[36:39], v[8:11]
    ds_read_b128 v[108:111], v163 offset:25600
    v_mfma_f32_16x16x32_bf16 v[12:15], v[112:115], v[36:39], v[12:15]
    ds_read_b128 v[112:115], v163 offset:26624
    s_add_u32 s32, s25, 31744
    buffer_load_dwordx4 v[32:35], v162, s[8:11], s32 offen sc1
    v_mfma_f32_16x16x32_bf16 v[16:19], v[116:119], v[36:39], v[16:19]
    ds_read_b128 v[116:119], v163 offset:27648
    v_mfma_f32_16x16x32_bf16 v[20:23], v[120:123], v[36:39], v[20:23]
    ds_read_b128 v[120:123], v163 offset:28672
    v_mfma_f32_16x16x32_bf16 v[24:27], v[124:127], v[36:39], v[24:27]
    ds_read_b128 v[124:127], v163 offset:29696
    s_waitcnt vmcnt(8) lgkmcnt(5)
    v_mfma_f32_16x16x32_bf16 v[8:11], v[128:131], v[40:43], v[8:11]
    ds_read_b128 v[128:131], v163 offset:30720
    v_mfma_f32_16x16x32_bf16 v[12:15], v[132:135], v[40:43], v[12:15]
    ds_read_b128 v[132:135], v163 offset:31744
    s_add_u32 s32, s25, 32768
    buffer_load_dwordx4 v[36:39], v162, s[8:11], s32 offen sc1
    v_mfma_f32_16x16x32_bf16 v[16:19], v[136:139], v[40:43], v[16:19]
    ds_read_b128 v[136:139], v163 offset:32768
    v_mfma_f32_16x16x32_bf16 v[20:23], v[140:143], v[40:43], v[20:23]
    ds_read_b128 v[140:143], v163 offset:33792
    v_mfma_f32_16x16x32_bf16 v[24:27], v[144:147], v[40:43], v[24:27]
    ds_read_b128 v[144:147], v163 offset:34816
    s_waitcnt vmcnt(8) lgkmcnt(5)
    v_mfma_f32_16x16x32_bf16 v[8:11], v[108:111], v[44:47], v[8:11]
    ds_read_b128 v[108:111], v163 offset:35840
    v_mfma_f32_16x16x32_bf16 v[12:15], v[112:115], v[44:47], v[12:15]
    ds_read_b128 v[112:115], v163 offset:36864
    s_add_u32 s32, s25, 33792
    buffer_load_dwordx4 v[40:43], v162, s[8:11], s32 offen sc1
    v_mfma_f32_16x16x32_bf16 v[16:19], v[116:119], v[44:47], v[16:19]
    ds_read_b128 v[116:119], v163 offset:37888
    v_mfma_f32_16x16x32_bf16 v[20:23], v[120:123], v[44:47], v[20:23]
    ds_read_b128 v[120:123], v163 offset:38912
    v_mfma_f32_16x16x32_bf16 v[24:27], v[124:127], v[44:47], v[24:27]
    ds_read_b128 v[124:127], v163 offset:39936
    s_waitcnt vmcnt(8) lgkmcnt(5)
    v_mfma_f32_16x16x32_bf16 v[8:11], v[128:131], v[48:51], v[8:11]
    ds_read_b128 v[128:131], v163 offset:40960
    v_mfma_f32_16x16x32_bf16 v[12:15], v[132:135], v[48:51], v[12:15]
    ds_read_b128 v[132:135], v163 offset:41984
    s_add_u32 s32, s25, 34816
    buffer_load_dwordx4 v[44:47], v162, s[8:11], s32 offen sc1
    v_mfma_f32_16x16x32_bf16 v[16:19], v[136:139], v[48:51], v[16:19]
    ds_read_b128 v[136:139], v163 offset:43008
    v_mfma_f32_16x16x32_bf16 v[20:23], v[140:143], v[48:51], v[20:23]
    ds_read_b128 v[140:143], v163 offset:44032
    v_mfma_f32_16x16x32_bf16 v[24:27], v[144:147], v[48:51], v[24:27]
    ds_read_b128 v[144:147], v163 offset:45056
    s_waitcnt vmcnt(8) lgkmcnt(5)
    v_mfma_f32_16x16x32_bf16 v[8:11], v[108:111], v[52:55], v[8:11]
    ds_read_b128 v[108:111], v163 offset:46080
    v_mfma_f32_16x16x32_bf16 v[12:15], v[112:115], v[52:55], v[12:15]
    ds_read_b128 v[112:115], v163 offset:47104
    s_add_u32 s32, s25, 35840
    buffer_load_dwordx4 v[48:51], v162, s[8:11], s32 offen sc1
    v_mfma_f32_16x16x32_bf16 v[16:19], v[116:119], v[52:55], v[16:19]
    ds_read_b128 v[116:119], v163 offset:48128
    v_mfma_f32_16x16x32_bf16 v[20:23], v[120:123], v[52:55], v[20:23]
    ds_read_b128 v[120:123], v163 offset:49152
    v_mfma_f32_16x16x32_bf16 v[24:27], v[124:127], v[52:55], v[24:27]
    ds_read_b128 v[124:127], v163 offset:50176
    s_waitcnt vmcnt(8) lgkmcnt(5)
    s_add_u32 s21, s21, 1
    v_mov_b32 v4, s21
    ds_write_b32 v5, v4
    v_mfma_f32_16x16x32_bf16 v[8:11], v[128:131], v[56:59], v[8:11]
    ds_read_b128 v[128:131], v164 offset:0
    v_mfma_f32_16x16x32_bf16 v[12:15], v[132:135], v[56:59], v[12:15]
    ds_read_b128 v[132:135], v164 offset:1024
    s_add_u32 s32, s25, 36864
    buffer_load_dwordx4 v[52:55], v162, s[8:11], s32 offen sc1
    v_mfma_f32_16x16x32_bf16 v[16:19], v[136:139], v[56:59], v[16:19]
    ds_read_b128 v[136:139], v164 offset:2048
    v_mfma_f32_16x16x32_bf16 v[20:23], v[140:143], v[56:59], v[20:23]
    ds_read_b128 v[140:143], v164 offset:3072
    v_mfma_f32_16x16x32_bf16 v[24:27], v[144:147], v[56:59], v[24:27]
    ds_read_b128 v[144:147], v164 offset:4096
    s_waitcnt vmcnt(8) lgkmcnt(6)
    v_mfma_f32_16x16x32_bf16 v[8:11], v[108:111], v[60:63], v[8:11]
    ds_read_b128 v[108:111], v164 offset:5120
    v_mfma_f32_16x16x32_bf16 v[12:15], v[112:115], v[60:63], v[12:15]
    ds_read_b128 v[112:115], v164 offset:6144
    s_add_u32 s32, s25, 37888
    buffer_load_dwordx4 v[56:59], v162, s[8:11], s32 offen sc1
    v_mfma_f32_16x16x32_bf16 v[16:19], v[116:119], v[60:63], v[16:19]
    ds_read_b128 v[116:119], v164 offset:7168
    v_mfma_f32_16x16x32_bf16 v[20:23], v[120:123], v[60:63], v[20:23]
    ds_read_b128 v[120:123], v164 offset:8192
    v_mfma_f32_16x16x32_bf16 v[24:27], v[124:127], v[60:63], v[24:27]
    ds_read_b128 v[124:127], v164 offset:9216
    s_waitcnt vmcnt(8) lgkmcnt(5)
    ds_read_b32 v158, v6
    v_mfma_f32_16x16x32_bf16 v[8:11], v[128:131], v[64:67], v[8:11]
    ds_read_b128 v[128:131], v164 offset:10240
    v_mfma_f32_16x16x32_bf16 v[12:15], v[132:135], v[64:67], v[12:15]
    ds_read_b128 v[132:135], v164 offset:11264
    s_add_u32 s32, s25, 38912
    buffer_load_dwordx4 v[60:63], v162, s[8:11], s32 offen sc1
    v_mfma_f32_16x16x32_bf16 v[16:19], v[136:139], v[64:67], v[16:19]
    ds_read_b128 v[136:139], v164 offset:12288
    v_mfma_f32_16x16x32_bf16 v[20:23], v[140:143], v[64:67], v[20:23]
    ds_read_b128 v[140:143], v164 offset:13312
    v_mfma_f32_16x16x32_bf16 v[24:27], v[144:147], v[64:67], v[24:27]
    ds_read_b128 v[144:147], v164 offset:14336
    s_waitcnt vmcnt(8) lgkmcnt(6)
    s_waitcnt lgkmcnt(5)
    v_cmp_gt_u32 vcc, s21, v158
    s_cbranch_vccnz L_parallel_sum__grouped_kv_mqa__mixer_gmlp__prompt_oslow_221
L_parallel_sum__grouped_kv_mqa__mixer_gmlp__prompt_ook_222:
    v_mfma_f32_16x16x32_bf16 v[8:11], v[108:111], v[28:31], v[8:11]
    ds_read_b128 v[108:111], v164 offset:15360
    v_mfma_f32_16x16x32_bf16 v[12:15], v[112:115], v[28:31], v[12:15]
    ds_read_b128 v[112:115], v164 offset:16384
    s_add_u32 s32, s25, 39936
    buffer_load_dwordx4 v[64:67], v162, s[8:11], s32 offen sc1
    v_mfma_f32_16x16x32_bf16 v[16:19], v[116:119], v[28:31], v[16:19]
    ds_read_b128 v[116:119], v164 offset:17408
    v_mfma_f32_16x16x32_bf16 v[20:23], v[120:123], v[28:31], v[20:23]
    ds_read_b128 v[120:123], v164 offset:18432
    ds_write_b128 v2, v[68:71] offset:0
    v_mfma_f32_16x16x32_bf16 v[24:27], v[124:127], v[28:31], v[24:27]
    ds_read_b128 v[124:127], v164 offset:19456
    ds_write_b128 v2, v[72:75] offset:1024
    s_waitcnt vmcnt(8) lgkmcnt(7)
    v_mfma_f32_16x16x32_bf16 v[8:11], v[128:131], v[32:35], v[8:11]
    ds_read_b128 v[128:131], v164 offset:20480
    v_mfma_f32_16x16x32_bf16 v[12:15], v[132:135], v[32:35], v[12:15]
    ds_read_b128 v[132:135], v164 offset:21504
    s_add_u32 s32, s25, 40960
    buffer_load_dwordx4 v[28:31], v162, s[8:11], s32 offen sc1
    v_mfma_f32_16x16x32_bf16 v[16:19], v[136:139], v[32:35], v[16:19]
    ds_read_b128 v[136:139], v164 offset:22528
    v_mfma_f32_16x16x32_bf16 v[20:23], v[140:143], v[32:35], v[20:23]
    ds_read_b128 v[140:143], v164 offset:23552
    ds_write_b128 v2, v[76:79] offset:2048
    v_mfma_f32_16x16x32_bf16 v[24:27], v[144:147], v[32:35], v[24:27]
    ds_read_b128 v[144:147], v164 offset:24576
    ds_write_b128 v2, v[80:83] offset:3072
    s_waitcnt vmcnt(8) lgkmcnt(8)
    v_mfma_f32_16x16x32_bf16 v[8:11], v[108:111], v[36:39], v[8:11]
    ds_read_b128 v[108:111], v164 offset:25600
    v_mfma_f32_16x16x32_bf16 v[12:15], v[112:115], v[36:39], v[12:15]
    ds_read_b128 v[112:115], v164 offset:26624
    s_add_u32 s32, s25, 41984
    buffer_load_dwordx4 v[32:35], v162, s[8:11], s32 offen sc1
    v_mfma_f32_16x16x32_bf16 v[16:19], v[116:119], v[36:39], v[16:19]
    ds_read_b128 v[116:119], v164 offset:27648
    v_mfma_f32_16x16x32_bf16 v[20:23], v[120:123], v[36:39], v[20:23]
    ds_read_b128 v[120:123], v164 offset:28672
    ds_write_b128 v2, v[84:87] offset:4096
    v_mfma_f32_16x16x32_bf16 v[24:27], v[124:127], v[36:39], v[24:27]
    ds_read_b128 v[124:127], v164 offset:29696
    ds_write_b128 v2, v[88:91] offset:5120
    s_waitcnt vmcnt(8) lgkmcnt(8)
    v_mfma_f32_16x16x32_bf16 v[8:11], v[128:131], v[40:43], v[8:11]
    ds_read_b128 v[128:131], v164 offset:30720
    v_mfma_f32_16x16x32_bf16 v[12:15], v[132:135], v[40:43], v[12:15]
    ds_read_b128 v[132:135], v164 offset:31744
    s_add_u32 s32, s25, 43008
    buffer_load_dwordx4 v[36:39], v162, s[8:11], s32 offen sc1
    v_mfma_f32_16x16x32_bf16 v[16:19], v[136:139], v[40:43], v[16:19]
    ds_read_b128 v[136:139], v164 offset:32768
    v_mfma_f32_16x16x32_bf16 v[20:23], v[140:143], v[40:43], v[20:23]
    ds_read_b128 v[140:143], v164 offset:33792
    ds_write_b128 v2, v[92:95] offset:6144
    v_mfma_f32_16x16x32_bf16 v[24:27], v[144:147], v[40:43], v[24:27]
    ds_read_b128 v[144:147], v164 offset:34816
    ds_write_b128 v2, v[96:99] offset:7168
    s_waitcnt vmcnt(8) lgkmcnt(8)
    v_mfma_f32_16x16x32_bf16 v[8:11], v[108:111], v[44:47], v[8:11]
    ds_read_b128 v[108:111], v164 offset:35840
    v_mfma_f32_16x16x32_bf16 v[12:15], v[112:115], v[44:47], v[12:15]
    ds_read_b128 v[112:115], v164 offset:36864
    s_add_u32 s32, s25, 44032
    buffer_load_dwordx4 v[40:43], v162, s[8:11], s32 offen sc1
    v_mfma_f32_16x16x32_bf16 v[16:19], v[116:119], v[44:47], v[16:19]
    ds_read_b128 v[116:119], v164 offset:37888
    v_mfma_f32_16x16x32_bf16 v[20:23], v[120:123], v[44:47], v[20:23]
    ds_read_b128 v[120:123], v164 offset:38912
    ds_write_b128 v2, v[100:103] offset:8192
    v_mfma_f32_16x16x32_bf16 v[24:27], v[124:127], v[44:47], v[24:27]
    ds_read_b128 v[124:127], v164 offset:39936
    ds_write_b128 v2, v[104:107] offset:9216
    s_waitcnt vmcnt(8) lgkmcnt(8)
    s_waitcnt lgkmcnt(0)
    s_add_u32 s21, s21, 1
    v_mov_b32 v4, s21
    ds_write_b32 v5, v4
    v_mfma_f32_16x16x32_bf16 v[8:11], v[128:131], v[48:51], v[8:11]
    ds_read_b128 v[128:131], v164 offset:40960
    v_mfma_f32_16x16x32_bf16 v[12:15], v[132:135], v[48:51], v[12:15]
    ds_read_b128 v[132:135], v164 offset:41984
    s_add_u32 s32, s25, 45056
    buffer_load_dwordx4 v[44:47], v162, s[8:11], s32 offen sc1
    v_mfma_f32_16x16x32_bf16 v[16:19], v[136:139], v[48:51], v[16:19]
    ds_read_b128 v[136:139], v164 offset:43008
    v_mfma_f32_16x16x32_bf16 v[20:23], v[140:143], v[48:51], v[20:23]
    ds_read_b128 v[140:143], v164 offset:44032
    v_mfma_f32_16x16x32_bf16 v[24:27], v[144:147], v[48:51], v[24:27]
    ds_read_b128 v[144:147], v164 offset:45056
    s_waitcnt vmcnt(8) lgkmcnt(7)
    ds_read_b32 v158, v6
    v_mfma_f32_16x16x32_bf16 v[8:11], v[108:111], v[52:55], v[8:11]
    ds_read_b128 v[108:111], v164 offset:46080
    v_mfma_f32_16x16x32_bf16 v[12:15], v[112:115], v[52:55], v[12:15]
    ds_read_b128 v[112:115], v164 offset:47104
    s_add_u32 s32, s25, 46080
    buffer_load_dwordx4 v[48:51], v162, s[8:11], s32 offen sc1
    v_mfma_f32_16x16x32_bf16 v[16:19], v[116:119], v[52:55], v[16:19]
    ds_read_b128 v[116:119], v164 offset:48128
    v_mfma_f32_16x16x32_bf16 v[20:23], v[120:123], v[52:55], v[20:23]
    ds_read_b128 v[120:123], v164 offset:49152
    v_mfma_f32_16x16x32_bf16 v[24:27], v[124:127], v[52:55], v[24:27]
    ds_read_b128 v[124:127], v164 offset:50176
    s_waitcnt vmcnt(8) lgkmcnt(6)
    s_waitcnt lgkmcnt(5)
    v_cmp_gt_u32 vcc, s21, v158
    s_cbranch_vccnz L_parallel_sum__grouped_kv_mqa__mixer_gmlp__prompt_oslow_223
L_parallel_sum__grouped_kv_mqa__mixer_gmlp__prompt_ook_224:
    v_mfma_f32_16x16x32_bf16 v[8:11], v[128:131], v[56:59], v[8:11]
    ds_read_b128 v[128:131], v163 offset:5120
    v_mfma_f32_16x16x32_bf16 v[12:15], v[132:135], v[56:59], v[12:15]
    ds_read_b128 v[132:135], v163 offset:6144
    s_add_u32 s32, s25, 47104
    buffer_load_dwordx4 v[52:55], v162, s[8:11], s32 offen sc1
    v_mfma_f32_16x16x32_bf16 v[16:19], v[136:139], v[56:59], v[16:19]
    ds_read_b128 v[136:139], v163 offset:7168
    v_mfma_f32_16x16x32_bf16 v[20:23], v[140:143], v[56:59], v[20:23]
    ds_read_b128 v[140:143], v163 offset:8192
    s_mul_i32 s33, s30, 240640
    s_mul_i32 s34, s20, 10240
    s_add_u32 s33, s33, s34
    s_add_u32 s33, s33, 61440
    s_add_u32 s34, s34, 104960
    s_add_u32 m0, s34, 0
    s_nop 0
    buffer_load_dwordx4 v162, s[12:15], s33 offen offset:0 sc1 lds
    v_mfma_f32_16x16x32_bf16 v[24:27], v[144:147], v[56:59], v[24:27]
    ds_read_b128 v[144:147], v163 offset:9216
    buffer_load_dwordx4 v162, s[12:15], s33 offen offset:1024 sc1 lds
    s_waitcnt vmcnt(10) lgkmcnt(5)
    v_mfma_f32_16x16x32_bf16 v[8:11], v[108:111], v[60:63], v[8:11]
    ds_read_b128 v[108:111], v163 offset:10240
    v_mfma_f32_16x16x32_bf16 v[12:15], v[112:115], v[60:63], v[12:15]
    ds_read_b128 v[112:115], v163 offset:11264
    s_mov_b64 exec, 0x000000ff
    buffer_load_dwordx2 v[160:161], v166, s[72:75], s29 offen sc1
    s_mov_b64 exec, -1
    v_mfma_f32_16x16x32_bf16 v[16:19], v[116:119], v[60:63], v[16:19]
    ds_read_b128 v[116:119], v163 offset:12288
    v_mfma_f32_16x16x32_bf16 v[20:23], v[120:123], v[60:63], v[20:23]
    ds_read_b128 v[120:123], v163 offset:13312
    buffer_load_dwordx4 v162, s[12:15], s33 offen offset:2048 sc1 lds
    v_mfma_f32_16x16x32_bf16 v[24:27], v[124:127], v[60:63], v[24:27]
    ds_read_b128 v[124:127], v163 offset:14336
    buffer_load_dwordx4 v162, s[12:15], s33 offen offset:3072 sc1 lds
    s_waitcnt vmcnt(12) lgkmcnt(5)
    v_mfma_f32_16x16x32_bf16 v[8:11], v[128:131], v[64:67], v[8:11]
    ds_read_b128 v[128:131], v163 offset:15360
    v_mfma_f32_16x16x32_bf16 v[12:15], v[132:135], v[64:67], v[12:15]
    ds_read_b128 v[132:135], v163 offset:16384
    s_add_u32 m0, s34, 4096
    s_add_u32 s33, s33, 4096
    buffer_load_dwordx4 v162, s[12:15], s33 offen offset:0 sc1 lds
    v_mfma_f32_16x16x32_bf16 v[16:19], v[136:139], v[64:67], v[16:19]
    ds_read_b128 v[136:139], v163 offset:17408
    v_mfma_f32_16x16x32_bf16 v[20:23], v[140:143], v[64:67], v[20:23]
    ds_read_b128 v[140:143], v163 offset:18432
    buffer_load_dwordx4 v162, s[12:15], s33 offen offset:1024 sc1 lds
    v_mfma_f32_16x16x32_bf16 v[24:27], v[144:147], v[64:67], v[24:27]
    ds_read_b128 v[144:147], v163 offset:19456
    s_waitcnt vmcnt(13) lgkmcnt(5)
    v_mfma_f32_16x16x32_bf16 v[8:11], v[108:111], v[28:31], v[8:11]
    ds_read_b128 v[108:111], v163 offset:20480
    v_mfma_f32_16x16x32_bf16 v[12:15], v[112:115], v[28:31], v[12:15]
    ds_read_b128 v[112:115], v163 offset:21504
    buffer_load_dwordx4 v162, s[12:15], s33 offen offset:2048 sc1 lds
    v_mfma_f32_16x16x32_bf16 v[16:19], v[116:119], v[28:31], v[16:19]
    ds_read_b128 v[116:119], v163 offset:22528
    v_mfma_f32_16x16x32_bf16 v[20:23], v[120:123], v[28:31], v[20:23]
    ds_read_b128 v[120:123], v163 offset:23552
    buffer_load_dwordx4 v162, s[12:15], s33 offen offset:3072 sc1 lds
    v_mfma_f32_16x16x32_bf16 v[24:27], v[124:127], v[28:31], v[24:27]
    ds_read_b128 v[124:127], v163 offset:24576
    s_waitcnt vmcnt(14) lgkmcnt(5)
    v_mfma_f32_16x16x32_bf16 v[8:11], v[128:131], v[32:35], v[8:11]
    ds_read_b128 v[128:131], v163 offset:25600
    v_mfma_f32_16x16x32_bf16 v[12:15], v[132:135], v[32:35], v[12:15]
    ds_read_b128 v[132:135], v163 offset:26624
    s_add_u32 m0, s34, 8192
    s_add_u32 s33, s33, 4096
    buffer_load_dwordx4 v162, s[12:15], s33 offen offset:0 sc1 lds
    v_mfma_f32_16x16x32_bf16 v[16:19], v[136:139], v[32:35], v[16:19]
    ds_read_b128 v[136:139], v163 offset:27648
    v_mfma_f32_16x16x32_bf16 v[20:23], v[140:143], v[32:35], v[20:23]
    ds_read_b128 v[140:143], v163 offset:28672
    buffer_load_dwordx4 v162, s[12:15], s33 offen offset:1024 sc1 lds
    v_mfma_f32_16x16x32_bf16 v[24:27], v[144:147], v[32:35], v[24:27]
    ds_read_b128 v[144:147], v163 offset:29696
    s_waitcnt vmcnt(15) lgkmcnt(5)
    s_waitcnt vmcnt(8)
    s_mov_b64 exec, 0x000000ff
    v_cmp_ne_u64 vcc, s[96:97], v[160:161]
    s_mov_b64 exec, -1
    s_cmp_eq_u64 vcc, 0
    s_cselect_b32 s28, 1, 0
    v_mfma_f32_16x16x32_bf16 v[8:11], v[108:111], v[36:39], v[8:11]
    ds_read_b128 v[108:111], v163 offset:30720
    v_mfma_f32_16x16x32_bf16 v[12:15], v[112:115], v[36:39], v[12:15]
    ds_read_b128 v[112:115], v163 offset:31744
    s_cmp_eq_u32 s28, 0
    s_cbranch_scc1 L_parallel_sum__grouped_kv_mqa__mixer_gmlp__prompt_oc_225
    s_add_u32 s32, s25, 0
    buffer_load_dwordx4 v[68:71], v162, s[8:11], s32 offen sc1
L_parallel_sum__grouped_kv_mqa__mixer_gmlp__prompt_oc_225:
    v_mfma_f32_16x16x32_bf16 v[16:19], v[116:119], v[36:39], v[16:19]
    ds_read_b128 v[116:119], v163 offset:32768
    v_mfma_f32_16x16x32_bf16 v[20:23], v[120:123], v[36:39], v[20:23]
    ds_read_b128 v[120:123], v163 offset:33792
    s_cmp_eq_u32 s28, 0
    s_cbranch_scc1 L_parallel_sum__grouped_kv_mqa__mixer_gmlp__prompt_oc_226
    s_add_u32 s32, s25, 1024
    buffer_load_dwordx4 v[72:75], v162, s[8:11], s32 offen sc1
L_parallel_sum__grouped_kv_mqa__mixer_gmlp__prompt_oc_226:
    v_mfma_f32_16x16x32_bf16 v[24:27], v[124:127], v[36:39], v[24:27]
    ds_read_b128 v[124:127], v163 offset:34816
    s_waitcnt vmcnt(63) lgkmcnt(5)
    v_mfma_f32_16x16x32_bf16 v[8:11], v[128:131], v[40:43], v[8:11]
    ds_read_b128 v[128:131], v163 offset:35840
    v_mfma_f32_16x16x32_bf16 v[12:15], v[132:135], v[40:43], v[12:15]
    ds_read_b128 v[132:135], v163 offset:36864
    s_cmp_eq_u32 s28, 0
    s_cbranch_scc1 L_parallel_sum__grouped_kv_mqa__mixer_gmlp__prompt_oc_227
    s_add_u32 s32, s25, 2048
    buffer_load_dwordx4 v[76:79], v162, s[8:11], s32 offen sc1
L_parallel_sum__grouped_kv_mqa__mixer_gmlp__prompt_oc_227:
    v_mfma_f32_16x16x32_bf16 v[16:19], v[136:139], v[40:43], v[16:19]
    ds_read_b128 v[136:139], v163 offset:37888
    v_mfma_f32_16x16x32_bf16 v[20:23], v[140:143], v[40:43], v[20:23]
    ds_read_b128 v[140:143], v163 offset:38912
    s_cmp_eq_u32 s28, 0
    s_cbranch_scc1 L_parallel_sum__grouped_kv_mqa__mixer_gmlp__prompt_oc_228
    s_add_u32 s32, s25, 3072
    buffer_load_dwordx4 v[80:83], v162, s[8:11], s32 offen sc1
L_parallel_sum__grouped_kv_mqa__mixer_gmlp__prompt_oc_228:
    v_mfma_f32_16x16x32_bf16 v[24:27], v[144:147], v[40:43], v[24:27]
    ds_read_b128 v[144:147], v163 offset:39936
    s_waitcnt vmcnt(63) lgkmcnt(5)
    v_mfma_f32_16x16x32_bf16 v[8:11], v[108:111], v[44:47], v[8:11]
    ds_read_b128 v[108:111], v163 offset:40960
    v_mfma_f32_16x16x32_bf16 v[12:15], v[112:115], v[44:47], v[12:15]
    ds_read_b128 v[112:115], v163 offset:41984
    s_cmp_eq_u32 s28, 0
    s_cbranch_scc1 L_parallel_sum__grouped_kv_mqa__mixer_gmlp__prompt_oc_229
    s_add_u32 s32, s25, 4096
    buffer_load_dwordx4 v[84:87], v162, s[8:11], s32 offen sc1
L_parallel_sum__grouped_kv_mqa__mixer_gmlp__prompt_oc_229:
    v_mfma_f32_16x16x32_bf16 v[16:19], v[116:119], v[44:47], v[16:19]
    ds_read_b128 v[116:119], v163 offset:43008
    v_mfma_f32_16x16x32_bf16 v[20:23], v[120:123], v[44:47], v[20:23]
    ds_read_b128 v[120:123], v163 offset:44032
    s_cmp_eq_u32 s28, 0
    s_cbranch_scc1 L_parallel_sum__grouped_kv_mqa__mixer_gmlp__prompt_oc_230
    s_add_u32 s32, s25, 5120
    buffer_load_dwordx4 v[88:91], v162, s[8:11], s32 offen sc1
L_parallel_sum__grouped_kv_mqa__mixer_gmlp__prompt_oc_230:
    v_mfma_f32_16x16x32_bf16 v[24:27], v[124:127], v[44:47], v[24:27]
    ds_read_b128 v[124:127], v163 offset:45056
    s_waitcnt vmcnt(63) lgkmcnt(5)
    v_mfma_f32_16x16x32_bf16 v[8:11], v[128:131], v[48:51], v[8:11]
    v_mfma_f32_16x16x32_bf16 v[12:15], v[132:135], v[48:51], v[12:15]
    s_cmp_eq_u32 s28, 0
    s_cbranch_scc1 L_parallel_sum__grouped_kv_mqa__mixer_gmlp__prompt_oc_231
    s_add_u32 s32, s25, 6144
    buffer_load_dwordx4 v[92:95], v162, s[8:11], s32 offen sc1
L_parallel_sum__grouped_kv_mqa__mixer_gmlp__prompt_oc_231:
    v_mfma_f32_16x16x32_bf16 v[16:19], v[136:139], v[48:51], v[16:19]
    v_mfma_f32_16x16x32_bf16 v[20:23], v[140:143], v[48:51], v[20:23]
    s_cmp_eq_u32 s28, 0
    s_cbranch_scc1 L_parallel_sum__grouped_kv_mqa__mixer_gmlp__prompt_oc_232
    s_add_u32 s32, s25, 7168
    buffer_load_dwordx4 v[96:99], v162, s[8:11], s32 offen sc1
L_parallel_sum__grouped_kv_mqa__mixer_gmlp__prompt_oc_232:
    v_mfma_f32_16x16x32_bf16 v[24:27], v[144:147], v[48:51], v[24:27]
    s_waitcnt vmcnt(63) lgkmcnt(0)
    v_mfma_f32_16x16x32_bf16 v[8:11], v[108:111], v[52:55], v[8:11]
    v_mfma_f32_16x16x32_bf16 v[12:15], v[112:115], v[52:55], v[12:15]
    s_cmp_eq_u32 s28, 0
    s_cbranch_scc1 L_parallel_sum__grouped_kv_mqa__mixer_gmlp__prompt_oc_233
    s_add_u32 s32, s25, 8192
    buffer_load_dwordx4 v[100:103], v162, s[8:11], s32 offen sc1
L_parallel_sum__grouped_kv_mqa__mixer_gmlp__prompt_oc_233:
    v_mfma_f32_16x16x32_bf16 v[16:19], v[116:119], v[52:55], v[16:19]
    v_mfma_f32_16x16x32_bf16 v[20:23], v[120:123], v[52:55], v[20:23]
    s_cmp_eq_u32 s28, 0
    s_cbranch_scc1 L_parallel_sum__grouped_kv_mqa__mixer_gmlp__prompt_oc_234
    s_add_u32 s32, s25, 9216
    buffer_load_dwordx4 v[104:107], v162, s[8:11], s32 offen sc1
L_parallel_sum__grouped_kv_mqa__mixer_gmlp__prompt_oc_234:
    v_mfma_f32_16x16x32_bf16 v[24:27], v[124:127], v[52:55], v[24:27]
    s_cmp_eq_u32 s28, 0
    s_cbranch_scc1 L_parallel_sum__grouped_kv_mqa__mixer_gmlp__prompt_olate_235
L_parallel_sum__grouped_kv_mqa__mixer_gmlp__prompt_ojoin_236:
    v_mov_b32 v158, 163376
L_parallel_sum__grouped_kv_mqa__mixer_gmlp__prompt_lw_237:
    ds_read_b32 v159, v158
    s_waitcnt lgkmcnt(0)
    v_cmp_gt_u32 vcc, 10, v159
    s_cbranch_vccz L_parallel_sum__grouped_kv_mqa__mixer_gmlp__prompt_lwd_238
    s_sleep 1
    s_sub_u32 s70, s70, 1
    s_cbranch_scc0 L_parallel_sum__grouped_kv_mqa__mixer_gmlp__prompt_lw_237
L_parallel_sum__grouped_kv_mqa__mixer_gmlp__prompt_lwd_238:
    s_setprio 3
    ds_read_b128 v[108:111], v162 offset:0
    ds_read_b128 v[112:115], v162 offset:1024
    ds_read_b128 v[116:119], v162 offset:2048
    ds_read_b128 v[120:123], v162 offset:3072
    ds_read_b128 v[124:127], v162 offset:4096
    ds_read_b128 v[128:131], v162 offset:5120
    ds_read_b128 v[132:135], v162 offset:6144
    ds_read_b128 v[136:139], v162 offset:7168
    ds_read_b128 v[140:143], v162 offset:8192
    ds_read_b128 v[144:147], v162 offset:9216
    s_waitcnt vmcnt(9) lgkmcnt(5)
    v_mfma_f32_16x16x32_bf16 v[8:11], v[108:111], v[68:71], v[8:11]
    ds_read_b128 v[108:111], v162 offset:10240
    v_mfma_f32_16x16x32_bf16 v[12:15], v[112:115], v[68:71], v[12:15]
    ds_read_b128 v[112:115], v162 offset:11264
    s_add_u32 s32, s25, 10240
    buffer_load_dwordx4 v[28:31], v162, s[8:11], s32 offen sc1
    v_mfma_f32_16x16x32_bf16 v[16:19], v[116:119], v[68:71], v[16:19]
    ds_read_b128 v[116:119], v162 offset:12288
    v_mfma_f32_16x16x32_bf16 v[20:23], v[120:123], v[68:71], v[20:23]
    ds_read_b128 v[120:123], v162 offset:13312
    s_add_u32 s32, s25, 11264
    buffer_load_dwordx4 v[32:35], v162, s[8:11], s32 offen sc1
    v_mfma_f32_16x16x32_bf16 v[24:27], v[124:127], v[68:71], v[24:27]
    ds_read_b128 v[124:127], v162 offset:14336
    s_waitcnt vmcnt(10) lgkmcnt(5)
    v_mfma_f32_16x16x32_bf16 v[8:11], v[128:131], v[72:75], v[8:11]
    ds_read_b128 v[128:131], v162 offset:15360
    v_mfma_f32_16x16x32_bf16 v[12:15], v[132:135], v[72:75], v[12:15]
    ds_read_b128 v[132:135], v162 offset:16384
    s_add_u32 s32, s25, 12288
    buffer_load_dwordx4 v[36:39], v162, s[8:11], s32 offen sc1
    v_mfma_f32_16x16x32_bf16 v[16:19], v[136:139], v[72:75], v[16:19]
    ds_read_b128 v[136:139], v162 offset:17408
    v_mfma_f32_16x16x32_bf16 v[20:23], v[140:143], v[72:75], v[20:23]
    ds_read_b128 v[140:143], v162 offset:18432
    s_add_u32 s32, s25, 13312
    buffer_load_dwordx4 v[40:43], v162, s[8:11], s32 offen sc1
    v_mfma_f32_16x16x32_bf16 v[24:27], v[144:147], v[72:75], v[24:27]
    ds_read_b128 v[144:147], v162 offset:19456
    s_waitcnt vmcnt(11) lgkmcnt(5)
    v_mfma_f32_16x16x32_bf16 v[8:11], v[108:111], v[76:79], v[8:11]
    ds_read_b128 v[108:111], v162 offset:20480
    v_mfma_f32_16x16x32_bf16 v[12:15], v[112:115], v[76:79], v[12:15]
    ds_read_b128 v[112:115], v162 offset:21504
    s_add_u32 s32, s25, 14336
    buffer_load_dwordx4 v[44:47], v162, s[8:11], s32 offen sc1
    v_mfma_f32_16x16x32_bf16 v[16:19], v[116:119], v[76:79], v[16:19]
    ds_read_b128 v[116:119], v162 offset:22528
    v_mfma_f32_16x16x32_bf16 v[20:23], v[120:123], v[76:79], v[20:23]
    ds_read_b128 v[120:123], v162 offset:23552
    s_add_u32 s32, s25, 15360
    buffer_load_dwordx4 v[48:51], v162, s[8:11], s32 offen sc1
    v_mfma_f32_16x16x32_bf16 v[24:27], v[124:127], v[76:79], v[24:27]
    ds_read_b128 v[124:127], v162 offset:24576
    s_waitcnt vmcnt(12) lgkmcnt(5)
    v_mfma_f32_16x16x32_bf16 v[8:11], v[128:131], v[80:83], v[8:11]
    ds_read_b128 v[128:131], v162 offset:25600
    v_mfma_f32_16x16x32_bf16 v[12:15], v[132:135], v[80:83], v[12:15]
    ds_read_b128 v[132:135], v162 offset:26624
    s_add_u32 s32, s25, 16384
    buffer_load_dwordx4 v[52:55], v162, s[8:11], s32 offen sc1
    v_mfma_f32_16x16x32_bf16 v[16:19], v[136:139], v[80:83], v[16:19]
    ds_read_b128 v[136:139], v162 offset:27648
    v_mfma_f32_16x16x32_bf16 v[20:23], v[140:143], v[80:83], v[20:23]
    ds_read_b128 v[140:143], v162 offset:28672
    s_add_u32 s32, s25, 17408
    buffer_load_dwordx4 v[56:59], v162, s[8:11], s32 offen sc1
    v_mfma_f32_16x16x32_bf16 v[24:27], v[144:147], v[80:83], v[24:27]
    ds_read_b128 v[144:147], v162 offset:29696
    s_waitcnt vmcnt(13) lgkmcnt(5)
    v_mfma_f32_16x16x32_bf16 v[8:11], v[108:111], v[84:87], v[8:11]
    ds_read_b128 v[108:111], v162 offset:30720
    v_mfma_f32_16x16x32_bf16 v[12:15], v[112:115], v[84:87], v[12:15]
    ds_read_b128 v[112:115], v162 offset:31744
    s_add_u32 s32, s25, 18432
    buffer_load_dwordx4 v[60:63], v162, s[8:11], s32 offen sc1
    v_mfma_f32_16x16x32_bf16 v[16:19], v[116:119], v[84:87], v[16:19]
    ds_read_b128 v[116:119], v162 offset:32768
    v_mfma_f32_16x16x32_bf16 v[20:23], v[120:123], v[84:87], v[20:23]
    ds_read_b128 v[120:123], v162 offset:33792
    s_add_u32 s32, s25, 19456
    buffer_load_dwordx4 v[64:67], v162, s[8:11], s32 offen sc1
    v_mfma_f32_16x16x32_bf16 v[24:27], v[124:127], v[84:87], v[24:27]
    ds_read_b128 v[124:127], v162 offset:34816
    s_waitcnt vmcnt(14) lgkmcnt(5)
    v_mfma_f32_16x16x32_bf16 v[8:11], v[128:131], v[88:91], v[8:11]
    ds_read_b128 v[128:131], v162 offset:35840
    v_mfma_f32_16x16x32_bf16 v[12:15], v[132:135], v[88:91], v[12:15]
    ds_read_b128 v[132:135], v162 offset:36864
    v_mfma_f32_16x16x32_bf16 v[16:19], v[136:139], v[88:91], v[16:19]
    ds_read_b128 v[136:139], v162 offset:37888
    v_mfma_f32_16x16x32_bf16 v[20:23], v[140:143], v[88:91], v[20:23]
    ds_read_b128 v[140:143], v162 offset:38912
    v_mfma_f32_16x16x32_bf16 v[24:27], v[144:147], v[88:91], v[24:27]
    ds_read_b128 v[144:147], v162 offset:39936
    s_waitcnt vmcnt(13) lgkmcnt(5)
    s_waitcnt vmcnt(20)
    s_add_u32 s21, s21, 1
    v_mov_b32_e64 v4, s21
    ds_write_b32 v5, v4
    v_mfma_f32_16x16x32_bf16 v[8:11], v[108:111], v[92:95], v[8:11]
    ds_read_b128 v[108:111], v162 offset:40960
    v_mfma_f32_16x16x32_bf16 v[12:15], v[112:115], v[92:95], v[12:15]
    ds_read_b128 v[112:115], v162 offset:41984
    v_mfma_f32_16x16x32_bf16 v[16:19], v[116:119], v[92:95], v[16:19]
    ds_read_b128 v[116:119], v162 offset:43008
    v_mfma_f32_16x16x32_bf16 v[20:23], v[120:123], v[92:95], v[20:23]
    ds_read_b128 v[120:123], v162 offset:44032
    v_mfma_f32_16x16x32_bf16 v[24:27], v[124:127], v[92:95], v[24:27]
    ds_read_b128 v[124:127], v162 offset:45056
    s_waitcnt vmcnt(12) lgkmcnt(6)
    v_mfma_f32_16x16x32_bf16 v[8:11], v[128:131], v[96:99], v[8:11]
    ds_read_b128 v[128:131], v162 offset:46080
    v_mfma_f32_16x16x32_bf16 v[12:15], v[132:135], v[96:99], v[12:15]
    ds_read_b128 v[132:135], v162 offset:47104
    v_mfma_f32_16x16x32_bf16 v[16:19], v[136:139], v[96:99], v[16:19]
    ds_read_b128 v[136:139], v162 offset:48128
    v_mfma_f32_16x16x32_bf16 v[20:23], v[140:143], v[96:99], v[20:23]
    ds_read_b128 v[140:143], v162 offset:49152
    v_mfma_f32_16x16x32_bf16 v[24:27], v[144:147], v[96:99], v[24:27]
    ds_read_b128 v[144:147], v162 offset:50176
    s_waitcnt vmcnt(11) lgkmcnt(5)
    ds_read_b32 v158, v6
    v_mfma_f32_16x16x32_bf16 v[8:11], v[108:111], v[100:103], v[8:11]
    ds_read_b128 v[108:111], v162 offset:51200
    v_mfma_f32_16x16x32_bf16 v[12:15], v[112:115], v[100:103], v[12:15]
    ds_read_b128 v[112:115], v162 offset:52224
    v_mfma_f32_16x16x32_bf16 v[16:19], v[116:119], v[100:103], v[16:19]
    ds_read_b128 v[116:119], v162 offset:53248
    v_mfma_f32_16x16x32_bf16 v[20:23], v[120:123], v[100:103], v[20:23]
    ds_read_b128 v[120:123], v162 offset:54272
    v_mfma_f32_16x16x32_bf16 v[24:27], v[124:127], v[100:103], v[24:27]
    ds_read_b128 v[124:127], v162 offset:55296
    s_waitcnt vmcnt(10) lgkmcnt(6)
    s_waitcnt lgkmcnt(5)
    v_cmp_gt_u32 vcc, s21, v158
    s_cbranch_vccnz L_parallel_sum__grouped_kv_mqa__mixer_gmlp__prompt_oslow_239
L_parallel_sum__grouped_kv_mqa__mixer_gmlp__prompt_ook_240:
    v_mfma_f32_16x16x32_bf16 v[8:11], v[128:131], v[104:107], v[8:11]
    ds_read_b128 v[128:131], v162 offset:56320
    v_mfma_f32_16x16x32_bf16 v[12:15], v[132:135], v[104:107], v[12:15]
    ds_read_b128 v[132:135], v162 offset:57344
    v_mfma_f32_16x16x32_bf16 v[16:19], v[136:139], v[104:107], v[16:19]
    ds_read_b128 v[136:139], v162 offset:58368
    v_mfma_f32_16x16x32_bf16 v[20:23], v[140:143], v[104:107], v[20:23]
    ds_read_b128 v[140:143], v162 offset:59392
    v_mfma_f32_16x16x32_bf16 v[24:27], v[144:147], v[104:107], v[24:27]
    ds_read_b128 v[144:147], v162 offset:60416
    s_waitcnt vmcnt(9) lgkmcnt(5)
    v_mfma_f32_16x16x32_bf16 v[8:11], v[108:111], v[28:31], v[8:11]
    ds_read_b128 v[108:111], v163 offset:46080
    v_mfma_f32_16x16x32_bf16 v[12:15], v[112:115], v[28:31], v[12:15]
    ds_read_b128 v[112:115], v163 offset:47104
    v_mfma_f32_16x16x32_bf16 v[16:19], v[116:119], v[28:31], v[16:19]
    ds_read_b128 v[116:119], v163 offset:48128
    v_mfma_f32_16x16x32_bf16 v[20:23], v[120:123], v[28:31], v[20:23]
    ds_read_b128 v[120:123], v163 offset:49152
    v_mfma_f32_16x16x32_bf16 v[24:27], v[124:127], v[28:31], v[24:27]
    ds_read_b128 v[124:127], v163 offset:50176
    s_waitcnt vmcnt(8) lgkmcnt(5)
    v_mfma_f32_16x16x32_bf16 v[8:11], v[128:131], v[32:35], v[8:11]
    ds_read_b128 v[128:131], v164 offset:0
    v_mfma_f32_16x16x32_bf16 v[12:15], v[132:135], v[32:35], v[12:15]
    ds_read_b128 v[132:135], v164 offset:1024
    v_mfma_f32_16x16x32_bf16 v[16:19], v[136:139], v[32:35], v[16:19]
    ds_read_b128 v[136:139], v164 offset:2048
    v_mfma_f32_16x16x32_bf16 v[20:23], v[140:143], v[32:35], v[20:23]
    ds_read_b128 v[140:143], v164 offset:3072
    v_mfma_f32_16x16x32_bf16 v[24:27], v[144:147], v[32:35], v[24:27]
    ds_read_b128 v[144:147], v164 offset:4096
    s_waitcnt vmcnt(7) lgkmcnt(5)
    v_mfma_f32_16x16x32_bf16 v[8:11], v[108:111], v[36:39], v[8:11]
    ds_read_b128 v[108:111], v164 offset:5120
    v_mfma_f32_16x16x32_bf16 v[12:15], v[112:115], v[36:39], v[12:15]
    ds_read_b128 v[112:115], v164 offset:6144
    v_mfma_f32_16x16x32_bf16 v[16:19], v[116:119], v[36:39], v[16:19]
    ds_read_b128 v[116:119], v164 offset:7168
    v_mfma_f32_16x16x32_bf16 v[20:23], v[120:123], v[36:39], v[20:23]
    ds_read_b128 v[120:123], v164 offset:8192
    v_mfma_f32_16x16x32_bf16 v[24:27], v[124:127], v[36:39], v[24:27]
    ds_read_b128 v[124:127], v164 offset:9216
    s_waitcnt vmcnt(6) lgkmcnt(5)
    v_mfma_f32_16x16x32_bf16 v[8:11], v[128:131], v[40:43], v[8:11]
    ds_read_b128 v[128:131], v164 offset:10240
    v_mfma_f32_16x16x32_bf16 v[12:15], v[132:135], v[40:43], v[12:15]
    ds_read_b128 v[132:135], v164 offset:11264
    v_mfma_f32_16x16x32_bf16 v[16:19], v[136:139], v[40:43], v[16:19]
    ds_read_b128 v[136:139], v164 offset:12288
    v_mfma_f32_16x16x32_bf16 v[20:23], v[140:143], v[40:43], v[20:23]
    ds_read_b128 v[140:143], v164 offset:13312
    v_mfma_f32_16x16x32_bf16 v[24:27], v[144:147], v[40:43], v[24:27]
    ds_read_b128 v[144:147], v164 offset:14336
    s_waitcnt vmcnt(5) lgkmcnt(5)
    v_mfma_f32_16x16x32_bf16 v[8:11], v[108:111], v[44:47], v[8:11]
    ds_read_b128 v[108:111], v164 offset:15360
    v_mfma_f32_16x16x32_bf16 v[12:15], v[112:115], v[44:47], v[12:15]
    ds_read_b128 v[112:115], v164 offset:16384
    v_mfma_f32_16x16x32_bf16 v[16:19], v[116:119], v[44:47], v[16:19]
    ds_read_b128 v[116:119], v164 offset:17408
    v_mfma_f32_16x16x32_bf16 v[20:23], v[120:123], v[44:47], v[20:23]
    ds_read_b128 v[120:123], v164 offset:18432
    v_mfma_f32_16x16x32_bf16 v[24:27], v[124:127], v[44:47], v[24:27]
    ds_read_b128 v[124:127], v164 offset:19456
    s_waitcnt vmcnt(4) lgkmcnt(5)
    v_mfma_f32_16x16x32_bf16 v[8:11], v[128:131], v[48:51], v[8:11]
    ds_read_b128 v[128:131], v164 offset:20480
    v_mfma_f32_16x16x32_bf16 v[12:15], v[132:135], v[48:51], v[12:15]
    ds_read_b128 v[132:135], v164 offset:21504
    v_mfma_f32_16x16x32_bf16 v[16:19], v[136:139], v[48:51], v[16:19]
    ds_read_b128 v[136:139], v164 offset:22528
    v_mfma_f32_16x16x32_bf16 v[20:23], v[140:143], v[48:51], v[20:23]
    ds_read_b128 v[140:143], v164 offset:23552
    v_mfma_f32_16x16x32_bf16 v[24:27], v[144:147], v[48:51], v[24:27]
    ds_read_b128 v[144:147], v164 offset:24576
    s_waitcnt vmcnt(3) lgkmcnt(5)
    v_mfma_f32_16x16x32_bf16 v[8:11], v[108:111], v[52:55], v[8:11]
    ds_read_b128 v[108:111], v164 offset:25600
    v_mfma_f32_16x16x32_bf16 v[12:15], v[112:115], v[52:55], v[12:15]
    ds_read_b128 v[112:115], v164 offset:26624
    v_mfma_f32_16x16x32_bf16 v[16:19], v[116:119], v[52:55], v[16:19]
    ds_read_b128 v[116:119], v164 offset:27648
    v_mfma_f32_16x16x32_bf16 v[20:23], v[120:123], v[52:55], v[20:23]
    ds_read_b128 v[120:123], v164 offset:28672
    v_mfma_f32_16x16x32_bf16 v[24:27], v[124:127], v[52:55], v[24:27]
    ds_read_b128 v[124:127], v164 offset:29696
    s_waitcnt vmcnt(2) lgkmcnt(5)
    v_mfma_f32_16x16x32_bf16 v[8:11], v[128:131], v[56:59], v[8:11]
    ds_read_b128 v[128:131], v164 offset:30720
    v_mfma_f32_16x16x32_bf16 v[12:15], v[132:135], v[56:59], v[12:15]
    ds_read_b128 v[132:135], v164 offset:31744
    v_mfma_f32_16x16x32_bf16 v[16:19], v[136:139], v[56:59], v[16:19]
    ds_read_b128 v[136:139], v164 offset:32768
    v_mfma_f32_16x16x32_bf16 v[20:23], v[140:143], v[56:59], v[20:23]
    ds_read_b128 v[140:143], v164 offset:33792
    v_mfma_f32_16x16x32_bf16 v[24:27], v[144:147], v[56:59], v[24:27]
    ds_read_b128 v[144:147], v164 offset:34816
    s_waitcnt vmcnt(1) lgkmcnt(5)
    v_mfma_f32_16x16x32_bf16 v[8:11], v[108:111], v[60:63], v[8:11]
    v_mfma_f32_16x16x32_bf16 v[12:15], v[112:115], v[60:63], v[12:15]
    v_mfma_f32_16x16x32_bf16 v[16:19], v[116:119], v[60:63], v[16:19]
    v_mfma_f32_16x16x32_bf16 v[20:23], v[120:123], v[60:63], v[20:23]
    v_mfma_f32_16x16x32_bf16 v[24:27], v[124:127], v[60:63], v[24:27]
    s_waitcnt vmcnt(0) lgkmcnt(0)
    v_mfma_f32_16x16x32_bf16 v[8:11], v[128:131], v[64:67], v[8:11]
    v_mfma_f32_16x16x32_bf16 v[12:15], v[132:135], v[64:67], v[12:15]
    v_mfma_f32_16x16x32_bf16 v[16:19], v[136:139], v[64:67], v[16:19]
    v_mfma_f32_16x16x32_bf16 v[20:23], v[140:143], v[64:67], v[20:23]
    v_mfma_f32_16x16x32_bf16 v[24:27], v[144:147], v[64:67], v[24:27]
    s_mov_b32 s16, s64
    s_mov_b32 s17, s65
    s_mov_b32 s18, 0x00280000
    s_mov_b32 s19, 0x00020000
    s_mov_b32 s32, 0xffff0000
    v_lshlrev_b32 v108, 16, v148
    v_and_b32 v109, s32, v148
    v_lshlrev_b32 v110, 16, v149
    v_and_b32 v111, s32, v149
    v_lshlrev_b32 v112, 16, v150
    v_and_b32 v113, s32, v150
    v_lshlrev_b32 v114, 16, v151
    v_and_b32 v115, s32, v151
    v_lshlrev_b32 v116, 16, v152
    v_and_b32 v117, s32, v152
    v_lshlrev_b32 v118, 16, v153
    v_and_b32 v119, s32, v153
    v_lshlrev_b32 v120, 16, v154
    v_and_b32 v121, s32, v154
    v_lshlrev_b32 v122, 16, v155
    v_and_b32 v123, s32, v155
    v_lshlrev_b32 v124, 16, v156
    v_and_b32 v125, s32, v156
    v_lshlrev_b32 v126, 16, v157
    v_and_b32 v127, s32, v157
    v_add_f32 v108, v108, v8
    v_add_f32 v109, v109, v9
    v_add_f32 v110, v110, v10
    v_add_f32 v111, v111, v11
    v_add_f32 v112, v112, v12
    v_add_f32 v113, v113, v13
    v_add_f32 v114, v114, v14
    v_add_f32 v115, v115, v15
    v_add_f32 v116, v116, v16
    v_add_f32 v117, v117, v17
    v_add_f32 v118, v118, v18
    v_add_f32 v119, v119, v19
    v_add_f32 v120, v120, v20
    v_add_f32 v121, v121, v21
    v_add_f32 v122, v122, v22
    v_add_f32 v123, v123, v23
    v_add_f32 v124, v124, v24
    v_add_f32 v125, v125, v25
    v_add_f32 v126, v126, v26
    v_add_f32 v127, v127, v27
    v_cvt_pk_bf16_f32 v148, v108, v109
    v_cvt_pk_bf16_f32 v149, v110, v111
    v_cvt_pk_bf16_f32 v150, v112, v113
    v_cvt_pk_bf16_f32 v151, v114, v115
    v_cvt_pk_bf16_f32 v152, v116, v117
    v_cvt_pk_bf16_f32 v153, v118, v119
    v_cvt_pk_bf16_f32 v154, v120, v121
    v_cvt_pk_bf16_f32 v155, v122, v123
    v_cvt_pk_bf16_f32 v156, v124, v125
    v_cvt_pk_bf16_f32 v157, v126, v127
    buffer_store_dwordx2 v[148:149], v165, s[16:19], s26 offen offset:0
    buffer_store_dwordx2 v[150:151], v165, s[16:19], s26 offen offset:32
    buffer_store_dwordx2 v[152:153], v165, s[16:19], s26 offen offset:64
    buffer_store_dwordx2 v[154:155], v165, s[16:19], s26 offen offset:96
    buffer_store_dwordx2 v[156:157], v165, s[16:19], s26 offen offset:128
    s_or_b32 s32, s2, s20
    s_cbranch_scc1 L_parallel_sum__grouped_kv_mqa__mixer_gmlp__prompt_ne_241
    s_mov_b32 s32, 0x00080000
    v_mov_b32 v158, s96
    v_mov_b32 v159, s97
    v_lshlrev_b32_e64 v166, 3, v1
    s_mov_b64 exec, 0xffff
    buffer_store_dwordx2 v[158:159], v166, s[72:75], s32 offen sc1
    s_mov_b64 exec, -1
L_parallel_sum__grouped_kv_mqa__mixer_gmlp__prompt_ne_241:
    s_endpgm
L_parallel_sum__grouped_kv_mqa__mixer_gmlp__prompt_olate_235:
L_parallel_sum__grouped_kv_mqa__mixer_gmlp__prompt_pb_242:
    s_mov_b64 exec, 0x000000ff
    buffer_load_dwordx2 v[158:159], v166, s[72:75], s29 offen sc1
    s_mov_b64 exec, -1
    s_waitcnt vmcnt(0)
    s_mov_b64 exec, 0x000000ff
    v_cmp_ne_u64 vcc, s[96:97], v[158:159]
    s_mov_b64 exec, -1
    s_cbranch_vccz L_parallel_sum__grouped_kv_mqa__mixer_gmlp__prompt_pbd_243
    s_sleep 1
    s_sub_u32 s70, s70, 1
    s_cbranch_scc0 L_parallel_sum__grouped_kv_mqa__mixer_gmlp__prompt_pb_242
L_parallel_sum__grouped_kv_mqa__mixer_gmlp__prompt_pbd_243:
    s_add_u32 s32, s25, 0
    buffer_load_dwordx4 v[68:71], v162, s[8:11], s32 offen sc1
    s_add_u32 s32, s25, 1024
    buffer_load_dwordx4 v[72:75], v162, s[8:11], s32 offen sc1
    s_add_u32 s32, s25, 2048
    buffer_load_dwordx4 v[76:79], v162, s[8:11], s32 offen sc1
    s_add_u32 s32, s25, 3072
    buffer_load_dwordx4 v[80:83], v162, s[8:11], s32 offen sc1
    s_add_u32 s32, s25, 4096
    buffer_load_dwordx4 v[84:87], v162, s[8:11], s32 offen sc1
    s_add_u32 s32, s25, 5120
    buffer_load_dwordx4 v[88:91], v162, s[8:11], s32 offen sc1
    s_add_u32 s32, s25, 6144
    buffer_load_dwordx4 v[92:95], v162, s[8:11], s32 offen sc1
    s_add_u32 s32, s25, 7168
    buffer_load_dwordx4 v[96:99], v162, s[8:11], s32 offen sc1
    s_add_u32 s32, s25, 8192
    buffer_load_dwordx4 v[100:103], v162, s[8:11], s32 offen sc1
    s_add_u32 s32, s25, 9216
    buffer_load_dwordx4 v[104:107], v162, s[8:11], s32 offen sc1
    s_branch L_parallel_sum__grouped_kv_mqa__mixer_gmlp__prompt_ojoin_236
L_parallel_sum__grouped_kv_mqa__mixer_gmlp__prompt_oslow_221:
L_parallel_sum__grouped_kv_mqa__mixer_gmlp__prompt_gspin_244:
    ds_read_b32 v4, v6
    s_waitcnt lgkmcnt(0)
    v_cmp_gt_u32 vcc, s21, v4
    s_cbranch_vccz L_parallel_sum__grouped_kv_mqa__mixer_gmlp__prompt_gspun_245
    s_sleep 1
    s_sub_u32 s70, s70, 1
    s_cbranch_scc0 L_parallel_sum__grouped_kv_mqa__mixer_gmlp__prompt_gspin_244
L_parallel_sum__grouped_kv_mqa__mixer_gmlp__prompt_gspun_245:
    s_branch L_parallel_sum__grouped_kv_mqa__mixer_gmlp__prompt_ook_222
L_parallel_sum__grouped_kv_mqa__mixer_gmlp__prompt_oslow_223:
L_parallel_sum__grouped_kv_mqa__mixer_gmlp__prompt_gspin_246:
    ds_read_b32 v4, v6
    s_waitcnt lgkmcnt(0)
    v_cmp_gt_u32 vcc, s21, v4
    s_cbranch_vccz L_parallel_sum__grouped_kv_mqa__mixer_gmlp__prompt_gspun_247
    s_sleep 1
    s_sub_u32 s70, s70, 1
    s_cbranch_scc0 L_parallel_sum__grouped_kv_mqa__mixer_gmlp__prompt_gspin_246
L_parallel_sum__grouped_kv_mqa__mixer_gmlp__prompt_gspun_247:
    s_branch L_parallel_sum__grouped_kv_mqa__mixer_gmlp__prompt_ook_224
L_parallel_sum__grouped_kv_mqa__mixer_gmlp__prompt_oslow_239:
L_parallel_sum__grouped_kv_mqa__mixer_gmlp__prompt_gspin_248:
    ds_read_b32 v4, v6
    s_waitcnt lgkmcnt(0)
    v_cmp_gt_u32 vcc, s21, v4
    s_cbranch_vccz L_parallel_sum__grouped_kv_mqa__mixer_gmlp__prompt_gspun_249
    s_sleep 1
    s_sub_u32 s70, s70, 1
    s_cbranch_scc0 L_parallel_sum__grouped_kv_mqa__mixer_gmlp__prompt_gspin_248
L_parallel_sum__grouped_kv_mqa__mixer_gmlp__prompt_gspun_249:
    s_branch L_parallel_sum__grouped_kv_mqa__mixer_gmlp__prompt_ook_240
L_parallel_sum__grouped_kv_mqa__mixer_gmlp__prompt_gslow_103:
L_parallel_sum__grouped_kv_mqa__mixer_gmlp__prompt_gspin_250:
    ds_read_b32 v4, v3
    s_waitcnt lgkmcnt(0)
    v_cmp_gt_u32 vcc, 8, v4
    s_cbranch_vccz L_parallel_sum__grouped_kv_mqa__mixer_gmlp__prompt_gspun_251
    s_sleep 1
    s_sub_u32 s70, s70, 1
    s_cbranch_scc0 L_parallel_sum__grouped_kv_mqa__mixer_gmlp__prompt_gspin_250
L_parallel_sum__grouped_kv_mqa__mixer_gmlp__prompt_gspun_251:
    s_branch L_parallel_sum__grouped_kv_mqa__mixer_gmlp__prompt_gok_102
L_parallel_sum__grouped_kv_mqa__mixer_gmlp__prompt_gslow_105:
L_parallel_sum__grouped_kv_mqa__mixer_gmlp__prompt_gspin_252:
    ds_read_b32 v4, v3
    s_waitcnt lgkmcnt(0)
    v_cmp_gt_u32 vcc, 9, v4
    s_cbranch_vccz L_parallel_sum__grouped_kv_mqa__mixer_gmlp__prompt_gspun_253
    s_sleep 1
    s_sub_u32 s70, s70, 1
    s_cbranch_scc0 L_parallel_sum__grouped_kv_mqa__mixer_gmlp__prompt_gspin_252
L_parallel_sum__grouped_kv_mqa__mixer_gmlp__prompt_gspun_253:
    s_branch L_parallel_sum__grouped_kv_mqa__mixer_gmlp__prompt_gok_104
L_parallel_sum__grouped_kv_mqa__mixer_gmlp__prompt_gslow_107:
L_parallel_sum__grouped_kv_mqa__mixer_gmlp__prompt_gspin_254:
    ds_read_b32 v4, v3
    s_waitcnt lgkmcnt(0)
    v_cmp_gt_u32 vcc, 10, v4
    s_cbranch_vccz L_parallel_sum__grouped_kv_mqa__mixer_gmlp__prompt_gspun_255
    s_sleep 1
    s_sub_u32 s70, s70, 1
    s_cbranch_scc0 L_parallel_sum__grouped_kv_mqa__mixer_gmlp__prompt_gspin_254
L_parallel_sum__grouped_kv_mqa__mixer_gmlp__prompt_gspun_255:
    s_branch L_parallel_sum__grouped_kv_mqa__mixer_gmlp__prompt_gok_106
L_parallel_sum__grouped_kv_mqa__mixer_gmlp__prompt_gslow_109:
L_parallel_sum__grouped_kv_mqa__mixer_gmlp__prompt_gspin_256:
    ds_read_b32 v4, v3
    s_waitcnt lgkmcnt(0)
    v_cmp_gt_u32 vcc, 11, v4
    s_cbranch_vccz L_parallel_sum__grouped_kv_mqa__mixer_gmlp__prompt_gspun_257
    s_sleep 1
    s_sub_u32 s70, s70, 1
    s_cbranch_scc0 L_parallel_sum__grouped_kv_mqa__mixer_gmlp__prompt_gspin_256
L_parallel_sum__grouped_kv_mqa__mixer_gmlp__prompt_gspun_257:
    s_branch L_parallel_sum__grouped_kv_mqa__mixer_gmlp__prompt_gok_108
L_parallel_sum__grouped_kv_mqa__mixer_gmlp__prompt_gslow_111:
L_parallel_sum__grouped_kv_mqa__mixer_gmlp__prompt_gspin_258:
    ds_read_b32 v4, v3
    s_waitcnt lgkmcnt(0)
    v_cmp_gt_u32 vcc, 12, v4
    s_cbranch_vccz L_parallel_sum__grouped_kv_mqa__mixer_gmlp__prompt_gspun_259
    s_sleep 1
    s_sub_u32 s70, s70, 1
    s_cbranch_scc0 L_parallel_sum__grouped_kv_mqa__mixer_gmlp__prompt_gspin_258
L_parallel_sum__grouped_kv_mqa__mixer_gmlp__prompt_gspun_259:
    s_branch L_parallel_sum__grouped_kv_mqa__mixer_gmlp__prompt_gok_110
L_parallel_sum__grouped_kv_mqa__mixer_gmlp__prompt_gslow_113:
L_parallel_sum__grouped_kv_mqa__mixer_gmlp__prompt_gspin_260:
    ds_read_b32 v4, v3
    s_waitcnt lgkmcnt(0)
    v_cmp_gt_u32 vcc, 13, v4
    s_cbranch_vccz L_parallel_sum__grouped_kv_mqa__mixer_gmlp__prompt_gspun_261
    s_sleep 1
    s_sub_u32 s70, s70, 1
    s_cbranch_scc0 L_parallel_sum__grouped_kv_mqa__mixer_gmlp__prompt_gspin_260
L_parallel_sum__grouped_kv_mqa__mixer_gmlp__prompt_gspun_261:
    s_branch L_parallel_sum__grouped_kv_mqa__mixer_gmlp__prompt_gok_112
L_parallel_sum__grouped_kv_mqa__mixer_gmlp__prompt_gslow_115:
L_parallel_sum__grouped_kv_mqa__mixer_gmlp__prompt_gspin_262:
    ds_read_b32 v4, v3
    s_waitcnt lgkmcnt(0)
    v_cmp_gt_u32 vcc, 14, v4
    s_cbranch_vccz L_parallel_sum__grouped_kv_mqa__mixer_gmlp__prompt_gspun_263
    s_sleep 1
    s_sub_u32 s70, s70, 1
    s_cbranch_scc0 L_parallel_sum__grouped_kv_mqa__mixer_gmlp__prompt_gspin_262
L_parallel_sum__grouped_kv_mqa__mixer_gmlp__prompt_gspun_263:
    s_branch L_parallel_sum__grouped_kv_mqa__mixer_gmlp__prompt_gok_114
L_parallel_sum__grouped_kv_mqa__mixer_gmlp__prompt_gslow_117:
L_parallel_sum__grouped_kv_mqa__mixer_gmlp__prompt_gspin_264:
    ds_read_b32 v4, v3
    s_waitcnt lgkmcnt(0)
    v_cmp_gt_u32 vcc, 15, v4
    s_cbranch_vccz L_parallel_sum__grouped_kv_mqa__mixer_gmlp__prompt_gspun_265
    s_sleep 1
    s_sub_u32 s70, s70, 1
    s_cbranch_scc0 L_parallel_sum__grouped_kv_mqa__mixer_gmlp__prompt_gspin_264
L_parallel_sum__grouped_kv_mqa__mixer_gmlp__prompt_gspun_265:
    s_branch L_parallel_sum__grouped_kv_mqa__mixer_gmlp__prompt_gok_116
L_parallel_sum__grouped_kv_mqa__mixer_gmlp__prompt_gslow_119:
L_parallel_sum__grouped_kv_mqa__mixer_gmlp__prompt_gspin_266:
    ds_read_b32 v4, v3
    s_waitcnt lgkmcnt(0)
    v_cmp_gt_u32 vcc, 16, v4
    s_cbranch_vccz L_parallel_sum__grouped_kv_mqa__mixer_gmlp__prompt_gspun_267
    s_sleep 1
    s_sub_u32 s70, s70, 1
    s_cbranch_scc0 L_parallel_sum__grouped_kv_mqa__mixer_gmlp__prompt_gspin_266
L_parallel_sum__grouped_kv_mqa__mixer_gmlp__prompt_gspun_267:
    s_branch L_parallel_sum__grouped_kv_mqa__mixer_gmlp__prompt_gok_118
L_parallel_sum__grouped_kv_mqa__mixer_gmlp__prompt_gslow_121:
L_parallel_sum__grouped_kv_mqa__mixer_gmlp__prompt_gspin_268:
    ds_read_b32 v4, v3
    s_waitcnt lgkmcnt(0)
    v_cmp_gt_u32 vcc, 17, v4
    s_cbranch_vccz L_parallel_sum__grouped_kv_mqa__mixer_gmlp__prompt_gspun_269
    s_sleep 1
    s_sub_u32 s70, s70, 1
    s_cbranch_scc0 L_parallel_sum__grouped_kv_mqa__mixer_gmlp__prompt_gspin_268
L_parallel_sum__grouped_kv_mqa__mixer_gmlp__prompt_gspun_269:
    s_branch L_parallel_sum__grouped_kv_mqa__mixer_gmlp__prompt_gok_120
L_parallel_sum__grouped_kv_mqa__mixer_gmlp__prompt_gslow_124:
L_parallel_sum__grouped_kv_mqa__mixer_gmlp__prompt_gspin_270:
    ds_read_b32 v4, v3
    s_waitcnt lgkmcnt(0)
    v_cmp_gt_u32 vcc, 18, v4
    s_cbranch_vccz L_parallel_sum__grouped_kv_mqa__mixer_gmlp__prompt_gspun_271
    s_sleep 1
    s_sub_u32 s70, s70, 1
    s_cbranch_scc0 L_parallel_sum__grouped_kv_mqa__mixer_gmlp__prompt_gspin_270
L_parallel_sum__grouped_kv_mqa__mixer_gmlp__prompt_gspun_271:
    s_branch L_parallel_sum__grouped_kv_mqa__mixer_gmlp__prompt_gok_123
L_parallel_sum__grouped_kv_mqa__mixer_gmlp__prompt_gslow_126:
L_parallel_sum__grouped_kv_mqa__mixer_gmlp__prompt_gspin_272:
    ds_read_b32 v4, v3
    s_waitcnt lgkmcnt(0)
    v_cmp_gt_u32 vcc, 19, v4
    s_cbranch_vccz L_parallel_sum__grouped_kv_mqa__mixer_gmlp__prompt_gspun_273
    s_sleep 1
    s_sub_u32 s70, s70, 1
    s_cbranch_scc0 L_parallel_sum__grouped_kv_mqa__mixer_gmlp__prompt_gspin_272
L_parallel_sum__grouped_kv_mqa__mixer_gmlp__prompt_gspun_273:
    s_branch L_parallel_sum__grouped_kv_mqa__mixer_gmlp__prompt_gok_125
L_parallel_sum__grouped_kv_mqa__mixer_gmlp__prompt_gslow_128:
L_parallel_sum__grouped_kv_mqa__mixer_gmlp__prompt_gspin_274:
    ds_read_b32 v4, v3
    s_waitcnt lgkmcnt(0)
    v_cmp_gt_u32 vcc, 20, v4
    s_cbranch_vccz L_parallel_sum__grouped_kv_mqa__mixer_gmlp__prompt_gspun_275
    s_sleep 1
    s_sub_u32 s70, s70, 1
    s_cbranch_scc0 L_parallel_sum__grouped_kv_mqa__mixer_gmlp__prompt_gspin_274
L_parallel_sum__grouped_kv_mqa__mixer_gmlp__prompt_gspun_275:
    s_branch L_parallel_sum__grouped_kv_mqa__mixer_gmlp__prompt_gok_127
L_parallel_sum__grouped_kv_mqa__mixer_gmlp__prompt_gslow_133:
L_parallel_sum__grouped_kv_mqa__mixer_gmlp__prompt_gspin_276:
    ds_read_b32 v4, v3
    s_waitcnt lgkmcnt(0)
    v_cmp_gt_u32 vcc, 21, v4
    s_cbranch_vccz L_parallel_sum__grouped_kv_mqa__mixer_gmlp__prompt_gspun_277
    s_sleep 1
    s_sub_u32 s70, s70, 1
    s_cbranch_scc0 L_parallel_sum__grouped_kv_mqa__mixer_gmlp__prompt_gspin_276
L_parallel_sum__grouped_kv_mqa__mixer_gmlp__prompt_gspun_277:
    s_branch L_parallel_sum__grouped_kv_mqa__mixer_gmlp__prompt_gok_132
L_parallel_sum__grouped_kv_mqa__mixer_gmlp__prompt_gslow_138:
L_parallel_sum__grouped_kv_mqa__mixer_gmlp__prompt_gspin_278:
    ds_read_b32 v4, v3
    s_waitcnt lgkmcnt(0)
    v_cmp_gt_u32 vcc, 22, v4
    s_cbranch_vccz L_parallel_sum__grouped_kv_mqa__mixer_gmlp__prompt_gspun_279
    s_sleep 1
    s_sub_u32 s70, s70, 1
    s_cbranch_scc0 L_parallel_sum__grouped_kv_mqa__mixer_gmlp__prompt_gspin_278
L_parallel_sum__grouped_kv_mqa__mixer_gmlp__prompt_gspun_279:
    s_branch L_parallel_sum__grouped_kv_mqa__mixer_gmlp__prompt_gok_137
L_parallel_sum__grouped_kv_mqa__mixer_gmlp__prompt_gslow_140:
L_parallel_sum__grouped_kv_mqa__mixer_gmlp__prompt_gspin_280:
    ds_read_b32 v4, v3
    s_waitcnt lgkmcnt(0)
    v_cmp_gt_u32 vcc, 23, v4
    s_cbranch_vccz L_parallel_sum__grouped_kv_mqa__mixer_gmlp__prompt_gspun_281
    s_sleep 1
    s_sub_u32 s70, s70, 1
    s_cbranch_scc0 L_parallel_sum__grouped_kv_mqa__mixer_gmlp__prompt_gspin_280
L_parallel_sum__grouped_kv_mqa__mixer_gmlp__prompt_gspun_281:
    s_branch L_parallel_sum__grouped_kv_mqa__mixer_gmlp__prompt_gok_139
L_parallel_sum__grouped_kv_mqa__mixer_gmlp__prompt_gslow_142:
L_parallel_sum__grouped_kv_mqa__mixer_gmlp__prompt_gspin_282:
    ds_read_b32 v4, v3
    s_waitcnt lgkmcnt(0)
    v_cmp_gt_u32 vcc, 24, v4
    s_cbranch_vccz L_parallel_sum__grouped_kv_mqa__mixer_gmlp__prompt_gspun_283
    s_sleep 1
    s_sub_u32 s70, s70, 1
    s_cbranch_scc0 L_parallel_sum__grouped_kv_mqa__mixer_gmlp__prompt_gspin_282
L_parallel_sum__grouped_kv_mqa__mixer_gmlp__prompt_gspun_283:
    s_branch L_parallel_sum__grouped_kv_mqa__mixer_gmlp__prompt_gok_141
L_parallel_sum__grouped_kv_mqa__mixer_gmlp__prompt_gslow_144:
L_parallel_sum__grouped_kv_mqa__mixer_gmlp__prompt_gspin_284:
    ds_read_b32 v4, v3
    s_waitcnt lgkmcnt(0)
    v_cmp_gt_u32 vcc, 25, v4
    s_cbranch_vccz L_parallel_sum__grouped_kv_mqa__mixer_gmlp__prompt_gspun_285
    s_sleep 1
    s_sub_u32 s70, s70, 1
    s_cbranch_scc0 L_parallel_sum__grouped_kv_mqa__mixer_gmlp__prompt_gspin_284
L_parallel_sum__grouped_kv_mqa__mixer_gmlp__prompt_gspun_285:
    s_branch L_parallel_sum__grouped_kv_mqa__mixer_gmlp__prompt_gok_143
L_parallel_sum__grouped_kv_mqa__mixer_gmlp__prompt_gslow_151:
L_parallel_sum__grouped_kv_mqa__mixer_gmlp__prompt_gspin_286:
    ds_read_b32 v4, v3
    s_waitcnt lgkmcnt(0)
    v_cmp_gt_u32 vcc, 26, v4
    s_cbranch_vccz L_parallel_sum__grouped_kv_mqa__mixer_gmlp__prompt_gspun_287
    s_sleep 1
    s_sub_u32 s70, s70, 1
    s_cbranch_scc0 L_parallel_sum__grouped_kv_mqa__mixer_gmlp__prompt_gspin_286
L_parallel_sum__grouped_kv_mqa__mixer_gmlp__prompt_gspun_287:
    s_branch L_parallel_sum__grouped_kv_mqa__mixer_gmlp__prompt_gok_150
L_parallel_sum__grouped_kv_mqa__mixer_gmlp__prompt_gslow_153:
L_parallel_sum__grouped_kv_mqa__mixer_gmlp__prompt_gspin_288:
    ds_read_b32 v4, v3
    s_waitcnt lgkmcnt(0)
    v_cmp_gt_u32 vcc, 27, v4
    s_cbranch_vccz L_parallel_sum__grouped_kv_mqa__mixer_gmlp__prompt_gspun_289
    s_sleep 1
    s_sub_u32 s70, s70, 1
    s_cbranch_scc0 L_parallel_sum__grouped_kv_mqa__mixer_gmlp__prompt_gspin_288
L_parallel_sum__grouped_kv_mqa__mixer_gmlp__prompt_gspun_289:
    s_branch L_parallel_sum__grouped_kv_mqa__mixer_gmlp__prompt_gok_152
L_parallel_sum__grouped_kv_mqa__mixer_gmlp__prompt_gslow_155:
L_parallel_sum__grouped_kv_mqa__mixer_gmlp__prompt_gspin_290:
    ds_read_b32 v4, v3
    s_waitcnt lgkmcnt(0)
    v_cmp_gt_u32 vcc, 28, v4
    s_cbranch_vccz L_parallel_sum__grouped_kv_mqa__mixer_gmlp__prompt_gspun_291
    s_sleep 1
    s_sub_u32 s70, s70, 1
    s_cbranch_scc0 L_parallel_sum__grouped_kv_mqa__mixer_gmlp__prompt_gspin_290
L_parallel_sum__grouped_kv_mqa__mixer_gmlp__prompt_gspun_291:
    s_branch L_parallel_sum__grouped_kv_mqa__mixer_gmlp__prompt_gok_154
L_parallel_sum__grouped_kv_mqa__mixer_gmlp__prompt_gslow_157:
L_parallel_sum__grouped_kv_mqa__mixer_gmlp__prompt_gspin_292:
    ds_read_b32 v4, v3
    s_waitcnt lgkmcnt(0)
    v_cmp_gt_u32 vcc, 29, v4
    s_cbranch_vccz L_parallel_sum__grouped_kv_mqa__mixer_gmlp__prompt_gspun_293
    s_sleep 1
    s_sub_u32 s70, s70, 1
    s_cbranch_scc0 L_parallel_sum__grouped_kv_mqa__mixer_gmlp__prompt_gspin_292
L_parallel_sum__grouped_kv_mqa__mixer_gmlp__prompt_gspun_293:
    s_branch L_parallel_sum__grouped_kv_mqa__mixer_gmlp__prompt_gok_156
L_parallel_sum__grouped_kv_mqa__mixer_gmlp__prompt_gslow_160:
L_parallel_sum__grouped_kv_mqa__mixer_gmlp__prompt_gspin_294:
    ds_read_b32 v4, v3
    s_waitcnt lgkmcnt(0)
    v_cmp_gt_u32 vcc, s29, v4
    s_cbranch_vccz L_parallel_sum__grouped_kv_mqa__mixer_gmlp__prompt_gspun_295
    s_sleep 1
    s_sub_u32 s70, s70, 1
    s_cbranch_scc0 L_parallel_sum__grouped_kv_mqa__mixer_gmlp__prompt_gspin_294
L_parallel_sum__grouped_kv_mqa__mixer_gmlp__prompt_gspun_295:
    s_branch L_parallel_sum__grouped_kv_mqa__mixer_gmlp__prompt_gok_159
L_parallel_sum__grouped_kv_mqa__mixer_gmlp__prompt_gslow_162:
L_parallel_sum__grouped_kv_mqa__mixer_gmlp__prompt_gspin_296:
    ds_read_b32 v4, v3
    s_waitcnt lgkmcnt(0)
    v_cmp_gt_u32 vcc, s29, v4
    s_cbranch_vccz L_parallel_sum__grouped_kv_mqa__mixer_gmlp__prompt_gspun_297
    s_sleep 1
    s_sub_u32 s70, s70, 1
    s_cbranch_scc0 L_parallel_sum__grouped_kv_mqa__mixer_gmlp__prompt_gspin_296
L_parallel_sum__grouped_kv_mqa__mixer_gmlp__prompt_gspun_297:
    s_branch L_parallel_sum__grouped_kv_mqa__mixer_gmlp__prompt_gok_161
L_parallel_sum__grouped_kv_mqa__mixer_gmlp__prompt_gslow_164:
L_parallel_sum__grouped_kv_mqa__mixer_gmlp__prompt_gspin_298:
    ds_read_b32 v4, v3
    s_waitcnt lgkmcnt(0)
    v_cmp_gt_u32 vcc, s29, v4
    s_cbranch_vccz L_parallel_sum__grouped_kv_mqa__mixer_gmlp__prompt_gspun_299
    s_sleep 1
    s_sub_u32 s70, s70, 1
    s_cbranch_scc0 L_parallel_sum__grouped_kv_mqa__mixer_gmlp__prompt_gspin_298
L_parallel_sum__grouped_kv_mqa__mixer_gmlp__prompt_gspun_299:
    s_branch L_parallel_sum__grouped_kv_mqa__mixer_gmlp__prompt_gok_163
L_parallel_sum__grouped_kv_mqa__mixer_gmlp__prompt_gslow_166:
L_parallel_sum__grouped_kv_mqa__mixer_gmlp__prompt_gspin_300:
    ds_read_b32 v4, v3
    s_waitcnt lgkmcnt(0)
    v_cmp_gt_u32 vcc, s29, v4
    s_cbranch_vccz L_parallel_sum__grouped_kv_mqa__mixer_gmlp__prompt_gspun_301
    s_sleep 1
    s_sub_u32 s70, s70, 1
    s_cbranch_scc0 L_parallel_sum__grouped_kv_mqa__mixer_gmlp__prompt_gspin_300
L_parallel_sum__grouped_kv_mqa__mixer_gmlp__prompt_gspun_301:
    s_branch L_parallel_sum__grouped_kv_mqa__mixer_gmlp__prompt_gok_165
L_parallel_sum__grouped_kv_mqa__mixer_gmlp__prompt_gslow_168:
L_parallel_sum__grouped_kv_mqa__mixer_gmlp__prompt_gspin_302:
    ds_read_b32 v4, v3
    s_waitcnt lgkmcnt(0)
    v_cmp_gt_u32 vcc, s29, v4
    s_cbranch_vccz L_parallel_sum__grouped_kv_mqa__mixer_gmlp__prompt_gspun_303
    s_sleep 1
    s_sub_u32 s70, s70, 1
    s_cbranch_scc0 L_parallel_sum__grouped_kv_mqa__mixer_gmlp__prompt_gspin_302
L_parallel_sum__grouped_kv_mqa__mixer_gmlp__prompt_gspun_303:
    s_branch L_parallel_sum__grouped_kv_mqa__mixer_gmlp__prompt_gok_167
L_parallel_sum__grouped_kv_mqa__mixer_gmlp__prompt_gslow_170:
L_parallel_sum__grouped_kv_mqa__mixer_gmlp__prompt_gspin_304:
    ds_read_b32 v4, v3
    s_waitcnt lgkmcnt(0)
    v_cmp_gt_u32 vcc, s29, v4
    s_cbranch_vccz L_parallel_sum__grouped_kv_mqa__mixer_gmlp__prompt_gspun_305
    s_sleep 1
    s_sub_u32 s70, s70, 1
    s_cbranch_scc0 L_parallel_sum__grouped_kv_mqa__mixer_gmlp__prompt_gspin_304
L_parallel_sum__grouped_kv_mqa__mixer_gmlp__prompt_gspun_305:
    s_branch L_parallel_sum__grouped_kv_mqa__mixer_gmlp__prompt_gok_169
L_parallel_sum__grouped_kv_mqa__mixer_gmlp__prompt_gslow_172:
L_parallel_sum__grouped_kv_mqa__mixer_gmlp__prompt_gspin_306:
    ds_read_b32 v4, v3
    s_waitcnt lgkmcnt(0)
    v_cmp_gt_u32 vcc, s29, v4
    s_cbranch_vccz L_parallel_sum__grouped_kv_mqa__mixer_gmlp__prompt_gspun_307
    s_sleep 1
    s_sub_u32 s70, s70, 1
    s_cbranch_scc0 L_parallel_sum__grouped_kv_mqa__mixer_gmlp__prompt_gspin_306
L_parallel_sum__grouped_kv_mqa__mixer_gmlp__prompt_gspun_307:
    s_branch L_parallel_sum__grouped_kv_mqa__mixer_gmlp__prompt_gok_171
L_parallel_sum__grouped_kv_mqa__mixer_gmlp__prompt_gslow_174:
L_parallel_sum__grouped_kv_mqa__mixer_gmlp__prompt_gspin_308:
    ds_read_b32 v4, v3
    s_waitcnt lgkmcnt(0)
    v_cmp_gt_u32 vcc, s29, v4
    s_cbranch_vccz L_parallel_sum__grouped_kv_mqa__mixer_gmlp__prompt_gspun_309
    s_sleep 1
    s_sub_u32 s70, s70, 1
    s_cbranch_scc0 L_parallel_sum__grouped_kv_mqa__mixer_gmlp__prompt_gspin_308
L_parallel_sum__grouped_kv_mqa__mixer_gmlp__prompt_gspun_309:
    s_branch L_parallel_sum__grouped_kv_mqa__mixer_gmlp__prompt_gok_173
L_parallel_sum__grouped_kv_mqa__mixer_gmlp__prompt_gslow_176:
L_parallel_sum__grouped_kv_mqa__mixer_gmlp__prompt_gspin_310:
    ds_read_b32 v4, v3
    s_waitcnt lgkmcnt(0)
    v_cmp_gt_u32 vcc, s29, v4
    s_cbranch_vccz L_parallel_sum__grouped_kv_mqa__mixer_gmlp__prompt_gspun_311
    s_sleep 1
    s_sub_u32 s70, s70, 1
    s_cbranch_scc0 L_parallel_sum__grouped_kv_mqa__mixer_gmlp__prompt_gspin_310
L_parallel_sum__grouped_kv_mqa__mixer_gmlp__prompt_gspun_311:
    s_branch L_parallel_sum__grouped_kv_mqa__mixer_gmlp__prompt_gok_175
L_parallel_sum__grouped_kv_mqa__mixer_gmlp__prompt_gslow_178:
L_parallel_sum__grouped_kv_mqa__mixer_gmlp__prompt_gspin_312:
    ds_read_b32 v4, v3
    s_waitcnt lgkmcnt(0)
    v_cmp_gt_u32 vcc, s29, v4
    s_cbranch_vccz L_parallel_sum__grouped_kv_mqa__mixer_gmlp__prompt_gspun_313
    s_sleep 1
    s_sub_u32 s70, s70, 1
    s_cbranch_scc0 L_parallel_sum__grouped_kv_mqa__mixer_gmlp__prompt_gspin_312
L_parallel_sum__grouped_kv_mqa__mixer_gmlp__prompt_gspun_313:
    s_branch L_parallel_sum__grouped_kv_mqa__mixer_gmlp__prompt_gok_177
L_parallel_sum__grouped_kv_mqa__mixer_gmlp__prompt_gslow_180:
L_parallel_sum__grouped_kv_mqa__mixer_gmlp__prompt_gspin_314:
    ds_read_b32 v4, v3
    s_waitcnt lgkmcnt(0)
    v_cmp_gt_u32 vcc, s29, v4
    s_cbranch_vccz L_parallel_sum__grouped_kv_mqa__mixer_gmlp__prompt_gspun_315
    s_sleep 1
    s_sub_u32 s70, s70, 1
    s_cbranch_scc0 L_parallel_sum__grouped_kv_mqa__mixer_gmlp__prompt_gspin_314
L_parallel_sum__grouped_kv_mqa__mixer_gmlp__prompt_gspun_315:
    s_branch L_parallel_sum__grouped_kv_mqa__mixer_gmlp__prompt_gok_179
L_parallel_sum__grouped_kv_mqa__mixer_gmlp__prompt_gslow_182:
L_parallel_sum__grouped_kv_mqa__mixer_gmlp__prompt_gspin_316:
    ds_read_b32 v4, v3
    s_waitcnt lgkmcnt(0)
    v_cmp_gt_u32 vcc, s29, v4
    s_cbranch_vccz L_parallel_sum__grouped_kv_mqa__mixer_gmlp__prompt_gspun_317
    s_sleep 1
    s_sub_u32 s70, s70, 1
    s_cbranch_scc0 L_parallel_sum__grouped_kv_mqa__mixer_gmlp__prompt_gspin_316
L_parallel_sum__grouped_kv_mqa__mixer_gmlp__prompt_gspun_317:
    s_branch L_parallel_sum__grouped_kv_mqa__mixer_gmlp__prompt_gok_181
L_parallel_sum__grouped_kv_mqa__mixer_gmlp__prompt_gslow_184:
L_parallel_sum__grouped_kv_mqa__mixer_gmlp__prompt_gspin_318:
    ds_read_b32 v4, v3
    s_waitcnt lgkmcnt(0)
    v_cmp_gt_u32 vcc, s29, v4
    s_cbranch_vccz L_parallel_sum__grouped_kv_mqa__mixer_gmlp__prompt_gspun_319
    s_sleep 1
    s_sub_u32 s70, s70, 1
    s_cbranch_scc0 L_parallel_sum__grouped_kv_mqa__mixer_gmlp__prompt_gspin_318
L_parallel_sum__grouped_kv_mqa__mixer_gmlp__prompt_gspun_319:
    s_branch L_parallel_sum__grouped_kv_mqa__mixer_gmlp__prompt_gok_183
L_parallel_sum__grouped_kv_mqa__mixer_gmlp__prompt_gslow_186:
L_parallel_sum__grouped_kv_mqa__mixer_gmlp__prompt_gspin_320:
    ds_read_b32 v4, v3
    s_waitcnt lgkmcnt(0)
    v_cmp_gt_u32 vcc, s29, v4
    s_cbranch_vccz L_parallel_sum__grouped_kv_mqa__mixer_gmlp__prompt_gspun_321
    s_sleep 1
    s_sub_u32 s70, s70, 1
    s_cbranch_scc0 L_parallel_sum__grouped_kv_mqa__mixer_gmlp__prompt_gspin_320
L_parallel_sum__grouped_kv_mqa__mixer_gmlp__prompt_gspun_321:
    s_branch L_parallel_sum__grouped_kv_mqa__mixer_gmlp__prompt_gok_185
L_parallel_sum__grouped_kv_mqa__mixer_gmlp__prompt_gslow_191:
L_parallel_sum__grouped_kv_mqa__mixer_gmlp__prompt_gspin_322:
    ds_read_b32 v4, v3
    s_waitcnt lgkmcnt(0)
    v_cmp_gt_u32 vcc, s29, v4
    s_cbranch_vccz L_parallel_sum__grouped_kv_mqa__mixer_gmlp__prompt_gspun_323
    s_sleep 1
    s_sub_u32 s70, s70, 1
    s_cbranch_scc0 L_parallel_sum__grouped_kv_mqa__mixer_gmlp__prompt_gspin_322
L_parallel_sum__grouped_kv_mqa__mixer_gmlp__prompt_gspun_323:
    s_branch L_parallel_sum__grouped_kv_mqa__mixer_gmlp__prompt_gok_190
L_parallel_sum__grouped_kv_mqa__mixer_gmlp__prompt_gslow_193:
L_parallel_sum__grouped_kv_mqa__mixer_gmlp__prompt_gspin_324:
    ds_read_b32 v4, v3
    s_waitcnt lgkmcnt(0)
    v_cmp_gt_u32 vcc, s29, v4
    s_cbranch_vccz L_parallel_sum__grouped_kv_mqa__mixer_gmlp__prompt_gspun_325
    s_sleep 1
    s_sub_u32 s70, s70, 1
    s_cbranch_scc0 L_parallel_sum__grouped_kv_mqa__mixer_gmlp__prompt_gspin_324
L_parallel_sum__grouped_kv_mqa__mixer_gmlp__prompt_gspun_325:
    s_branch L_parallel_sum__grouped_kv_mqa__mixer_gmlp__prompt_gok_192
L_parallel_sum__grouped_kv_mqa__mixer_gmlp__prompt_gslow_195:
L_parallel_sum__grouped_kv_mqa__mixer_gmlp__prompt_gspin_326:
    ds_read_b32 v4, v3
    s_waitcnt lgkmcnt(0)
    v_cmp_gt_u32 vcc, s29, v4
    s_cbranch_vccz L_parallel_sum__grouped_kv_mqa__mixer_gmlp__prompt_gspun_327
    s_sleep 1
    s_sub_u32 s70, s70, 1
    s_cbranch_scc0 L_parallel_sum__grouped_kv_mqa__mixer_gmlp__prompt_gspin_326
L_parallel_sum__grouped_kv_mqa__mixer_gmlp__prompt_gspun_327:
    s_branch L_parallel_sum__grouped_kv_mqa__mixer_gmlp__prompt_gok_194
L_parallel_sum__grouped_kv_mqa__mixer_gmlp__prompt_gslow_197:
L_parallel_sum__grouped_kv_mqa__mixer_gmlp__prompt_gspin_328:
    ds_read_b32 v4, v3
    s_waitcnt lgkmcnt(0)
    v_cmp_gt_u32 vcc, s29, v4
    s_cbranch_vccz L_parallel_sum__grouped_kv_mqa__mixer_gmlp__prompt_gspun_329
    s_sleep 1
    s_sub_u32 s70, s70, 1
    s_cbranch_scc0 L_parallel_sum__grouped_kv_mqa__mixer_gmlp__prompt_gspin_328
L_parallel_sum__grouped_kv_mqa__mixer_gmlp__prompt_gspun_329:
    s_branch L_parallel_sum__grouped_kv_mqa__mixer_gmlp__prompt_gok_196
L_parallel_sum__grouped_kv_mqa__mixer_gmlp__prompt_end_1:
    s_endpgm
.section .rodata,"a"
.p2align 6
.amdhsa_kernel parallel_sum__grouped_kv_mqa__mixer_gmlp__prompt_kernel
  .amdhsa_next_free_vgpr 168
  .amdhsa_next_free_sgpr 100
  .amdhsa_accum_offset 168
  .amdhsa_group_segment_fixed_size 0
  .amdhsa_kernarg_size 104
  .amdhsa_user_sgpr_count 2
  .amdhsa_user_sgpr_kernarg_segment_ptr 1
  .amdhsa_system_sgpr_workgroup_id_x 1
  .amdhsa_float_denorm_mode_32 3
.end_amdhsa_kernel
```
